```python
import torch

def _softmax(x, axis=-1):
    return torch.softmax(x, dim=axis)
def _gelu(x):
    return torch.nn.functional.gelu(x, approximate="tanh")
def _silu(x):
    return torch.nn.functional.silu(x)
def _sigmoid(x):
    return torch.sigmoid(x)
def _layernorm(x, axis=-1, eps=1e-5):
    m = x.mean(dim=axis, keepdim=True)
    v = x.var(dim=axis, keepdim=True, unbiased=False)
    return (x - m) / torch.sqrt(v + eps)
def _scatter_add(tgt, idx, src, axis=0):
    return tgt.clone().index_add_(axis, idx, src)
def _segment_sum(src, seg, n):
    out = torch.zeros((n,) + src.shape[1:], dtype=src.dtype)
    return out.index_add_(0, seg, src)
def _pad(x, pw):
    flat = tuple(v for pair in reversed(pw) for v in pair)
    return torch.nn.functional.pad(x, flat)

kernel_name = 'parallel_sum__mha_block__geglu_ffn__prompt'

def setup_inputs():

    _w = (lambda a: (lambda t: t.to(torch.bfloat16) if t.is_floating_point() else t)(torch.as_tensor(a)))
    def _A_setup():
        B, S, D, H = 1, 2048, 448, 16
        return {
            "x": _w((lambda *s: torch.randn(*s, dtype=torch.bfloat16) * 0.05)(B, S, D)),
            "wqkv": _w((lambda *s: torch.randn(*s, dtype=torch.bfloat16) * 0.2)(D, 3 * D)),
            "wo": _w((lambda *s: torch.randn(*s, dtype=torch.bfloat16) * 0.1)(D, D)),
        }
    _A_in = _A_setup()

    def _B_setup():
        B, S, D, F = 1, 2048, 448, 1792
        return {
            "x": _w((lambda *s: torch.randn(*s, dtype=torch.bfloat16) * 0.05)(B, S, D)),
            "w_gate": _w((lambda *s: torch.randn(*s, dtype=torch.bfloat16) * 0.1)(D, F)),
            "w_up": _w((lambda *s: torch.randn(*s, dtype=torch.bfloat16) * 0.1)(D, F)),
            "w_down": _w((lambda *s: torch.randn(*s, dtype=torch.bfloat16) * 0.1)(F, D)),
        }
    _B_in = _B_setup()

    return {
        "A_x": _A_in["x"],
        "A_wqkv": _A_in["wqkv"],
        "A_wo": _A_in["wo"],
        "B_x": _B_in["x"],
        "B_w_gate": _B_in["w_gate"],
        "B_w_up": _B_in["w_up"],
        "B_w_down": _B_in["w_down"],
    }

def reference(A_x, A_wqkv, A_wo, B_x, B_w_gate, B_w_up, B_w_down):
    def _A_ref(x, wqkv, wo):
        B, S, D = x.shape
        H = 16
        Dh = D // H
        qkv = (lambda x, *d: x.permute(*d))((x @ wqkv).reshape(B, S, 3, H, Dh), 2, 0, 3, 1, 4)
        q, k, v = qkv[0], qkv[1], qkv[2]
        scores = torch.einsum("bhqd,bhkd->bhqk", q, k) * (Dh ** -0.5)
        p = _softmax(scores, axis=-1)
        o = torch.einsum("bhqk,bhkd->bhqd", p, v)
        return (lambda x, *d: x.permute(*d))(o, 0, 2, 1, 3).reshape(B, S, D) @ wo

    def _B_ref(x, w_gate, w_up, w_down):
        return (_gelu(x @ w_gate) * (x @ w_up)) @ w_down

    x = A_x
    xn = _layernorm(x, axis=-1)
    return x + _A_ref(xn, A_wqkv, A_wo) + _B_ref(xn, B_w_gate, B_w_up, B_w_down)
```

```asm
; @launch grid=(256,1,1) block=(512,1,1) lds=163840
.amdgcn_target "amdgcn-amd-amdhsa--gfx950"
.text
.globl parallel_sum__mha_block__geglu_ffn__prompt_kernel
.p2align 8
.type parallel_sum__mha_block__geglu_ffn__prompt_kernel,@function
parallel_sum__mha_block__geglu_ffn__prompt_kernel:
    s_cmp_ge_u32 s2, 256
    s_cbranch_scc1 L_end
    s_load_dwordx16 s[4:19], s[0:1], 0
    s_load_dwordx4 s[20:23], s[0:1], 64
    s_and_b32 s55, s2, 7
    s_lshr_b32 s56, s2, 3
    s_and_b32 s51, s55, 1
    s_lshl_b32 s51, s51, 3
    s_and_b32 s52, s56, 7
    s_add_u32 s51, s51, s52
    s_lshr_b32 s50, s55, 1
    s_lshl_b32 s50, s50, 2
    s_lshr_b32 s52, s56, 3
    s_add_u32 s50, s50, s52
    v_lshrrev_b32 v1, 6, v0
    v_and_b32 v2, 63, v0
    v_readfirstlane_b32 s53, v1
    v_and_b32 v224, 31, v2
    v_lshrrev_b32 v225, 5, v2
    v_lshlrev_b32 v13, 4, v2
    s_cmp_lg_u32 s53, 7
    s_cbranch_scc1 L1_nopf
    s_getpc_b64 s[58:59]
L1_pc:
    s_lshl_b32 s57, s56, 11
    v_and_b32 v1, 15, v2
    v_lshlrev_b32 v1, 7, v1
    v_add_u32 v1, s57, v1
    v_min_u32 v1, L_code_end - L1_pc - 4, v1
    global_load_dword v128, v1, s[58:59]
L1_nopf:
    s_and_b32 s48, s53, 3
    s_lshr_b32 s49, s53, 2
    s_lshl_b32 s54, s51, 2
    s_add_u32 s54, s54, s48
    s_mul_i32 s55, s50, 2
    s_mul_i32 s56, s51, 1
    s_add_u32 s55, s55, s56
    s_mul_i32 s56, s55, 9363
    s_lshr_b32 s56, s56, 16
    s_mul_i32 s56, s56, 7
    s_sub_u32 s56, s55, s56
    s_lshl_b32 s70, s48, 12
    v_lshrrev_b32 v228, 3, v2
    v_and_b32 v229, 7, v2
    v_lshrrev_b32 v230, 4, v2
    s_lshl_b32 s55, s54, 5
    v_add_u32 v231, s55, v228
    v_mul_u32_u24 v231, 896, v231
    v_xor_b32 v232, v229, v230
    v_lshl_add_u32 v226, v232, 4, v231
    v_xor_b32 v232, 4, v232
    v_lshl_add_u32 v227, v232, 4, v231
    s_waitcnt lgkmcnt(0)
    s_mov_b32 s24, s4
    s_mov_b32 s25, s5
    s_mov_b32 s26, 1835008
    s_mov_b32 s27, 0x00020000
    v_mov_b32 v136, v226
    v_mov_b32 v137, v227
    s_cmp_eq_u32 s49, 1
    s_cbranch_scc1 L1_x3
    s_add_u32 s57, s56, 0
    s_sub_u32 s58, s57, 7
    s_cmp_lt_u32 s57, 7
    s_cselect_b32 s57, s57, s58
    s_lshl_b32 s57, s57, 7
    s_add_u32 m0, s70, 0
    s_nop 0
    buffer_load_dwordx4 v136, s[24:27], s57 offen offset:0 lds
    s_add_u32 s57, s57, 6144
    buffer_load_dwordx4 v137, s[24:27], s57 offen offset:1024 lds
    s_add_u32 s57, s57, 6144
    buffer_load_dwordx4 v136, s[24:27], s57 offen offset:2048 lds
    s_add_u32 s57, s57, 6144
    buffer_load_dwordx4 v137, s[24:27], s57 offen offset:3072 lds
    s_add_u32 s57, s56, 1
    s_sub_u32 s58, s57, 7
    s_cmp_lt_u32 s57, 7
    s_cselect_b32 s57, s57, s58
    s_lshl_b32 s57, s57, 7
    s_add_u32 m0, s70, 16384
    s_nop 0
    buffer_load_dwordx4 v136, s[24:27], s57 offen offset:0 lds
    s_add_u32 s57, s57, 6144
    buffer_load_dwordx4 v137, s[24:27], s57 offen offset:1024 lds
    s_add_u32 s57, s57, 6144
    buffer_load_dwordx4 v136, s[24:27], s57 offen offset:2048 lds
    s_add_u32 s57, s57, 6144
    buffer_load_dwordx4 v137, s[24:27], s57 offen offset:3072 lds
    s_add_u32 s57, s56, 2
    s_sub_u32 s58, s57, 7
    s_cmp_lt_u32 s57, 7
    s_cselect_b32 s57, s57, s58
    s_lshl_b32 s57, s57, 7
    s_add_u32 m0, s70, 32768
    s_nop 0
    buffer_load_dwordx4 v136, s[24:27], s57 offen offset:0 lds
    s_add_u32 s57, s57, 6144
    buffer_load_dwordx4 v137, s[24:27], s57 offen offset:1024 lds
    s_add_u32 s57, s57, 6144
    buffer_load_dwordx4 v136, s[24:27], s57 offen offset:2048 lds
    s_add_u32 s57, s57, 6144
    buffer_load_dwordx4 v137, s[24:27], s57 offen offset:3072 lds
    s_add_u32 s57, s56, 3
    s_sub_u32 s58, s57, 7
    s_cmp_lt_u32 s57, 7
    s_cselect_b32 s57, s57, s58
    s_lshl_b32 s57, s57, 7
    s_add_u32 m0, s70, 49152
    s_nop 0
    buffer_load_dwordx4 v136, s[24:27], s57 offen offset:0 lds
    s_add_u32 s57, s57, 6144
    buffer_load_dwordx4 v137, s[24:27], s57 offen offset:1024 lds
    s_add_u32 s57, s57, 6144
    buffer_load_dwordx4 v136, s[24:27], s57 offen offset:2048 lds
    s_add_u32 s57, s57, 6144
    buffer_load_dwordx4 v137, s[24:27], s57 offen offset:3072 lds
L1_x3:
    s_lshr_b32 s57, s50, 2
    s_and_b32 s58, s50, 3
    s_and_b32 s59, s50, 10
    s_cmp_eq_u32 s59, 10
    s_cselect_b32 s59, 1, 0
    s_xor_b32 s58, s58, s59
    s_mul_i32 s59, s57, 3
    s_add_u32 s59, s59, s58
    s_lshl_b32 s59, s59, 1
    s_add_u32 s65, s57, 24
    s_lshl_b32 s62, s57, 2
    s_add_u32 s62, s62, 32
    s_cmp_eq_u32 s58, 3
    s_cselect_b32 s60, 1, 0
    s_cselect_b32 s61, s65, s59
    s_movk_i32 s64, 3584
    s_cselect_b32 s64, 2688, s64
    s_cselect_b32 s76, s6, s12
    s_cselect_b32 s77, s7, s13
    s_mov_b32 s78, 1605632
    s_cselect_b32 s78, 1204224, s78
    s_mov_b32 s79, 0x00020000
    s_cselect_b32 s80, s6, s14
    s_cselect_b32 s81, s7, s15
    s_mov_b32 s82, s78
    s_mov_b32 s83, 0x00020000
    s_mov_b32 s36, s6
    s_mov_b32 s37, s7
    s_mov_b32 s38, 1204224
    s_mov_b32 s39, 0x00020000
    s_lshl_b32 s58, s48, 4
    v_add_u32 v231, s58, v228
    v_and_b32 v230, 2, v228
    v_lshlrev_b32 v230, 1, v230
    v_xor_b32 v230, v229, v230
    s_lshl_b32 s88, s64, 6
    s_lshl_b32 s52, s64, 3
    s_sub_u32 s52, s52, 1024
    v_mul_u32_u24 v232, 3584, v231
    s_lshl_b32 s58, s61, 7
    v_add_u32 v232, s58, v232
    v_lshl_add_u32 v239, v230, 4, v232
    v_xor_b32 v233, 2, v230
    v_lshl_add_u32 v243, v233, 4, v232
    v_add_u32 v236, 128, v239
    v_add_u32 v237, 128, v243
    s_cmp_eq_u32 s60, 0
    s_cbranch_scc1 L1_vx
    v_lshrrev_b32 v232, 4, v2
    v_and_b32 v233, 15, v2
    v_lshlrev_b32 v1, 2, v232
    v_xor_b32 v233, v233, v1
    v_mul_u32_u24 v232, 2688, v232
    s_mul_i32 s58, s62, 56
    s_mul_i32 s59, s48, 43008
    s_add_u32 s58, s58, s59
    v_lshl_add_u32 v232, v233, 4, v232
    v_cmp_eq_u32 vcc, 15, v233
    v_add_u32 v232, s58, v232
    v_mov_b32 v1, 0x7f000000
    v_cndmask_b32 v236, v232, v1, vcc
    v_add_u32 v237, 10752, v236
L1_vx:
    v_lshrrev_b32 v232, 2, v2
    v_mul_u32_u24 v232, 2688, v232
    v_and_b32 v233, 3, v2
    s_mul_i32 s58, s50, 56
    s_and_b32 s58, s58, -16
    s_mul_i32 s59, s48, 43008
    s_add_u32 s58, s58, s59
    v_lshl_add_u32 v233, v233, 4, v232
    v_add_u32 v238, s58, v233
    s_mov_b32 s28, s12
    s_mov_b32 s29, s13
    s_mov_b32 s30, 1605632
    s_mov_b32 s31, 0x00020000
    s_mov_b32 s32, s14
    s_mov_b32 s33, s15
    s_mov_b32 s34, 1605632
    s_mov_b32 s35, 0x00020000
    s_mov_b32 s40, s22
    s_mov_b32 s41, s23
    s_mov_b32 s42, 24641536
    s_mov_b32 s43, 0x00020000
    s_mov_b32 s84, s20
    s_mov_b32 s85, s21
    s_mov_b32 s86, 256
    s_mov_b32 s87, 0x00020000
    v_bfe_u32 v228, v2, 4, 1
    v_bfe_u32 v229, v2, 2, 2
    v_and_b32 v230, 3, v2
    v_lshlrev_b32 v231, 10, v225
    s_cmp_gt_u32 s60, s49
    s_cbranch_scc1 L1_ay
    v_lshl_add_u32 v231, v229, 7, v231
    v_lshl_add_u32 v231, v228, 11, v231
    v_lshl_add_u32 v231, v230, 3, v231
    v_and_b32 v232, 2, v229
    v_or_b32 v232, v232, v228
    v_xor_b32 v1, 0, v232
    v_lshl_add_u32 v3, v1, 5, v231
    v_xor_b32 v1, 1, v232
    v_lshl_add_u32 v4, v1, 5, v231
    v_xor_b32 v1, 2, v232
    v_lshl_add_u32 v5, v1, 5, v231
    v_xor_b32 v1, 3, v232
    v_lshl_add_u32 v6, v1, 5, v231
    s_branch L1_az
L1_ay:
    v_lshl_add_u32 v231, v229, 8, v231
    v_lshlrev_b32 v232, 6, v229
    v_lshlrev_b32 v233, 5, v228
    v_lshl_add_u32 v233, v230, 3, v233
    v_xor_b32 v1, v233, v232
    v_add_u32 v3, v1, v231
    v_add_u32 v233, 56, v233
    v_xor_b32 v1, v233, v232
    v_add_u32 v4, v1, v231
    v_add_u32 v233, 56, v233
    v_xor_b32 v1, v233, v232
    v_add_u32 v5, v1, v231
    v_add_u32 v233, 56, v233
    v_xor_b32 v1, v233, v232
    v_add_u32 v6, v1, v231
L1_az:
    v_lshlrev_b32 v233, 5, v228
    v_lshl_add_u32 v233, v230, 3, v233
    v_lshl_add_u32 v233, v229, 6, v233
    v_lshl_add_u32 v7, v225, 9, v233
    s_lshl_b32 s58, s50, 3
    s_and_b32 s58, s58, 8
    v_add_u32 v7, s58, v7
    v_lshlrev_b32 v231, 7, v224
    v_add_u32 v231, s70, v231
    v_bfe_u32 v232, v224, 1, 3
    v_xor_b32 v232, v232, v225
    v_xor_b32 v233, 0, v232
    v_lshl_add_u32 v252, v233, 4, v231
    v_xor_b32 v233, 2, v232
    v_lshl_add_u32 v253, v233, 4, v231
    v_xor_b32 v233, 4, v232
    v_lshl_add_u32 v254, v233, 4, v231
    v_xor_b32 v233, 6, v232
    v_lshl_add_u32 v255, v233, 4, v231
    s_mov_b32 s89, 0x3f803f80
    s_mov_b32 s90, 0xffff0000
    s_mov_b32 s91, 0x00003f80
    s_mov_b32 s94, 0x3f800000
    s_mov_b32 s92, 0
    s_mov_b32 s93, -1
    v_mov_b32 v226, 0
    v_mov_b32 v227, 0
    v_mov_b32 v228, 0
    v_mov_b32 v229, 0
    v_lshlrev_b32 v234, 3, v2
    s_lshl_b32 s58, s49, 9
    s_add_u32 s58, s58, s70
    s_add_u32 s58, s58, 149504
    v_add_u32 v234, s58, v234
    v_xor_b32 v235, 512, v234
    s_lshr_b32 s66, s54, 1
    s_mul_i32 s66, s66, 229376
    s_and_b32 s67, s54, 1
    s_lshl_b32 s67, s67, 10
    s_add_u32 s66, s66, s67
    s_sub_u32 s61, s61, s49
    s_add_u32 s61, s61, 1
    s_lshl_b32 s67, s61, 13
    s_add_u32 s66, s66, s67
    s_add_u32 s66, s66, 6291456
    s_lshl_b32 s69, s54, 11
    s_cmp_eq_u32 s49, 0
    s_cbranch_scc1 L1_roleA
    s_add_u32 s57, s56, 4
    s_sub_u32 s58, s57, 7
    s_cmp_lt_u32 s57, 7
    s_cselect_b32 s57, s57, s58
    s_lshl_b32 s57, s57, 7
    s_add_u32 m0, s70, 65536
    s_nop 0
    buffer_load_dwordx4 v136, s[24:27], s57 offen offset:0 lds
    s_add_u32 s57, s57, 6144
    buffer_load_dwordx4 v137, s[24:27], s57 offen offset:1024 lds
    s_add_u32 s57, s57, 6144
    buffer_load_dwordx4 v136, s[24:27], s57 offen offset:2048 lds
    s_add_u32 s57, s57, 6144
    buffer_load_dwordx4 v137, s[24:27], s57 offen offset:3072 lds
    s_add_u32 s57, s56, 5
    s_sub_u32 s58, s57, 7
    s_cmp_lt_u32 s57, 7
    s_cselect_b32 s57, s57, s58
    s_lshl_b32 s57, s57, 7
    s_add_u32 m0, s70, 81920
    s_nop 0
    buffer_load_dwordx4 v136, s[24:27], s57 offen offset:0 lds
    s_add_u32 s57, s57, 6144
    buffer_load_dwordx4 v137, s[24:27], s57 offen offset:1024 lds
    s_add_u32 s57, s57, 6144
    buffer_load_dwordx4 v136, s[24:27], s57 offen offset:2048 lds
    s_add_u32 s57, s57, 6144
    buffer_load_dwordx4 v137, s[24:27], s57 offen offset:3072 lds
    s_add_u32 s57, s56, 6
    s_sub_u32 s58, s57, 7
    s_cmp_lt_u32 s57, 7
    s_cselect_b32 s57, s57, s58
    s_lshl_b32 s57, s57, 7
    s_add_u32 m0, s70, 98304
    s_nop 0
    buffer_load_dwordx4 v136, s[24:27], s57 offen offset:0 lds
    s_add_u32 s57, s57, 6144
    buffer_load_dwordx4 v137, s[24:27], s57 offen offset:1024 lds
    s_add_u32 s57, s57, 6144
    buffer_load_dwordx4 v136, s[24:27], s57 offen offset:2048 lds
    s_add_u32 s57, s57, 6144
    buffer_load_dwordx4 v137, s[24:27], s57 offen offset:3072 lds
    s_branch L1_roleB
L1_roleA:
    s_mov_b32 s72, s50
    s_mov_b32 s73, s51
    s_mov_b32 s57, s54
    s_lshr_b32 s71, s57, 1
    s_lshl_b32 s71, s71, 16
    s_and_b32 s58, s57, 1
    s_lshl_b32 s58, s58, 10
    s_add_u32 s71, s71, s58
    s_lshl_b32 s58, s72, 12
    s_add_u32 s71, s71, s58
    s_add_u32 s71, s71, 15728640
    s_or_b32 s57, s2, s53
    s_cmp_lg_u32 s57, 0
    s_cbranch_scc1 L1_notag
    s_memrealtime s[96:97]
    v_mov_b32 v0, 0
    s_waitcnt lgkmcnt(0)
    s_or_b32 s57, s96, 1
    v_mov_b32 v1, s57
    buffer_store_dword v1, v0, s[84:87], 0 offen sc1
    s_waitcnt vmcnt(0)
L1_notag:
    s_waitcnt vmcnt(12)
    ds_read_b128 v[16:19], v252 offset:0
    ds_read_b128 v[20:23], v253 offset:0
    ds_read_b128 v[24:27], v254 offset:0
    ds_read_b128 v[28:31], v255 offset:0
    s_waitcnt vmcnt(8)
    ds_read_b128 v[32:35], v252 offset:16384
    ds_read_b128 v[36:39], v253 offset:16384
    ds_read_b128 v[40:43], v254 offset:16384
    ds_read_b128 v[44:47], v255 offset:16384
    s_waitcnt lgkmcnt(4)
    v_dot2c_f32_bf16 v226, s89, v16
    v_dot2c_f32_bf16 v227, v16, v16
    v_dot2c_f32_bf16 v228, s89, v17
    v_dot2c_f32_bf16 v229, v17, v17
    v_dot2c_f32_bf16 v226, s89, v18
    v_dot2c_f32_bf16 v227, v18, v18
    v_dot2c_f32_bf16 v228, s89, v19
    v_dot2c_f32_bf16 v229, v19, v19
    v_dot2c_f32_bf16 v226, s89, v20
    v_dot2c_f32_bf16 v227, v20, v20
    v_dot2c_f32_bf16 v228, s89, v21
    v_dot2c_f32_bf16 v229, v21, v21
    v_dot2c_f32_bf16 v226, s89, v22
    v_dot2c_f32_bf16 v227, v22, v22
    v_dot2c_f32_bf16 v228, s89, v23
    v_dot2c_f32_bf16 v229, v23, v23
    v_dot2c_f32_bf16 v226, s89, v24
    v_dot2c_f32_bf16 v227, v24, v24
    v_dot2c_f32_bf16 v228, s89, v25
    v_dot2c_f32_bf16 v229, v25, v25
    v_dot2c_f32_bf16 v226, s89, v26
    v_dot2c_f32_bf16 v227, v26, v26
    v_dot2c_f32_bf16 v228, s89, v27
    v_dot2c_f32_bf16 v229, v27, v27
    v_dot2c_f32_bf16 v226, s89, v28
    v_dot2c_f32_bf16 v227, v28, v28
    v_dot2c_f32_bf16 v228, s89, v29
    v_dot2c_f32_bf16 v229, v29, v29
    v_dot2c_f32_bf16 v226, s89, v30
    v_dot2c_f32_bf16 v227, v30, v30
    v_dot2c_f32_bf16 v228, s89, v31
    v_dot2c_f32_bf16 v229, v31, v31
    s_waitcnt vmcnt(4)
    ds_read_b128 v[48:51], v252 offset:32768
    ds_read_b128 v[52:55], v253 offset:32768
    ds_read_b128 v[56:59], v254 offset:32768
    ds_read_b128 v[60:63], v255 offset:32768
    s_waitcnt lgkmcnt(4)
    v_dot2c_f32_bf16 v226, s89, v32
    v_dot2c_f32_bf16 v227, v32, v32
    v_dot2c_f32_bf16 v228, s89, v33
    v_dot2c_f32_bf16 v229, v33, v33
    v_dot2c_f32_bf16 v226, s89, v34
    v_dot2c_f32_bf16 v227, v34, v34
    v_dot2c_f32_bf16 v228, s89, v35
    v_dot2c_f32_bf16 v229, v35, v35
    v_dot2c_f32_bf16 v226, s89, v36
    v_dot2c_f32_bf16 v227, v36, v36
    v_dot2c_f32_bf16 v228, s89, v37
    v_dot2c_f32_bf16 v229, v37, v37
    v_dot2c_f32_bf16 v226, s89, v38
    v_dot2c_f32_bf16 v227, v38, v38
    v_dot2c_f32_bf16 v228, s89, v39
    v_dot2c_f32_bf16 v229, v39, v39
    v_dot2c_f32_bf16 v226, s89, v40
    v_dot2c_f32_bf16 v227, v40, v40
    v_dot2c_f32_bf16 v228, s89, v41
    v_dot2c_f32_bf16 v229, v41, v41
    v_dot2c_f32_bf16 v226, s89, v42
    v_dot2c_f32_bf16 v227, v42, v42
    v_dot2c_f32_bf16 v228, s89, v43
    v_dot2c_f32_bf16 v229, v43, v43
    v_dot2c_f32_bf16 v226, s89, v44
    v_dot2c_f32_bf16 v227, v44, v44
    v_dot2c_f32_bf16 v228, s89, v45
    v_dot2c_f32_bf16 v229, v45, v45
    v_dot2c_f32_bf16 v226, s89, v46
    v_dot2c_f32_bf16 v227, v46, v46
    v_dot2c_f32_bf16 v228, s89, v47
    v_dot2c_f32_bf16 v229, v47, v47
    s_waitcnt vmcnt(0)
    ds_read_b128 v[64:67], v252 offset:49152
    ds_read_b128 v[68:71], v253 offset:49152
    ds_read_b128 v[72:75], v254 offset:49152
    ds_read_b128 v[76:79], v255 offset:49152
    s_waitcnt lgkmcnt(4)
    v_dot2c_f32_bf16 v226, s89, v48
    v_dot2c_f32_bf16 v227, v48, v48
    v_dot2c_f32_bf16 v228, s89, v49
    v_dot2c_f32_bf16 v229, v49, v49
    v_dot2c_f32_bf16 v226, s89, v50
    v_dot2c_f32_bf16 v227, v50, v50
    v_dot2c_f32_bf16 v228, s89, v51
    v_dot2c_f32_bf16 v229, v51, v51
    v_dot2c_f32_bf16 v226, s89, v52
    v_dot2c_f32_bf16 v227, v52, v52
    v_dot2c_f32_bf16 v228, s89, v53
    v_dot2c_f32_bf16 v229, v53, v53
    v_dot2c_f32_bf16 v226, s89, v54
    v_dot2c_f32_bf16 v227, v54, v54
    v_dot2c_f32_bf16 v228, s89, v55
    v_dot2c_f32_bf16 v229, v55, v55
    v_dot2c_f32_bf16 v226, s89, v56
    v_dot2c_f32_bf16 v227, v56, v56
    v_dot2c_f32_bf16 v228, s89, v57
    v_dot2c_f32_bf16 v229, v57, v57
    v_dot2c_f32_bf16 v226, s89, v58
    v_dot2c_f32_bf16 v227, v58, v58
    v_dot2c_f32_bf16 v228, s89, v59
    v_dot2c_f32_bf16 v229, v59, v59
    v_dot2c_f32_bf16 v226, s89, v60
    v_dot2c_f32_bf16 v227, v60, v60
    v_dot2c_f32_bf16 v228, s89, v61
    v_dot2c_f32_bf16 v229, v61, v61
    v_dot2c_f32_bf16 v226, s89, v62
    v_dot2c_f32_bf16 v227, v62, v62
    v_dot2c_f32_bf16 v228, s89, v63
    v_dot2c_f32_bf16 v229, v63, v63
    s_waitcnt lgkmcnt(0)
    v_dot2c_f32_bf16 v226, s89, v64
    v_dot2c_f32_bf16 v227, v64, v64
    v_dot2c_f32_bf16 v228, s89, v65
    v_dot2c_f32_bf16 v229, v65, v65
    v_dot2c_f32_bf16 v226, s89, v66
    v_dot2c_f32_bf16 v227, v66, v66
    v_dot2c_f32_bf16 v228, s89, v67
    v_dot2c_f32_bf16 v229, v67, v67
    v_dot2c_f32_bf16 v226, s89, v68
    v_dot2c_f32_bf16 v227, v68, v68
    v_dot2c_f32_bf16 v228, s89, v69
    v_dot2c_f32_bf16 v229, v69, v69
    v_dot2c_f32_bf16 v226, s89, v70
    v_dot2c_f32_bf16 v227, v70, v70
    v_dot2c_f32_bf16 v228, s89, v71
    v_dot2c_f32_bf16 v229, v71, v71
    v_dot2c_f32_bf16 v226, s89, v72
    v_dot2c_f32_bf16 v227, v72, v72
    v_dot2c_f32_bf16 v228, s89, v73
    v_dot2c_f32_bf16 v229, v73, v73
    v_dot2c_f32_bf16 v226, s89, v74
    v_dot2c_f32_bf16 v227, v74, v74
    v_dot2c_f32_bf16 v228, s89, v75
    v_dot2c_f32_bf16 v229, v75, v75
    v_dot2c_f32_bf16 v226, s89, v76
    v_dot2c_f32_bf16 v227, v76, v76
    v_dot2c_f32_bf16 v228, s89, v77
    v_dot2c_f32_bf16 v229, v77, v77
    v_dot2c_f32_bf16 v226, s89, v78
    v_dot2c_f32_bf16 v227, v78, v78
    v_dot2c_f32_bf16 v228, s89, v79
    v_dot2c_f32_bf16 v229, v79, v79
    s_nop 1
    v_add_f32 v226, v226, v228
    v_add_f32 v227, v227, v229
    ds_write_b64 v234, v[226:227]
    s_add_u32 s74, s56, 0
    s_sub_u32 s75, s74, 7
    s_cmp_lt_u32 s74, 7
    s_cselect_b32 s74, s74, s75
    s_add_u32 m0, s70, 114688
    s_mul_i32 s74, s74, s88
    s_add_u32 s75, s74, s52
    buffer_load_dwordx4 v236, s[76:79], s74 offen lds
    buffer_load_dwordx4 v236, s[76:79], s75 offen offset:1024 lds
    s_add_u32 m0, s70, 116736
    s_nop 0
    buffer_load_dwordx4 v237, s[80:83], s74 offen lds
    buffer_load_dwordx4 v237, s[80:83], s75 offen offset:1024 lds
    s_add_u32 s74, s56, 0
    s_sub_u32 s75, s74, 7
    s_cmp_lt_u32 s74, 7
    s_cselect_b32 s74, s74, s75
    s_add_u32 m0, s70, 147456
    s_mul_i32 s74, s74, 172032
    s_add_u32 s75, s74, 896
    buffer_load_dwordx4 v238, s[36:39], s74 offen lds
    s_add_u32 m0, s70, 148480
    s_nop 0
    buffer_load_dwordx4 v238, s[36:39], s75 offen lds
    s_add_u32 s74, s56, 1
    s_sub_u32 s75, s74, 7
    s_cmp_lt_u32 s74, 7
    s_cselect_b32 s74, s74, s75
    s_add_u32 m0, s70, 131072
    s_mul_i32 s74, s74, s88
    s_add_u32 s75, s74, s52
    buffer_load_dwordx4 v236, s[76:79], s74 offen lds
    buffer_load_dwordx4 v236, s[76:79], s75 offen offset:1024 lds
    s_add_u32 m0, s70, 133120
    s_nop 0
    buffer_load_dwordx4 v237, s[80:83], s74 offen lds
    buffer_load_dwordx4 v237, s[80:83], s75 offen offset:1024 lds
    s_waitcnt lgkmcnt(0)
    s_barrier
    ds_read_b64 v[228:229], v235
    v_add_u32 v252, 65536, v252
    v_add_u32 v253, 65536, v253
    v_add_u32 v254, 65536, v254
    v_add_u32 v255, 65536, v255
    ds_read_b128 v[80:83], v252 offset:0
    ds_read_b128 v[84:87], v253 offset:0
    ds_read_b128 v[88:91], v254 offset:0
    ds_read_b128 v[92:95], v255 offset:0
    ds_read_b128 v[96:99], v252 offset:16384
    ds_read_b128 v[100:103], v253 offset:16384
    ds_read_b128 v[104:107], v254 offset:16384
    ds_read_b128 v[108:111], v255 offset:16384
    ds_read_b128 v[112:115], v252 offset:32768
    ds_read_b128 v[116:119], v253 offset:32768
    ds_read_b128 v[120:123], v254 offset:32768
    ds_read_b128 v[124:127], v255 offset:32768
    s_waitcnt lgkmcnt(12)
    v_add_f32 v226, v226, v228
    v_add_f32 v227, v227, v229
    v_mov_b32 v228, v226
    v_mov_b32 v229, v227
    s_mov_b32 s58, 0xbb124925
    v_mov_b32 v230, 0x3727c5ac
    v_permlane32_swap_b32 v226, v228
    v_permlane32_swap_b32 v227, v229
    v_add_f32 v226, v226, v228
    v_add_f32 v227, v227, v229
    v_mul_f32 v9, s58, v226
    v_fma_f32 v227, -v227, s58, v230
    v_fma_f32 v227, -v9, v9, v227
    v_max_f32 v10, v227, v230
    v_dot2_f32_bf16 v192, v16, s91, v9
    v_dot2_f32_bf16 v193, v16, s94, v9
    v_dot2_f32_bf16 v194, v17, s91, v9
    v_dot2_f32_bf16 v195, v17, s94, v9
    v_dot2_f32_bf16 v196, v18, s91, v9
    v_dot2_f32_bf16 v197, v18, s94, v9
    v_dot2_f32_bf16 v198, v19, s91, v9
    v_dot2_f32_bf16 v199, v19, s94, v9
    v_dot2_f32_bf16 v200, v20, s91, v9
    v_dot2_f32_bf16 v201, v20, s94, v9
    v_dot2_f32_bf16 v202, v21, s91, v9
    v_dot2_f32_bf16 v203, v21, s94, v9
    v_dot2_f32_bf16 v204, v22, s91, v9
    v_dot2_f32_bf16 v205, v22, s94, v9
    v_dot2_f32_bf16 v206, v23, s91, v9
    v_dot2_f32_bf16 v207, v23, s94, v9
    s_nop 0
    v_cvt_pk_bf16_f32 v16, v192, v193
    v_cvt_pk_bf16_f32 v17, v194, v195
    v_cvt_pk_bf16_f32 v18, v196, v197
    v_cvt_pk_bf16_f32 v19, v198, v199
    v_cvt_pk_bf16_f32 v20, v200, v201
    v_cvt_pk_bf16_f32 v21, v202, v203
    v_cvt_pk_bf16_f32 v22, v204, v205
    v_cvt_pk_bf16_f32 v23, v206, v207
    v_dot2_f32_bf16 v192, v24, s91, v9
    v_dot2_f32_bf16 v193, v24, s94, v9
    v_dot2_f32_bf16 v194, v25, s91, v9
    v_dot2_f32_bf16 v195, v25, s94, v9
    v_dot2_f32_bf16 v196, v26, s91, v9
    v_dot2_f32_bf16 v197, v26, s94, v9
    v_dot2_f32_bf16 v198, v27, s91, v9
    v_dot2_f32_bf16 v199, v27, s94, v9
    v_dot2_f32_bf16 v200, v28, s91, v9
    v_dot2_f32_bf16 v201, v28, s94, v9
    v_dot2_f32_bf16 v202, v29, s91, v9
    v_dot2_f32_bf16 v203, v29, s94, v9
    v_dot2_f32_bf16 v204, v30, s91, v9
    v_dot2_f32_bf16 v205, v30, s94, v9
    v_dot2_f32_bf16 v206, v31, s91, v9
    v_dot2_f32_bf16 v207, v31, s94, v9
    s_nop 0
    v_cvt_pk_bf16_f32 v24, v192, v193
    v_cvt_pk_bf16_f32 v25, v194, v195
    v_cvt_pk_bf16_f32 v26, v196, v197
    v_cvt_pk_bf16_f32 v27, v198, v199
    v_cvt_pk_bf16_f32 v28, v200, v201
    v_cvt_pk_bf16_f32 v29, v202, v203
    v_cvt_pk_bf16_f32 v30, v204, v205
    v_cvt_pk_bf16_f32 v31, v206, v207
    s_waitcnt lgkmcnt(0)
    s_barrier
    v_dot2_f32_bf16 v192, v32, s91, v9
    v_dot2_f32_bf16 v193, v32, s94, v9
    v_dot2_f32_bf16 v194, v33, s91, v9
    v_dot2_f32_bf16 v195, v33, s94, v9
    v_dot2_f32_bf16 v196, v34, s91, v9
    v_dot2_f32_bf16 v197, v34, s94, v9
    v_dot2_f32_bf16 v198, v35, s91, v9
    v_dot2_f32_bf16 v199, v35, s94, v9
    v_dot2_f32_bf16 v200, v36, s91, v9
    v_dot2_f32_bf16 v201, v36, s94, v9
    v_dot2_f32_bf16 v202, v37, s91, v9
    v_dot2_f32_bf16 v203, v37, s94, v9
    v_dot2_f32_bf16 v204, v38, s91, v9
    v_dot2_f32_bf16 v205, v38, s94, v9
    v_dot2_f32_bf16 v206, v39, s91, v9
    v_dot2_f32_bf16 v207, v39, s94, v9
    s_nop 0
    v_cvt_pk_bf16_f32 v32, v192, v193
    v_cvt_pk_bf16_f32 v33, v194, v195
    v_cvt_pk_bf16_f32 v34, v196, v197
    v_cvt_pk_bf16_f32 v35, v198, v199
    v_cvt_pk_bf16_f32 v36, v200, v201
    v_cvt_pk_bf16_f32 v37, v202, v203
    v_cvt_pk_bf16_f32 v38, v204, v205
    v_cvt_pk_bf16_f32 v39, v206, v207
    v_dot2_f32_bf16 v192, v40, s91, v9
    v_dot2_f32_bf16 v193, v40, s94, v9
    v_dot2_f32_bf16 v194, v41, s91, v9
    v_dot2_f32_bf16 v195, v41, s94, v9
    v_dot2_f32_bf16 v196, v42, s91, v9
    v_dot2_f32_bf16 v197, v42, s94, v9
    v_dot2_f32_bf16 v198, v43, s91, v9
    v_dot2_f32_bf16 v199, v43, s94, v9
    v_dot2_f32_bf16 v200, v44, s91, v9
    v_dot2_f32_bf16 v201, v44, s94, v9
    v_dot2_f32_bf16 v202, v45, s91, v9
    v_dot2_f32_bf16 v203, v45, s94, v9
    v_dot2_f32_bf16 v204, v46, s91, v9
    v_dot2_f32_bf16 v205, v46, s94, v9
    v_dot2_f32_bf16 v206, v47, s91, v9
    v_dot2_f32_bf16 v207, v47, s94, v9
    s_nop 0
    v_cvt_pk_bf16_f32 v40, v192, v193
    v_cvt_pk_bf16_f32 v41, v194, v195
    v_cvt_pk_bf16_f32 v42, v196, v197
    v_cvt_pk_bf16_f32 v43, v198, v199
    v_cvt_pk_bf16_f32 v44, v200, v201
    v_cvt_pk_bf16_f32 v45, v202, v203
    v_cvt_pk_bf16_f32 v46, v204, v205
    v_cvt_pk_bf16_f32 v47, v206, v207
    s_mov_b32 s28, s16
    s_mov_b32 s29, s17
    s_mov_b32 s30, 1605632
    s_mov_b32 s31, 0x00020000
    s_mov_b32 s32, s8
    s_mov_b32 s33, s9
    s_mov_b32 s34, 401408
    s_mov_b32 s35, 0x00020000
    s_lshl_b32 s57, s2, 2
    s_add_u32 s57, s57, s48
    s_mul_i32 s74, s57, 1792
    s_mul_i32 s75, s57, 512
    v_lshlrev_b32 v11, 7, v2
    s_waitcnt lgkmcnt(0)
    s_setprio 1
    s_cmp_eq_u32 s60, 1
    s_cbranch_scc1 L1_AP1y
    s_waitcnt vmcnt(4)
    s_barrier
    v_add_u32 v3, 114688, v3
    v_add_u32 v4, 114688, v4
    v_add_u32 v5, 114688, v5
    v_add_u32 v6, 114688, v6
    ds_read_b64_tr_b16 v[128:129], v3 offset:0
    ds_read_b64_tr_b16 v[130:131], v3 offset:512
    ds_read_b64_tr_b16 v[132:133], v4 offset:0
    ds_read_b64_tr_b16 v[134:135], v4 offset:512
    ds_read_b64_tr_b16 v[136:137], v5 offset:0
    ds_read_b64_tr_b16 v[138:139], v5 offset:512
    ds_read_b64_tr_b16 v[140:141], v6 offset:0
    ds_read_b64_tr_b16 v[142:143], v6 offset:512
    v_add_u32 v7, 147456, v7
    ds_read_b64_tr_b16 v[144:145], v7 offset:0
    ds_read_b64_tr_b16 v[146:147], v7 offset:256
    s_waitcnt lgkmcnt(6)
    v_mfma_f32_32x32x16_bf16 v[160:175], v[128:131], v[16:19], 0
    ds_read_b64_tr_b16 v[148:149], v7 offset:1024
    ds_read_b64_tr_b16 v[150:151], v7 offset:1280
    v_lshlrev_b32 v152, 16, v48
    v_and_b32 v153, s90, v48
    v_lshlrev_b32 v154, 16, v49
    v_mfma_f32_32x32x16_bf16 v[176:191], v[132:135], v[16:19], 0
    ds_read_b64_tr_b16 v[128:129], v3 offset:4096
    ds_read_b64_tr_b16 v[130:131], v3 offset:4608
    v_and_b32 v155, s90, v49
    v_lshlrev_b32 v156, 16, v50
    s_waitcnt lgkmcnt(6)
    v_mfma_f32_32x32x16_bf16 v[192:207], v[136:139], v[16:19], 0
    ds_read_b64_tr_b16 v[132:133], v4 offset:4096
    ds_read_b64_tr_b16 v[134:135], v4 offset:4608
    v_and_b32 v157, s90, v50
    v_lshlrev_b32 v158, 16, v51
    v_and_b32 v159, s90, v51
    v_mfma_f32_32x32x16_bf16 v[208:223], v[140:143], v[16:19], 0
    ds_read_b64_tr_b16 v[136:137], v5 offset:4096
    ds_read_b64_tr_b16 v[138:139], v5 offset:4608
    v_add_f32 v152, v152, v9
    v_add_f32 v153, v153, v9
    s_waitcnt lgkmcnt(6)
    v_mfma_f32_32x32x16_bf16 v[224:239], v[144:147], v[16:19], 0
    ds_read_b64_tr_b16 v[140:141], v6 offset:4096
    ds_read_b64_tr_b16 v[142:143], v6 offset:4608
    v_add_f32 v154, v154, v9
    v_add_f32 v155, v155, v9
    v_add_f32 v156, v156, v9
    v_mfma_f32_32x32x16_bf16 v[240:255], v[148:151], v[16:19], 0
    ds_read_b64_tr_b16 v[144:145], v7 offset:4096
    ds_read_b64_tr_b16 v[146:147], v7 offset:4352
    v_add_f32 v157, v157, v9
    v_add_f32 v158, v158, v9
    s_waitcnt lgkmcnt(6)
    v_mfma_f32_32x32x16_bf16 v[160:175], v[128:131], v[20:23], v[160:175]
    ds_read_b64_tr_b16 v[148:149], v7 offset:5120
    ds_read_b64_tr_b16 v[150:151], v7 offset:5376
    v_add_f32 v159, v159, v9
    v_cvt_pk_bf16_f32 v48, v152, v153
    v_cvt_pk_bf16_f32 v49, v154, v155
    v_mfma_f32_32x32x16_bf16 v[176:191], v[132:135], v[20:23], v[176:191]
    ds_read_b64_tr_b16 v[128:129], v3 offset:8192
    ds_read_b64_tr_b16 v[130:131], v3 offset:8704
    v_cvt_pk_bf16_f32 v50, v156, v157
    v_cvt_pk_bf16_f32 v51, v158, v159
    s_waitcnt lgkmcnt(6)
    v_mfma_f32_32x32x16_bf16 v[192:207], v[136:139], v[20:23], v[192:207]
    ds_read_b64_tr_b16 v[132:133], v4 offset:8192
    ds_read_b64_tr_b16 v[134:135], v4 offset:8704
    v_lshlrev_b32 v152, 16, v52
    v_and_b32 v153, s90, v52
    v_lshlrev_b32 v154, 16, v53
    v_mfma_f32_32x32x16_bf16 v[208:223], v[140:143], v[20:23], v[208:223]
    ds_read_b64_tr_b16 v[136:137], v5 offset:8192
    ds_read_b64_tr_b16 v[138:139], v5 offset:8704
    v_and_b32 v155, s90, v53
    v_lshlrev_b32 v156, 16, v54
    s_waitcnt lgkmcnt(6)
    v_mfma_f32_32x32x16_bf16 v[224:239], v[144:147], v[20:23], v[224:239]
    ds_read_b64_tr_b16 v[140:141], v6 offset:8192
    ds_read_b64_tr_b16 v[142:143], v6 offset:8704
    v_and_b32 v157, s90, v54
    v_lshlrev_b32 v158, 16, v55
    v_and_b32 v159, s90, v55
    v_mfma_f32_32x32x16_bf16 v[240:255], v[148:151], v[20:23], v[240:255]
    ds_read_b64_tr_b16 v[144:145], v7 offset:8192
    ds_read_b64_tr_b16 v[146:147], v7 offset:8448
    v_add_f32 v152, v152, v9
    v_add_f32 v153, v153, v9
    s_waitcnt lgkmcnt(6)
    v_mfma_f32_32x32x16_bf16 v[160:175], v[128:131], v[24:27], v[160:175]
    ds_read_b64_tr_b16 v[148:149], v7 offset:9216
    ds_read_b64_tr_b16 v[150:151], v7 offset:9472
    v_add_f32 v154, v154, v9
    v_add_f32 v155, v155, v9
    v_add_f32 v156, v156, v9
    v_mfma_f32_32x32x16_bf16 v[176:191], v[132:135], v[24:27], v[176:191]
    ds_read_b64_tr_b16 v[128:129], v3 offset:12288
    ds_read_b64_tr_b16 v[130:131], v3 offset:12800
    v_add_f32 v157, v157, v9
    v_add_f32 v158, v158, v9
    s_waitcnt lgkmcnt(6)
    v_mfma_f32_32x32x16_bf16 v[192:207], v[136:139], v[24:27], v[192:207]
    ds_read_b64_tr_b16 v[132:133], v4 offset:12288
    ds_read_b64_tr_b16 v[134:135], v4 offset:12800
    v_add_f32 v159, v159, v9
    v_cvt_pk_bf16_f32 v52, v152, v153
    v_cvt_pk_bf16_f32 v53, v154, v155
    v_mfma_f32_32x32x16_bf16 v[208:223], v[140:143], v[24:27], v[208:223]
    ds_read_b64_tr_b16 v[136:137], v5 offset:12288
    ds_read_b64_tr_b16 v[138:139], v5 offset:12800
    v_cvt_pk_bf16_f32 v54, v156, v157
    v_cvt_pk_bf16_f32 v55, v158, v159
    s_waitcnt lgkmcnt(6)
    v_mfma_f32_32x32x16_bf16 v[224:239], v[144:147], v[24:27], v[224:239]
    ds_read_b64_tr_b16 v[140:141], v6 offset:12288
    ds_read_b64_tr_b16 v[142:143], v6 offset:12800
    v_lshlrev_b32 v152, 16, v56
    v_and_b32 v153, s90, v56
    v_lshlrev_b32 v154, 16, v57
    v_mfma_f32_32x32x16_bf16 v[240:255], v[148:151], v[24:27], v[240:255]
    ds_read_b64_tr_b16 v[144:145], v7 offset:12288
    ds_read_b64_tr_b16 v[146:147], v7 offset:12544
    v_and_b32 v155, s90, v57
    v_lshlrev_b32 v156, 16, v58
    s_waitcnt lgkmcnt(6)
    v_mfma_f32_32x32x16_bf16 v[160:175], v[128:131], v[28:31], v[160:175]
    ds_read_b64_tr_b16 v[148:149], v7 offset:13312
    ds_read_b64_tr_b16 v[150:151], v7 offset:13568
    v_and_b32 v157, s90, v58
    v_lshlrev_b32 v158, 16, v59
    v_and_b32 v159, s90, v59
    v_mfma_f32_32x32x16_bf16 v[176:191], v[132:135], v[28:31], v[176:191]
    s_waitcnt vmcnt(0)
    s_barrier
    ds_read_b64_tr_b16 v[128:129], v3 offset:16384
    ds_read_b64_tr_b16 v[130:131], v3 offset:16896
    v_add_f32 v152, v152, v9
    v_add_f32 v153, v153, v9
    s_waitcnt lgkmcnt(6)
    v_mfma_f32_32x32x16_bf16 v[192:207], v[136:139], v[28:31], v[192:207]
    ds_read_b64_tr_b16 v[132:133], v4 offset:16384
    ds_read_b64_tr_b16 v[134:135], v4 offset:16896
    v_add_f32 v154, v154, v9
    v_add_f32 v155, v155, v9
    v_add_f32 v156, v156, v9
    v_mfma_f32_32x32x16_bf16 v[208:223], v[140:143], v[28:31], v[208:223]
    ds_read_b64_tr_b16 v[136:137], v5 offset:16384
    ds_read_b64_tr_b16 v[138:139], v5 offset:16896
    v_add_f32 v157, v157, v9
    v_add_f32 v158, v158, v9
    s_waitcnt lgkmcnt(6)
    v_mfma_f32_32x32x16_bf16 v[224:239], v[144:147], v[28:31], v[224:239]
    ds_read_b64_tr_b16 v[140:141], v6 offset:16384
    ds_read_b64_tr_b16 v[142:143], v6 offset:16896
    v_add_f32 v159, v159, v9
    v_cvt_pk_bf16_f32 v56, v152, v153
    v_cvt_pk_bf16_f32 v57, v154, v155
    v_mfma_f32_32x32x16_bf16 v[240:255], v[148:151], v[28:31], v[240:255]
    ds_read_b64_tr_b16 v[144:145], v7 offset:2048
    ds_read_b64_tr_b16 v[146:147], v7 offset:2304
    v_cvt_pk_bf16_f32 v58, v156, v157
    v_cvt_pk_bf16_f32 v59, v158, v159
    s_waitcnt lgkmcnt(6)
    v_mfma_f32_32x32x16_bf16 v[160:175], v[128:131], v[32:35], v[160:175]
    ds_read_b64_tr_b16 v[148:149], v7 offset:3072
    ds_read_b64_tr_b16 v[150:151], v7 offset:3328
    v_lshlrev_b32 v152, 16, v60
    v_and_b32 v153, s90, v60
    v_lshlrev_b32 v154, 16, v61
    v_mfma_f32_32x32x16_bf16 v[176:191], v[132:135], v[32:35], v[176:191]
    ds_read_b64_tr_b16 v[128:129], v3 offset:20480
    ds_read_b64_tr_b16 v[130:131], v3 offset:20992
    v_and_b32 v155, s90, v61
    v_lshlrev_b32 v156, 16, v62
    s_waitcnt lgkmcnt(6)
    v_mfma_f32_32x32x16_bf16 v[192:207], v[136:139], v[32:35], v[192:207]
    ds_read_b64_tr_b16 v[132:133], v4 offset:20480
    ds_read_b64_tr_b16 v[134:135], v4 offset:20992
    v_and_b32 v157, s90, v62
    v_lshlrev_b32 v158, 16, v63
    v_and_b32 v159, s90, v63
    v_mfma_f32_32x32x16_bf16 v[208:223], v[140:143], v[32:35], v[208:223]
    ds_read_b64_tr_b16 v[136:137], v5 offset:20480
    ds_read_b64_tr_b16 v[138:139], v5 offset:20992
    v_add_f32 v152, v152, v9
    v_add_f32 v153, v153, v9
    s_waitcnt lgkmcnt(6)
    v_mfma_f32_32x32x16_bf16 v[224:239], v[144:147], v[32:35], v[224:239]
    ds_read_b64_tr_b16 v[140:141], v6 offset:20480
    ds_read_b64_tr_b16 v[142:143], v6 offset:20992
    v_add_f32 v154, v154, v9
    v_add_f32 v155, v155, v9
    v_add_f32 v156, v156, v9
    v_mfma_f32_32x32x16_bf16 v[240:255], v[148:151], v[32:35], v[240:255]
    ds_read_b64_tr_b16 v[144:145], v7 offset:6144
    ds_read_b64_tr_b16 v[146:147], v7 offset:6400
    v_add_f32 v157, v157, v9
    v_add_f32 v158, v158, v9
    s_waitcnt lgkmcnt(6)
    v_mfma_f32_32x32x16_bf16 v[160:175], v[128:131], v[36:39], v[160:175]
    ds_read_b64_tr_b16 v[148:149], v7 offset:7168
    ds_read_b64_tr_b16 v[150:151], v7 offset:7424
    v_add_f32 v159, v159, v9
    v_cvt_pk_bf16_f32 v60, v152, v153
    v_cvt_pk_bf16_f32 v61, v154, v155
    v_mfma_f32_32x32x16_bf16 v[176:191], v[132:135], v[36:39], v[176:191]
    ds_read_b64_tr_b16 v[128:129], v3 offset:24576
    ds_read_b64_tr_b16 v[130:131], v3 offset:25088
    v_cvt_pk_bf16_f32 v62, v156, v157
    v_cvt_pk_bf16_f32 v63, v158, v159
    s_waitcnt lgkmcnt(6)
    v_mfma_f32_32x32x16_bf16 v[192:207], v[136:139], v[36:39], v[192:207]
    ds_read_b64_tr_b16 v[132:133], v4 offset:24576
    ds_read_b64_tr_b16 v[134:135], v4 offset:25088
    v_lshlrev_b32 v152, 16, v64
    v_and_b32 v153, s90, v64
    v_mfma_f32_32x32x16_bf16 v[208:223], v[140:143], v[36:39], v[208:223]
    ds_read_b64_tr_b16 v[136:137], v5 offset:24576
    ds_read_b64_tr_b16 v[138:139], v5 offset:25088
    v_lshlrev_b32 v154, 16, v65
    v_and_b32 v155, s90, v65
    v_lshlrev_b32 v156, 16, v66
    s_waitcnt lgkmcnt(6)
    v_mfma_f32_32x32x16_bf16 v[224:239], v[144:147], v[36:39], v[224:239]
    ds_read_b64_tr_b16 v[140:141], v6 offset:24576
    ds_read_b64_tr_b16 v[142:143], v6 offset:25088
    v_and_b32 v157, s90, v66
    v_lshlrev_b32 v158, 16, v67
    v_mfma_f32_32x32x16_bf16 v[240:255], v[148:151], v[36:39], v[240:255]
    ds_read_b64_tr_b16 v[144:145], v7 offset:10240
    ds_read_b64_tr_b16 v[146:147], v7 offset:10496
    v_and_b32 v159, s90, v67
    v_add_f32 v152, v152, v9
    v_add_f32 v153, v153, v9
    s_waitcnt lgkmcnt(6)
    v_mfma_f32_32x32x16_bf16 v[160:175], v[128:131], v[40:43], v[160:175]
    ds_read_b64_tr_b16 v[148:149], v7 offset:11264
    ds_read_b64_tr_b16 v[150:151], v7 offset:11520
    v_add_f32 v154, v154, v9
    v_add_f32 v155, v155, v9
    v_mfma_f32_32x32x16_bf16 v[176:191], v[132:135], v[40:43], v[176:191]
    ds_read_b64_tr_b16 v[128:129], v3 offset:28672
    ds_read_b64_tr_b16 v[130:131], v3 offset:29184
    v_add_f32 v156, v156, v9
    v_add_f32 v157, v157, v9
    v_add_f32 v158, v158, v9
    s_waitcnt lgkmcnt(6)
    v_mfma_f32_32x32x16_bf16 v[192:207], v[136:139], v[40:43], v[192:207]
    ds_read_b64_tr_b16 v[132:133], v4 offset:28672
    ds_read_b64_tr_b16 v[134:135], v4 offset:29184
    v_add_f32 v159, v159, v9
    v_cvt_pk_bf16_f32 v64, v152, v153
    v_mfma_f32_32x32x16_bf16 v[208:223], v[140:143], v[40:43], v[208:223]
    ds_read_b64_tr_b16 v[136:137], v5 offset:28672
    ds_read_b64_tr_b16 v[138:139], v5 offset:29184
    v_cvt_pk_bf16_f32 v65, v154, v155
    v_cvt_pk_bf16_f32 v66, v156, v157
    v_cvt_pk_bf16_f32 v67, v158, v159
    s_waitcnt lgkmcnt(6)
    v_mfma_f32_32x32x16_bf16 v[224:239], v[144:147], v[40:43], v[224:239]
    ds_read_b64_tr_b16 v[140:141], v6 offset:28672
    ds_read_b64_tr_b16 v[142:143], v6 offset:29184
    v_lshlrev_b32 v152, 16, v68
    v_and_b32 v153, s90, v68
    v_mfma_f32_32x32x16_bf16 v[240:255], v[148:151], v[40:43], v[240:255]
    ds_read_b64_tr_b16 v[144:145], v7 offset:14336
    ds_read_b64_tr_b16 v[146:147], v7 offset:14592
    v_lshlrev_b32 v154, 16, v69
    v_and_b32 v155, s90, v69
    v_lshlrev_b32 v156, 16, v70
    s_waitcnt lgkmcnt(6)
    v_mfma_f32_32x32x16_bf16 v[160:175], v[128:131], v[44:47], v[160:175]
    ds_read_b64_tr_b16 v[148:149], v7 offset:15360
    ds_read_b64_tr_b16 v[150:151], v7 offset:15616
    v_and_b32 v157, s90, v70
    v_lshlrev_b32 v158, 16, v71
    v_mfma_f32_32x32x16_bf16 v[176:191], v[132:135], v[44:47], v[176:191]
    s_barrier
    v_subrev_u32 v3, 114688, v3
    v_subrev_u32 v4, 114688, v4
    v_subrev_u32 v5, 114688, v5
    v_subrev_u32 v6, 114688, v6
    ds_read_b64_tr_b16 v[128:129], v3 offset:0
    ds_read_b64_tr_b16 v[130:131], v3 offset:512
    v_and_b32 v159, s90, v71
    v_add_f32 v152, v152, v9
    v_add_f32 v153, v153, v9
    s_waitcnt lgkmcnt(6)
    v_mfma_f32_32x32x16_bf16 v[192:207], v[136:139], v[44:47], v[192:207]
    ds_read_b64_tr_b16 v[132:133], v4 offset:0
    ds_read_b64_tr_b16 v[134:135], v4 offset:512
    v_add_f32 v154, v154, v9
    v_add_f32 v155, v155, v9
    v_mfma_f32_32x32x16_bf16 v[208:223], v[140:143], v[44:47], v[208:223]
    ds_read_b64_tr_b16 v[136:137], v5 offset:0
    ds_read_b64_tr_b16 v[138:139], v5 offset:512
    v_add_f32 v156, v156, v9
    v_add_f32 v157, v157, v9
    v_add_f32 v158, v158, v9
    s_waitcnt lgkmcnt(6)
    v_mfma_f32_32x32x16_bf16 v[224:239], v[144:147], v[44:47], v[224:239]
    ds_read_b64_tr_b16 v[140:141], v6 offset:0
    ds_read_b64_tr_b16 v[142:143], v6 offset:512
    v_add_f32 v159, v159, v9
    v_cvt_pk_bf16_f32 v68, v152, v153
    v_mfma_f32_32x32x16_bf16 v[240:255], v[148:151], v[44:47], v[240:255]
    v_subrev_u32 v7, 131072, v7
    ds_read_b64_tr_b16 v[144:145], v7 offset:0
    ds_read_b64_tr_b16 v[146:147], v7 offset:256
    v_cvt_pk_bf16_f32 v69, v154, v155
    v_cvt_pk_bf16_f32 v70, v156, v157
    v_cvt_pk_bf16_f32 v71, v158, v159
    s_waitcnt lgkmcnt(6)
    v_mfma_f32_32x32x16_bf16 v[160:175], v[128:131], v[48:51], v[160:175]
    ds_read_b64_tr_b16 v[148:149], v7 offset:1024
    ds_read_b64_tr_b16 v[150:151], v7 offset:1280
    v_lshlrev_b32 v152, 16, v72
    v_and_b32 v153, s90, v72
    v_mfma_f32_32x32x16_bf16 v[176:191], v[132:135], v[48:51], v[176:191]
    ds_read_b64_tr_b16 v[128:129], v3 offset:4096
    ds_read_b64_tr_b16 v[130:131], v3 offset:4608
    v_lshlrev_b32 v154, 16, v73
    v_and_b32 v155, s90, v73
    v_lshlrev_b32 v156, 16, v74
    s_waitcnt lgkmcnt(6)
    v_mfma_f32_32x32x16_bf16 v[192:207], v[136:139], v[48:51], v[192:207]
    ds_read_b64_tr_b16 v[132:133], v4 offset:4096
    ds_read_b64_tr_b16 v[134:135], v4 offset:4608
    v_and_b32 v157, s90, v74
    v_lshlrev_b32 v158, 16, v75
    v_mfma_f32_32x32x16_bf16 v[208:223], v[140:143], v[48:51], v[208:223]
    ds_read_b64_tr_b16 v[136:137], v5 offset:4096
    ds_read_b64_tr_b16 v[138:139], v5 offset:4608
    v_and_b32 v159, s90, v75
    v_add_f32 v152, v152, v9
    v_add_f32 v153, v153, v9
    s_waitcnt lgkmcnt(6)
    v_mfma_f32_32x32x16_bf16 v[224:239], v[144:147], v[48:51], v[224:239]
    ds_read_b64_tr_b16 v[140:141], v6 offset:4096
    ds_read_b64_tr_b16 v[142:143], v6 offset:4608
    v_add_f32 v154, v154, v9
    v_add_f32 v155, v155, v9
    v_mfma_f32_32x32x16_bf16 v[240:255], v[148:151], v[48:51], v[240:255]
    ds_read_b64_tr_b16 v[144:145], v7 offset:4096
    ds_read_b64_tr_b16 v[146:147], v7 offset:4352
    v_add_f32 v156, v156, v9
    v_add_f32 v157, v157, v9
    v_add_f32 v158, v158, v9
    s_waitcnt lgkmcnt(6)
    v_mfma_f32_32x32x16_bf16 v[160:175], v[128:131], v[52:55], v[160:175]
    ds_read_b64_tr_b16 v[148:149], v7 offset:5120
    ds_read_b64_tr_b16 v[150:151], v7 offset:5376
    v_add_f32 v159, v159, v9
    v_cvt_pk_bf16_f32 v72, v152, v153
    v_mfma_f32_32x32x16_bf16 v[176:191], v[132:135], v[52:55], v[176:191]
    ds_read_b64_tr_b16 v[128:129], v3 offset:8192
    ds_read_b64_tr_b16 v[130:131], v3 offset:8704
    v_cvt_pk_bf16_f32 v73, v154, v155
    v_cvt_pk_bf16_f32 v74, v156, v157
    v_cvt_pk_bf16_f32 v75, v158, v159
    s_waitcnt lgkmcnt(6)
    v_mfma_f32_32x32x16_bf16 v[192:207], v[136:139], v[52:55], v[192:207]
    ds_read_b64_tr_b16 v[132:133], v4 offset:8192
    ds_read_b64_tr_b16 v[134:135], v4 offset:8704
    v_lshlrev_b32 v152, 16, v76
    v_and_b32 v153, s90, v76
    v_mfma_f32_32x32x16_bf16 v[208:223], v[140:143], v[52:55], v[208:223]
    ds_read_b64_tr_b16 v[136:137], v5 offset:8192
    ds_read_b64_tr_b16 v[138:139], v5 offset:8704
    v_lshlrev_b32 v154, 16, v77
    v_and_b32 v155, s90, v77
    v_lshlrev_b32 v156, 16, v78
    s_waitcnt lgkmcnt(6)
    v_mfma_f32_32x32x16_bf16 v[224:239], v[144:147], v[52:55], v[224:239]
    ds_read_b64_tr_b16 v[140:141], v6 offset:8192
    ds_read_b64_tr_b16 v[142:143], v6 offset:8704
    v_and_b32 v157, s90, v78
    v_lshlrev_b32 v158, 16, v79
    v_mfma_f32_32x32x16_bf16 v[240:255], v[148:151], v[52:55], v[240:255]
    ds_read_b64_tr_b16 v[144:145], v7 offset:8192
    ds_read_b64_tr_b16 v[146:147], v7 offset:8448
    s_mov_b64 exec, 0x3fff
    buffer_load_dword v12, v11, s[28:31], s74 offen
    s_mov_b64 exec, 0xf
    buffer_load_dword v12, v11, s[32:35], s75 offen
    s_mov_b64 exec, -1
    s_add_u32 s74, s74, 1792
    s_add_u32 s75, s75, 512
    v_and_b32 v159, s90, v79
    v_add_f32 v152, v152, v9
    v_add_f32 v153, v153, v9
    s_waitcnt lgkmcnt(6)
    v_mfma_f32_32x32x16_bf16 v[160:175], v[128:131], v[56:59], v[160:175]
    ds_read_b64_tr_b16 v[148:149], v7 offset:9216
    ds_read_b64_tr_b16 v[150:151], v7 offset:9472
    v_add_f32 v154, v154, v9
    v_add_f32 v155, v155, v9
    v_mfma_f32_32x32x16_bf16 v[176:191], v[132:135], v[56:59], v[176:191]
    ds_read_b64_tr_b16 v[128:129], v3 offset:12288
    ds_read_b64_tr_b16 v[130:131], v3 offset:12800
    v_add_f32 v156, v156, v9
    v_add_f32 v157, v157, v9
    v_add_f32 v158, v158, v9
    s_waitcnt lgkmcnt(6)
    v_mfma_f32_32x32x16_bf16 v[192:207], v[136:139], v[56:59], v[192:207]
    ds_read_b64_tr_b16 v[132:133], v4 offset:12288
    ds_read_b64_tr_b16 v[134:135], v4 offset:12800
    v_add_f32 v159, v159, v9
    v_cvt_pk_bf16_f32 v76, v152, v153
    v_mfma_f32_32x32x16_bf16 v[208:223], v[140:143], v[56:59], v[208:223]
    ds_read_b64_tr_b16 v[136:137], v5 offset:12288
    ds_read_b64_tr_b16 v[138:139], v5 offset:12800
    v_cvt_pk_bf16_f32 v77, v154, v155
    v_cvt_pk_bf16_f32 v78, v156, v157
    v_cvt_pk_bf16_f32 v79, v158, v159
    s_waitcnt lgkmcnt(6)
    v_mfma_f32_32x32x16_bf16 v[224:239], v[144:147], v[56:59], v[224:239]
    ds_read_b64_tr_b16 v[140:141], v6 offset:12288
    ds_read_b64_tr_b16 v[142:143], v6 offset:12800
    v_lshlrev_b32 v152, 16, v80
    v_and_b32 v153, s90, v80
    v_mfma_f32_32x32x16_bf16 v[240:255], v[148:151], v[56:59], v[240:255]
    ds_read_b64_tr_b16 v[144:145], v7 offset:12288
    ds_read_b64_tr_b16 v[146:147], v7 offset:12544
    v_lshlrev_b32 v154, 16, v81
    v_and_b32 v155, s90, v81
    s_waitcnt lgkmcnt(6)
    v_mfma_f32_32x32x16_bf16 v[160:175], v[128:131], v[60:63], v[160:175]
    ds_read_b64_tr_b16 v[148:149], v7 offset:13312
    ds_read_b64_tr_b16 v[150:151], v7 offset:13568
    v_lshlrev_b32 v156, 16, v82
    v_and_b32 v157, s90, v82
    v_lshlrev_b32 v158, 16, v83
    v_mfma_f32_32x32x16_bf16 v[176:191], v[132:135], v[60:63], v[176:191]
    s_barrier
    ds_read_b64_tr_b16 v[128:129], v3 offset:32768
    ds_read_b64_tr_b16 v[130:131], v3 offset:33280
    v_and_b32 v159, s90, v83
    v_add_f32 v152, v152, v9
    s_waitcnt lgkmcnt(6)
    v_mfma_f32_32x32x16_bf16 v[192:207], v[136:139], v[60:63], v[192:207]
    ds_read_b64_tr_b16 v[132:133], v4 offset:32768
    ds_read_b64_tr_b16 v[134:135], v4 offset:33280
    v_add_f32 v153, v153, v9
    v_add_f32 v154, v154, v9
    v_add_f32 v155, v155, v9
    v_mfma_f32_32x32x16_bf16 v[208:223], v[140:143], v[60:63], v[208:223]
    ds_read_b64_tr_b16 v[136:137], v5 offset:32768
    ds_read_b64_tr_b16 v[138:139], v5 offset:33280
    v_add_f32 v156, v156, v9
    v_add_f32 v157, v157, v9
    s_waitcnt lgkmcnt(6)
    v_mfma_f32_32x32x16_bf16 v[224:239], v[144:147], v[60:63], v[224:239]
    ds_read_b64_tr_b16 v[140:141], v6 offset:32768
    ds_read_b64_tr_b16 v[142:143], v6 offset:33280
    v_add_f32 v158, v158, v9
    v_add_f32 v159, v159, v9
    v_cvt_pk_bf16_f32 v80, v152, v153
    v_mfma_f32_32x32x16_bf16 v[240:255], v[148:151], v[60:63], v[240:255]
    ds_read_b64_tr_b16 v[144:145], v7 offset:2048
    ds_read_b64_tr_b16 v[146:147], v7 offset:2304
    v_cvt_pk_bf16_f32 v81, v154, v155
    v_cvt_pk_bf16_f32 v82, v156, v157
    s_waitcnt lgkmcnt(6)
    v_mfma_f32_32x32x16_bf16 v[160:175], v[128:131], v[64:67], v[160:175]
    ds_read_b64_tr_b16 v[148:149], v7 offset:3072
    ds_read_b64_tr_b16 v[150:151], v7 offset:3328
    v_cvt_pk_bf16_f32 v83, v158, v159
    v_lshlrev_b32 v152, 16, v84
    v_and_b32 v153, s90, v84
    v_mfma_f32_32x32x16_bf16 v[176:191], v[132:135], v[64:67], v[176:191]
    ds_read_b64_tr_b16 v[128:129], v3 offset:36864
    ds_read_b64_tr_b16 v[130:131], v3 offset:37376
    v_lshlrev_b32 v154, 16, v85
    v_and_b32 v155, s90, v85
    s_waitcnt lgkmcnt(6)
    v_mfma_f32_32x32x16_bf16 v[192:207], v[136:139], v[64:67], v[192:207]
    ds_read_b64_tr_b16 v[132:133], v4 offset:36864
    ds_read_b64_tr_b16 v[134:135], v4 offset:37376
    v_lshlrev_b32 v156, 16, v86
    v_and_b32 v157, s90, v86
    v_lshlrev_b32 v158, 16, v87
    v_mfma_f32_32x32x16_bf16 v[208:223], v[140:143], v[64:67], v[208:223]
    ds_read_b64_tr_b16 v[136:137], v5 offset:36864
    ds_read_b64_tr_b16 v[138:139], v5 offset:37376
    v_and_b32 v159, s90, v87
    v_add_f32 v152, v152, v9
    s_waitcnt lgkmcnt(6)
    v_mfma_f32_32x32x16_bf16 v[224:239], v[144:147], v[64:67], v[224:239]
    ds_read_b64_tr_b16 v[140:141], v6 offset:36864
    ds_read_b64_tr_b16 v[142:143], v6 offset:37376
    v_add_f32 v153, v153, v9
    v_add_f32 v154, v154, v9
    v_add_f32 v155, v155, v9
    v_mfma_f32_32x32x16_bf16 v[240:255], v[148:151], v[64:67], v[240:255]
    ds_read_b64_tr_b16 v[144:145], v7 offset:6144
    ds_read_b64_tr_b16 v[146:147], v7 offset:6400
    v_add_f32 v156, v156, v9
    v_add_f32 v157, v157, v9
    s_waitcnt lgkmcnt(6)
    v_mfma_f32_32x32x16_bf16 v[160:175], v[128:131], v[68:71], v[160:175]
    ds_read_b64_tr_b16 v[148:149], v7 offset:7168
    ds_read_b64_tr_b16 v[150:151], v7 offset:7424
    v_add_f32 v158, v158, v9
    v_add_f32 v159, v159, v9
    v_cvt_pk_bf16_f32 v84, v152, v153
    v_mfma_f32_32x32x16_bf16 v[176:191], v[132:135], v[68:71], v[176:191]
    ds_read_b64_tr_b16 v[128:129], v3 offset:40960
    ds_read_b64_tr_b16 v[130:131], v3 offset:41472
    v_cvt_pk_bf16_f32 v85, v154, v155
    v_cvt_pk_bf16_f32 v86, v156, v157
    s_waitcnt lgkmcnt(6)
    v_mfma_f32_32x32x16_bf16 v[192:207], v[136:139], v[68:71], v[192:207]
    ds_read_b64_tr_b16 v[132:133], v4 offset:40960
    ds_read_b64_tr_b16 v[134:135], v4 offset:41472
    v_cvt_pk_bf16_f32 v87, v158, v159
    v_lshlrev_b32 v152, 16, v88
    v_and_b32 v153, s90, v88
    v_mfma_f32_32x32x16_bf16 v[208:223], v[140:143], v[68:71], v[208:223]
    ds_read_b64_tr_b16 v[136:137], v5 offset:40960
    ds_read_b64_tr_b16 v[138:139], v5 offset:41472
    v_lshlrev_b32 v154, 16, v89
    v_and_b32 v155, s90, v89
    s_waitcnt lgkmcnt(6)
    v_mfma_f32_32x32x16_bf16 v[224:239], v[144:147], v[68:71], v[224:239]
    ds_read_b64_tr_b16 v[140:141], v6 offset:40960
    ds_read_b64_tr_b16 v[142:143], v6 offset:41472
    v_lshlrev_b32 v156, 16, v90
    v_and_b32 v157, s90, v90
    v_lshlrev_b32 v158, 16, v91
    v_mfma_f32_32x32x16_bf16 v[240:255], v[148:151], v[68:71], v[240:255]
    ds_read_b64_tr_b16 v[144:145], v7 offset:10240
    ds_read_b64_tr_b16 v[146:147], v7 offset:10496
    v_and_b32 v159, s90, v91
    v_add_f32 v152, v152, v9
    s_waitcnt lgkmcnt(6)
    v_mfma_f32_32x32x16_bf16 v[160:175], v[128:131], v[72:75], v[160:175]
    ds_read_b64_tr_b16 v[148:149], v7 offset:11264
    ds_read_b64_tr_b16 v[150:151], v7 offset:11520
    v_add_f32 v153, v153, v9
    v_add_f32 v154, v154, v9
    v_add_f32 v155, v155, v9
    v_mfma_f32_32x32x16_bf16 v[176:191], v[132:135], v[72:75], v[176:191]
    ds_read_b64_tr_b16 v[128:129], v3 offset:45056
    ds_read_b64_tr_b16 v[130:131], v3 offset:45568
    v_add_f32 v156, v156, v9
    v_add_f32 v157, v157, v9
    s_waitcnt lgkmcnt(6)
    v_mfma_f32_32x32x16_bf16 v[192:207], v[136:139], v[72:75], v[192:207]
    ds_read_b64_tr_b16 v[132:133], v4 offset:45056
    ds_read_b64_tr_b16 v[134:135], v4 offset:45568
    v_add_f32 v158, v158, v9
    v_add_f32 v159, v159, v9
    v_cvt_pk_bf16_f32 v88, v152, v153
    v_mfma_f32_32x32x16_bf16 v[208:223], v[140:143], v[72:75], v[208:223]
    ds_read_b64_tr_b16 v[136:137], v5 offset:45056
    ds_read_b64_tr_b16 v[138:139], v5 offset:45568
    v_cvt_pk_bf16_f32 v89, v154, v155
    v_cvt_pk_bf16_f32 v90, v156, v157
    s_waitcnt lgkmcnt(6)
    v_mfma_f32_32x32x16_bf16 v[224:239], v[144:147], v[72:75], v[224:239]
    ds_read_b64_tr_b16 v[140:141], v6 offset:45056
    ds_read_b64_tr_b16 v[142:143], v6 offset:45568
    v_cvt_pk_bf16_f32 v91, v158, v159
    v_lshlrev_b32 v152, 16, v92
    v_and_b32 v153, s90, v92
    v_mfma_f32_32x32x16_bf16 v[240:255], v[148:151], v[72:75], v[240:255]
    ds_read_b64_tr_b16 v[144:145], v7 offset:14336
    ds_read_b64_tr_b16 v[146:147], v7 offset:14592
    v_lshlrev_b32 v154, 16, v93
    v_and_b32 v155, s90, v93
    s_waitcnt lgkmcnt(6)
    v_mfma_f32_32x32x16_bf16 v[160:175], v[128:131], v[76:79], v[160:175]
    ds_read_b64_tr_b16 v[148:149], v7 offset:15360
    ds_read_b64_tr_b16 v[150:151], v7 offset:15616
    v_lshlrev_b32 v156, 16, v94
    v_and_b32 v157, s90, v94
    v_lshlrev_b32 v158, 16, v95
    v_mfma_f32_32x32x16_bf16 v[176:191], v[132:135], v[76:79], v[176:191]
    s_barrier
    ds_read_b64_tr_b16 v[128:129], v3 offset:49152
    ds_read_b64_tr_b16 v[130:131], v3 offset:49664
    v_and_b32 v159, s90, v95
    v_add_f32 v152, v152, v9
    s_waitcnt lgkmcnt(6)
    v_mfma_f32_32x32x16_bf16 v[192:207], v[136:139], v[76:79], v[192:207]
    ds_read_b64_tr_b16 v[132:133], v4 offset:49152
    ds_read_b64_tr_b16 v[134:135], v4 offset:49664
    v_add_f32 v153, v153, v9
    v_add_f32 v154, v154, v9
    v_add_f32 v155, v155, v9
    v_mfma_f32_32x32x16_bf16 v[208:223], v[140:143], v[76:79], v[208:223]
    ds_read_b64_tr_b16 v[136:137], v5 offset:49152
    ds_read_b64_tr_b16 v[138:139], v5 offset:49664
    v_add_f32 v156, v156, v9
    v_add_f32 v157, v157, v9
    s_waitcnt lgkmcnt(6)
    v_mfma_f32_32x32x16_bf16 v[224:239], v[144:147], v[76:79], v[224:239]
    ds_read_b64_tr_b16 v[140:141], v6 offset:49152
    ds_read_b64_tr_b16 v[142:143], v6 offset:49664
    v_add_f32 v158, v158, v9
    v_add_f32 v159, v159, v9
    v_cvt_pk_bf16_f32 v92, v152, v153
    v_mfma_f32_32x32x16_bf16 v[240:255], v[148:151], v[76:79], v[240:255]
    ds_read_b64_tr_b16 v[144:145], v7 offset:49152
    ds_read_b64_tr_b16 v[146:147], v7 offset:49408
    v_cvt_pk_bf16_f32 v93, v154, v155
    v_cvt_pk_bf16_f32 v94, v156, v157
    s_waitcnt lgkmcnt(6)
    v_mfma_f32_32x32x16_bf16 v[160:175], v[128:131], v[80:83], v[160:175]
    ds_read_b64_tr_b16 v[148:149], v7 offset:50176
    ds_read_b64_tr_b16 v[150:151], v7 offset:50432
    v_cvt_pk_bf16_f32 v95, v158, v159
    v_lshlrev_b32 v152, 16, v96
    v_mfma_f32_32x32x16_bf16 v[176:191], v[132:135], v[80:83], v[176:191]
    ds_read_b64_tr_b16 v[128:129], v3 offset:53248
    ds_read_b64_tr_b16 v[130:131], v3 offset:53760
    v_and_b32 v153, s90, v96
    v_lshlrev_b32 v154, 16, v97
    v_and_b32 v155, s90, v97
    s_waitcnt lgkmcnt(6)
    v_mfma_f32_32x32x16_bf16 v[192:207], v[136:139], v[80:83], v[192:207]
    ds_read_b64_tr_b16 v[132:133], v4 offset:53248
    ds_read_b64_tr_b16 v[134:135], v4 offset:53760
    v_lshlrev_b32 v156, 16, v98
    v_and_b32 v157, s90, v98
    v_mfma_f32_32x32x16_bf16 v[208:223], v[140:143], v[80:83], v[208:223]
    ds_read_b64_tr_b16 v[136:137], v5 offset:53248
    ds_read_b64_tr_b16 v[138:139], v5 offset:53760
    v_lshlrev_b32 v158, 16, v99
    v_and_b32 v159, s90, v99
    v_add_f32 v152, v152, v9
    s_waitcnt lgkmcnt(6)
    v_mfma_f32_32x32x16_bf16 v[224:239], v[144:147], v[80:83], v[224:239]
    ds_read_b64_tr_b16 v[140:141], v6 offset:53248
    ds_read_b64_tr_b16 v[142:143], v6 offset:53760
    v_add_f32 v153, v153, v9
    v_add_f32 v154, v154, v9
    v_mfma_f32_32x32x16_bf16 v[240:255], v[148:151], v[80:83], v[240:255]
    ds_read_b64_tr_b16 v[144:145], v7 offset:53248
    ds_read_b64_tr_b16 v[146:147], v7 offset:53504
    v_add_f32 v155, v155, v9
    v_add_f32 v156, v156, v9
    v_add_f32 v157, v157, v9
    s_waitcnt lgkmcnt(6)
    v_mfma_f32_32x32x16_bf16 v[160:175], v[128:131], v[84:87], v[160:175]
    ds_read_b64_tr_b16 v[148:149], v7 offset:54272
    ds_read_b64_tr_b16 v[150:151], v7 offset:54528
    v_add_f32 v158, v158, v9
    v_add_f32 v159, v159, v9
    v_mfma_f32_32x32x16_bf16 v[176:191], v[132:135], v[84:87], v[176:191]
    ds_read_b64_tr_b16 v[128:129], v3 offset:57344
    ds_read_b64_tr_b16 v[130:131], v3 offset:57856
    v_cvt_pk_bf16_f32 v96, v152, v153
    v_cvt_pk_bf16_f32 v97, v154, v155
    v_cvt_pk_bf16_f32 v98, v156, v157
    s_waitcnt lgkmcnt(6)
    v_mfma_f32_32x32x16_bf16 v[192:207], v[136:139], v[84:87], v[192:207]
    ds_read_b64_tr_b16 v[132:133], v4 offset:57344
    ds_read_b64_tr_b16 v[134:135], v4 offset:57856
    v_cvt_pk_bf16_f32 v99, v158, v159
    v_lshlrev_b32 v152, 16, v100
    v_mfma_f32_32x32x16_bf16 v[208:223], v[140:143], v[84:87], v[208:223]
    ds_read_b64_tr_b16 v[136:137], v5 offset:57344
    ds_read_b64_tr_b16 v[138:139], v5 offset:57856
    v_and_b32 v153, s90, v100
    v_lshlrev_b32 v154, 16, v101
    v_and_b32 v155, s90, v101
    s_waitcnt lgkmcnt(6)
    v_mfma_f32_32x32x16_bf16 v[224:239], v[144:147], v[84:87], v[224:239]
    ds_read_b64_tr_b16 v[140:141], v6 offset:57344
    ds_read_b64_tr_b16 v[142:143], v6 offset:57856
    v_lshlrev_b32 v156, 16, v102
    v_and_b32 v157, s90, v102
    v_mfma_f32_32x32x16_bf16 v[240:255], v[148:151], v[84:87], v[240:255]
    ds_read_b64_tr_b16 v[144:145], v7 offset:57344
    ds_read_b64_tr_b16 v[146:147], v7 offset:57600
    v_lshlrev_b32 v158, 16, v103
    v_and_b32 v159, s90, v103
    v_add_f32 v152, v152, v9
    s_waitcnt lgkmcnt(6)
    v_mfma_f32_32x32x16_bf16 v[160:175], v[128:131], v[88:91], v[160:175]
    ds_read_b64_tr_b16 v[148:149], v7 offset:58368
    ds_read_b64_tr_b16 v[150:151], v7 offset:58624
    v_add_f32 v153, v153, v9
    v_add_f32 v154, v154, v9
    v_mfma_f32_32x32x16_bf16 v[176:191], v[132:135], v[88:91], v[176:191]
    ds_read_b64_tr_b16 v[128:129], v3 offset:61440
    ds_read_b64_tr_b16 v[130:131], v3 offset:61952
    v_add_f32 v155, v155, v9
    v_add_f32 v156, v156, v9
    v_add_f32 v157, v157, v9
    s_waitcnt lgkmcnt(6)
    v_mfma_f32_32x32x16_bf16 v[192:207], v[136:139], v[88:91], v[192:207]
    ds_read_b64_tr_b16 v[132:133], v4 offset:61440
    ds_read_b64_tr_b16 v[134:135], v4 offset:61952
    v_add_f32 v158, v158, v9
    v_add_f32 v159, v159, v9
    v_mfma_f32_32x32x16_bf16 v[208:223], v[140:143], v[88:91], v[208:223]
    ds_read_b64_tr_b16 v[136:137], v5 offset:61440
    ds_read_b64_tr_b16 v[138:139], v5 offset:61952
    v_cvt_pk_bf16_f32 v100, v152, v153
    v_cvt_pk_bf16_f32 v101, v154, v155
    v_cvt_pk_bf16_f32 v102, v156, v157
    s_waitcnt lgkmcnt(6)
    v_mfma_f32_32x32x16_bf16 v[224:239], v[144:147], v[88:91], v[224:239]
    ds_read_b64_tr_b16 v[140:141], v6 offset:61440
    ds_read_b64_tr_b16 v[142:143], v6 offset:61952
    v_cvt_pk_bf16_f32 v103, v158, v159
    v_lshlrev_b32 v152, 16, v104
    v_mfma_f32_32x32x16_bf16 v[240:255], v[148:151], v[88:91], v[240:255]
    ds_read_b64_tr_b16 v[144:145], v7 offset:61440
    ds_read_b64_tr_b16 v[146:147], v7 offset:61696
    v_and_b32 v153, s90, v104
    v_lshlrev_b32 v154, 16, v105
    v_and_b32 v155, s90, v105
    s_waitcnt lgkmcnt(6)
    v_mfma_f32_32x32x16_bf16 v[160:175], v[128:131], v[92:95], v[160:175]
    ds_read_b64_tr_b16 v[148:149], v7 offset:62464
    ds_read_b64_tr_b16 v[150:151], v7 offset:62720
    v_lshlrev_b32 v156, 16, v106
    v_and_b32 v157, s90, v106
    v_mfma_f32_32x32x16_bf16 v[176:191], v[132:135], v[92:95], v[176:191]
    s_barrier
    v_add_u32 v3, 81920, v3
    v_add_u32 v4, 81920, v4
    v_add_u32 v5, 81920, v5
    v_add_u32 v6, 81920, v6
    ds_read_b64_tr_b16 v[128:129], v3 offset:0
    ds_read_b64_tr_b16 v[130:131], v3 offset:512
    v_lshlrev_b32 v158, 16, v107
    v_and_b32 v159, s90, v107
    v_add_f32 v152, v152, v9
    s_waitcnt lgkmcnt(6)
    v_mfma_f32_32x32x16_bf16 v[192:207], v[136:139], v[92:95], v[192:207]
    ds_read_b64_tr_b16 v[132:133], v4 offset:0
    ds_read_b64_tr_b16 v[134:135], v4 offset:512
    v_add_f32 v153, v153, v9
    v_add_f32 v154, v154, v9
    v_mfma_f32_32x32x16_bf16 v[208:223], v[140:143], v[92:95], v[208:223]
    ds_read_b64_tr_b16 v[136:137], v5 offset:0
    ds_read_b64_tr_b16 v[138:139], v5 offset:512
    v_add_f32 v155, v155, v9
    v_add_f32 v156, v156, v9
    v_add_f32 v157, v157, v9
    s_waitcnt lgkmcnt(6)
    v_mfma_f32_32x32x16_bf16 v[224:239], v[144:147], v[92:95], v[224:239]
    ds_read_b64_tr_b16 v[140:141], v6 offset:0
    ds_read_b64_tr_b16 v[142:143], v6 offset:512
    v_add_f32 v158, v158, v9
    v_add_f32 v159, v159, v9
    v_mfma_f32_32x32x16_bf16 v[240:255], v[148:151], v[92:95], v[240:255]
    v_add_u32 v7, 51200, v7
    ds_read_b64_tr_b16 v[144:145], v7 offset:0
    ds_read_b64_tr_b16 v[146:147], v7 offset:256
    v_cvt_pk_bf16_f32 v104, v152, v153
    v_cvt_pk_bf16_f32 v105, v154, v155
    v_cvt_pk_bf16_f32 v106, v156, v157
    s_waitcnt lgkmcnt(6)
    v_mfma_f32_32x32x16_bf16 v[160:175], v[128:131], v[96:99], v[160:175]
    ds_read_b64_tr_b16 v[148:149], v7 offset:1024
    ds_read_b64_tr_b16 v[150:151], v7 offset:1280
    v_cvt_pk_bf16_f32 v107, v158, v159
    v_lshlrev_b32 v152, 16, v108
    v_mfma_f32_32x32x16_bf16 v[176:191], v[132:135], v[96:99], v[176:191]
    ds_read_b64_tr_b16 v[128:129], v3 offset:4096
    ds_read_b64_tr_b16 v[130:131], v3 offset:4608
    v_and_b32 v153, s90, v108
    v_lshlrev_b32 v154, 16, v109
    v_and_b32 v155, s90, v109
    s_waitcnt lgkmcnt(6)
    v_mfma_f32_32x32x16_bf16 v[192:207], v[136:139], v[96:99], v[192:207]
    ds_read_b64_tr_b16 v[132:133], v4 offset:4096
    ds_read_b64_tr_b16 v[134:135], v4 offset:4608
    v_lshlrev_b32 v156, 16, v110
    v_and_b32 v157, s90, v110
    v_mfma_f32_32x32x16_bf16 v[208:223], v[140:143], v[96:99], v[208:223]
    ds_read_b64_tr_b16 v[136:137], v5 offset:4096
    ds_read_b64_tr_b16 v[138:139], v5 offset:4608
    v_lshlrev_b32 v158, 16, v111
    v_and_b32 v159, s90, v111
    v_add_f32 v152, v152, v9
    s_waitcnt lgkmcnt(6)
    v_mfma_f32_32x32x16_bf16 v[224:239], v[144:147], v[96:99], v[224:239]
    ds_read_b64_tr_b16 v[140:141], v6 offset:4096
    ds_read_b64_tr_b16 v[142:143], v6 offset:4608
    v_add_f32 v153, v153, v9
    v_add_f32 v154, v154, v9
    v_mfma_f32_32x32x16_bf16 v[240:255], v[148:151], v[96:99], v[240:255]
    ds_read_b64_tr_b16 v[144:145], v7 offset:4096
    ds_read_b64_tr_b16 v[146:147], v7 offset:4352
    v_add_f32 v155, v155, v9
    v_add_f32 v156, v156, v9
    v_add_f32 v157, v157, v9
    s_waitcnt lgkmcnt(6)
    v_mfma_f32_32x32x16_bf16 v[160:175], v[128:131], v[100:103], v[160:175]
    ds_read_b64_tr_b16 v[148:149], v7 offset:5120
    ds_read_b64_tr_b16 v[150:151], v7 offset:5376
    v_add_f32 v158, v158, v9
    v_add_f32 v159, v159, v9
    v_mfma_f32_32x32x16_bf16 v[176:191], v[132:135], v[100:103], v[176:191]
    ds_read_b64_tr_b16 v[128:129], v3 offset:8192
    ds_read_b64_tr_b16 v[130:131], v3 offset:8704
    v_cvt_pk_bf16_f32 v108, v152, v153
    v_cvt_pk_bf16_f32 v109, v154, v155
    v_cvt_pk_bf16_f32 v110, v156, v157
    s_waitcnt lgkmcnt(6)
    v_mfma_f32_32x32x16_bf16 v[192:207], v[136:139], v[100:103], v[192:207]
    ds_read_b64_tr_b16 v[132:133], v4 offset:8192
    ds_read_b64_tr_b16 v[134:135], v4 offset:8704
    v_cvt_pk_bf16_f32 v111, v158, v159
    v_lshlrev_b32 v152, 16, v112
    v_mfma_f32_32x32x16_bf16 v[208:223], v[140:143], v[100:103], v[208:223]
    ds_read_b64_tr_b16 v[136:137], v5 offset:8192
    ds_read_b64_tr_b16 v[138:139], v5 offset:8704
    v_and_b32 v153, s90, v112
    v_lshlrev_b32 v154, 16, v113
    s_waitcnt lgkmcnt(6)
    v_mfma_f32_32x32x16_bf16 v[224:239], v[144:147], v[100:103], v[224:239]
    ds_read_b64_tr_b16 v[140:141], v6 offset:8192
    ds_read_b64_tr_b16 v[142:143], v6 offset:8704
    v_and_b32 v155, s90, v113
    v_lshlrev_b32 v156, 16, v114
    v_and_b32 v157, s90, v114
    v_mfma_f32_32x32x16_bf16 v[240:255], v[148:151], v[100:103], v[240:255]
    ds_read_b64_tr_b16 v[144:145], v7 offset:8192
    ds_read_b64_tr_b16 v[146:147], v7 offset:8448
    v_lshlrev_b32 v158, 16, v115
    v_and_b32 v159, s90, v115
    s_waitcnt lgkmcnt(6)
    v_mfma_f32_32x32x16_bf16 v[160:175], v[128:131], v[104:107], v[160:175]
    ds_read_b64_tr_b16 v[148:149], v7 offset:9216
    ds_read_b64_tr_b16 v[150:151], v7 offset:9472
    v_add_f32 v152, v152, v9
    v_add_f32 v153, v153, v9
    v_add_f32 v154, v154, v9
    v_mfma_f32_32x32x16_bf16 v[176:191], v[132:135], v[104:107], v[176:191]
    ds_read_b64_tr_b16 v[128:129], v3 offset:12288
    ds_read_b64_tr_b16 v[130:131], v3 offset:12800
    v_add_f32 v155, v155, v9
    v_add_f32 v156, v156, v9
    s_waitcnt lgkmcnt(6)
    v_mfma_f32_32x32x16_bf16 v[192:207], v[136:139], v[104:107], v[192:207]
    ds_read_b64_tr_b16 v[132:133], v4 offset:12288
    ds_read_b64_tr_b16 v[134:135], v4 offset:12800
    v_add_f32 v157, v157, v9
    v_add_f32 v158, v158, v9
    v_add_f32 v159, v159, v9
    v_mfma_f32_32x32x16_bf16 v[208:223], v[140:143], v[104:107], v[208:223]
    ds_read_b64_tr_b16 v[136:137], v5 offset:12288
    ds_read_b64_tr_b16 v[138:139], v5 offset:12800
    v_cvt_pk_bf16_f32 v112, v152, v153
    v_cvt_pk_bf16_f32 v113, v154, v155
    s_waitcnt lgkmcnt(6)
    v_mfma_f32_32x32x16_bf16 v[224:239], v[144:147], v[104:107], v[224:239]
    ds_read_b64_tr_b16 v[140:141], v6 offset:12288
    ds_read_b64_tr_b16 v[142:143], v6 offset:12800
    v_cvt_pk_bf16_f32 v114, v156, v157
    v_cvt_pk_bf16_f32 v115, v158, v159
    v_lshlrev_b32 v152, 16, v116
    v_mfma_f32_32x32x16_bf16 v[240:255], v[148:151], v[104:107], v[240:255]
    ds_read_b64_tr_b16 v[144:145], v7 offset:12288
    ds_read_b64_tr_b16 v[146:147], v7 offset:12544
    v_and_b32 v153, s90, v116
    v_lshlrev_b32 v154, 16, v117
    s_waitcnt lgkmcnt(6)
    v_mfma_f32_32x32x16_bf16 v[160:175], v[128:131], v[108:111], v[160:175]
    ds_read_b64_tr_b16 v[148:149], v7 offset:13312
    ds_read_b64_tr_b16 v[150:151], v7 offset:13568
    v_and_b32 v155, s90, v117
    v_lshlrev_b32 v156, 16, v118
    v_and_b32 v157, s90, v118
    v_mfma_f32_32x32x16_bf16 v[176:191], v[132:135], v[108:111], v[176:191]
    s_barrier
    ds_read_b64_tr_b16 v[128:129], v3 offset:16384
    ds_read_b64_tr_b16 v[130:131], v3 offset:16896
    v_lshlrev_b32 v158, 16, v119
    v_and_b32 v159, s90, v119
    s_waitcnt lgkmcnt(6)
    v_mfma_f32_32x32x16_bf16 v[192:207], v[136:139], v[108:111], v[192:207]
    ds_read_b64_tr_b16 v[132:133], v4 offset:16384
    ds_read_b64_tr_b16 v[134:135], v4 offset:16896
    v_add_f32 v152, v152, v9
    v_add_f32 v153, v153, v9
    v_add_f32 v154, v154, v9
    v_mfma_f32_32x32x16_bf16 v[208:223], v[140:143], v[108:111], v[208:223]
    ds_read_b64_tr_b16 v[136:137], v5 offset:16384
    ds_read_b64_tr_b16 v[138:139], v5 offset:16896
    v_add_f32 v155, v155, v9
    v_add_f32 v156, v156, v9
    s_waitcnt lgkmcnt(6)
    v_mfma_f32_32x32x16_bf16 v[224:239], v[144:147], v[108:111], v[224:239]
    ds_read_b64_tr_b16 v[140:141], v6 offset:16384
    ds_read_b64_tr_b16 v[142:143], v6 offset:16896
    v_add_f32 v157, v157, v9
    v_add_f32 v158, v158, v9
    v_add_f32 v159, v159, v9
    v_mfma_f32_32x32x16_bf16 v[240:255], v[148:151], v[108:111], v[240:255]
    ds_read_b64_tr_b16 v[144:145], v7 offset:47104
    ds_read_b64_tr_b16 v[146:147], v7 offset:47360
    v_cvt_pk_bf16_f32 v116, v152, v153
    v_cvt_pk_bf16_f32 v117, v154, v155
    s_waitcnt lgkmcnt(6)
    v_mfma_f32_32x32x16_bf16 v[160:175], v[128:131], v[112:115], v[160:175]
    ds_read_b64_tr_b16 v[148:149], v7 offset:48128
    ds_read_b64_tr_b16 v[150:151], v7 offset:48384
    v_cvt_pk_bf16_f32 v118, v156, v157
    v_cvt_pk_bf16_f32 v119, v158, v159
    v_lshlrev_b32 v152, 16, v120
    v_mfma_f32_32x32x16_bf16 v[176:191], v[132:135], v[112:115], v[176:191]
    ds_read_b64_tr_b16 v[128:129], v3 offset:20480
    ds_read_b64_tr_b16 v[130:131], v3 offset:20992
    v_and_b32 v153, s90, v120
    v_lshlrev_b32 v154, 16, v121
    s_waitcnt lgkmcnt(6)
    v_mfma_f32_32x32x16_bf16 v[192:207], v[136:139], v[112:115], v[192:207]
    ds_read_b64_tr_b16 v[132:133], v4 offset:20480
    ds_read_b64_tr_b16 v[134:135], v4 offset:20992
    v_and_b32 v155, s90, v121
    v_lshlrev_b32 v156, 16, v122
    v_and_b32 v157, s90, v122
    v_mfma_f32_32x32x16_bf16 v[208:223], v[140:143], v[112:115], v[208:223]
    ds_read_b64_tr_b16 v[136:137], v5 offset:20480
    ds_read_b64_tr_b16 v[138:139], v5 offset:20992
    v_lshlrev_b32 v158, 16, v123
    v_and_b32 v159, s90, v123
    s_waitcnt lgkmcnt(6)
    v_mfma_f32_32x32x16_bf16 v[224:239], v[144:147], v[112:115], v[224:239]
    ds_read_b64_tr_b16 v[140:141], v6 offset:20480
    ds_read_b64_tr_b16 v[142:143], v6 offset:20992
    v_add_f32 v152, v152, v9
    v_add_f32 v153, v153, v9
    v_add_f32 v154, v154, v9
    v_mfma_f32_32x32x16_bf16 v[240:255], v[148:151], v[112:115], v[240:255]
    ds_read_b64_tr_b16 v[144:145], v7 offset:51200
    ds_read_b64_tr_b16 v[146:147], v7 offset:51456
    v_add_f32 v155, v155, v9
    v_add_f32 v156, v156, v9
    s_waitcnt lgkmcnt(6)
    v_mfma_f32_32x32x16_bf16 v[160:175], v[128:131], v[116:119], v[160:175]
    ds_read_b64_tr_b16 v[148:149], v7 offset:52224
    ds_read_b64_tr_b16 v[150:151], v7 offset:52480
    v_add_f32 v157, v157, v9
    v_add_f32 v158, v158, v9
    v_add_f32 v159, v159, v9
    v_mfma_f32_32x32x16_bf16 v[176:191], v[132:135], v[116:119], v[176:191]
    ds_read_b64_tr_b16 v[128:129], v3 offset:24576
    ds_read_b64_tr_b16 v[130:131], v3 offset:25088
    v_cvt_pk_bf16_f32 v120, v152, v153
    v_cvt_pk_bf16_f32 v121, v154, v155
    s_waitcnt lgkmcnt(6)
    v_mfma_f32_32x32x16_bf16 v[192:207], v[136:139], v[116:119], v[192:207]
    ds_read_b64_tr_b16 v[132:133], v4 offset:24576
    ds_read_b64_tr_b16 v[134:135], v4 offset:25088
    v_cvt_pk_bf16_f32 v122, v156, v157
    v_cvt_pk_bf16_f32 v123, v158, v159
    v_lshlrev_b32 v152, 16, v124
    v_mfma_f32_32x32x16_bf16 v[208:223], v[140:143], v[116:119], v[208:223]
    ds_read_b64_tr_b16 v[136:137], v5 offset:24576
    ds_read_b64_tr_b16 v[138:139], v5 offset:25088
    v_and_b32 v153, s90, v124
    v_lshlrev_b32 v154, 16, v125
    s_waitcnt lgkmcnt(6)
    v_mfma_f32_32x32x16_bf16 v[224:239], v[144:147], v[116:119], v[224:239]
    ds_read_b64_tr_b16 v[140:141], v6 offset:24576
    ds_read_b64_tr_b16 v[142:143], v6 offset:25088
    v_and_b32 v155, s90, v125
    v_lshlrev_b32 v156, 16, v126
    v_and_b32 v157, s90, v126
    v_mfma_f32_32x32x16_bf16 v[240:255], v[148:151], v[116:119], v[240:255]
    ds_read_b64_tr_b16 v[144:145], v7 offset:55296
    ds_read_b64_tr_b16 v[146:147], v7 offset:55552
    v_lshlrev_b32 v158, 16, v127
    v_and_b32 v159, s90, v127
    s_waitcnt lgkmcnt(6)
    v_mfma_f32_32x32x16_bf16 v[160:175], v[128:131], v[120:123], v[160:175]
    ds_read_b64_tr_b16 v[148:149], v7 offset:56320
    ds_read_b64_tr_b16 v[150:151], v7 offset:56576
    v_add_f32 v152, v152, v9
    v_add_f32 v153, v153, v9
    v_add_f32 v154, v154, v9
    v_mfma_f32_32x32x16_bf16 v[176:191], v[132:135], v[120:123], v[176:191]
    ds_read_b64_tr_b16 v[128:129], v3 offset:28672
    ds_read_b64_tr_b16 v[130:131], v3 offset:29184
    v_add_f32 v155, v155, v9
    v_add_f32 v156, v156, v9
    s_waitcnt lgkmcnt(6)
    v_mfma_f32_32x32x16_bf16 v[192:207], v[136:139], v[120:123], v[192:207]
    ds_read_b64_tr_b16 v[132:133], v4 offset:28672
    ds_read_b64_tr_b16 v[134:135], v4 offset:29184
    v_add_f32 v157, v157, v9
    v_add_f32 v158, v158, v9
    v_add_f32 v159, v159, v9
    v_mfma_f32_32x32x16_bf16 v[208:223], v[140:143], v[120:123], v[208:223]
    ds_read_b64_tr_b16 v[136:137], v5 offset:28672
    ds_read_b64_tr_b16 v[138:139], v5 offset:29184
    v_cvt_pk_bf16_f32 v124, v152, v153
    v_cvt_pk_bf16_f32 v125, v154, v155
    s_waitcnt lgkmcnt(6)
    v_mfma_f32_32x32x16_bf16 v[224:239], v[144:147], v[120:123], v[224:239]
    ds_read_b64_tr_b16 v[140:141], v6 offset:28672
    ds_read_b64_tr_b16 v[142:143], v6 offset:29184
    v_cvt_pk_bf16_f32 v126, v156, v157
    v_cvt_pk_bf16_f32 v127, v158, v159
    v_mfma_f32_32x32x16_bf16 v[240:255], v[148:151], v[120:123], v[240:255]
    ds_read_b64_tr_b16 v[144:145], v7 offset:59392
    ds_read_b64_tr_b16 v[146:147], v7 offset:59648
    s_waitcnt lgkmcnt(6)
    v_mfma_f32_32x32x16_bf16 v[160:175], v[128:131], v[124:127], v[160:175]
    ds_read_b64_tr_b16 v[148:149], v7 offset:60416
    ds_read_b64_tr_b16 v[150:151], v7 offset:60672
    v_mfma_f32_32x32x16_bf16 v[176:191], v[132:135], v[124:127], v[176:191]
    s_barrier
    s_waitcnt lgkmcnt(4)
    v_mfma_f32_32x32x16_bf16 v[192:207], v[136:139], v[124:127], v[192:207]
    v_mfma_f32_32x32x16_bf16 v[208:223], v[140:143], v[124:127], v[208:223]
    s_waitcnt lgkmcnt(0)
    v_mfma_f32_32x32x16_bf16 v[224:239], v[144:147], v[124:127], v[224:239]
    v_mfma_f32_32x32x16_bf16 v[240:255], v[148:151], v[124:127], v[240:255]
L1_AP1e:
    s_setprio 3
    v_mov_b32 v0, 0
    buffer_load_dword v45, v0, s[84:87], 0 offen
    v_rsq_f32 v32, v10
    s_nop 0
    v_mul_f32 v33, 0xc0135761, v32
    v_mul_f32 v34, v32, v32
    v_mul_f32 v34, v34, v32
    v_mul_f32 v34, 0xbdd2d3e8, v34
    s_cmp_eq_u32 s60, 0
    s_cbranch_scc1 L1_nrt
    s_add_u32 s67, s70, 116736
    v_lshl_add_u32 v26, v2, 2, s67
    v_lshrrev_b32 v27, 5, v2
    v_lshl_add_u32 v27, v27, 4, s67
    ds_write_b32 v26, v32
    ds_read_b128 v[48:51], v27 offset:0
    ds_read_b128 v[52:55], v27 offset:32
    ds_read_b128 v[56:59], v27 offset:64
    ds_read_b128 v[60:63], v27 offset:96
L1_nrt:
    v_mov_b32 v1, 0x3f80
    v_mov_b32 v0, 0x3f803f80
    s_add_u32 s68, s50, 16
    s_lshl_b32 s68, s68, 17
    s_add_u32 s68, s68, s69
    v_mul_f32 v240, v240, v32
    v_mul_f32 v241, v241, v32
    v_mul_f32 v242, v242, v32
    v_mul_f32 v243, v243, v32
    v_mul_f32 v244, v244, v32
    v_mul_f32 v245, v245, v32
    v_mul_f32 v246, v246, v32
    v_mul_f32 v247, v247, v32
    v_mul_f32 v248, v248, v32
    v_mul_f32 v249, v249, v32
    v_mul_f32 v250, v250, v32
    v_mul_f32 v251, v251, v32
    v_mul_f32 v252, v252, v32
    v_mul_f32 v253, v253, v32
    v_mul_f32 v254, v254, v32
    v_mul_f32 v255, v255, v32
    v_cvt_pk_bf16_f32 v240, v240, v241
    v_cvt_pk_bf16_f32 v241, v242, v243
    v_cvt_pk_bf16_f32 v242, v244, v245
    v_cvt_pk_bf16_f32 v243, v246, v247
    v_cvt_pk_bf16_f32 v244, v248, v249
    v_cvt_pk_bf16_f32 v245, v250, v251
    v_cvt_pk_bf16_f32 v246, v252, v253
    v_cvt_pk_bf16_f32 v247, v254, v255
    v_cndmask_b32 v246, v246, v0, s[92:93]
    v_cndmask_b32 v247, v247, v1, s[92:93]
    buffer_store_dwordx4 v[240:243], v13, s[40:43], s68 offen sc1
    buffer_store_dwordx4 v[244:247], v13, s[40:43], s68 offen offset:1024 sc1
    s_cmp_eq_u32 s60, 0
    s_cbranch_scc1 L1_Ax
    s_waitcnt lgkmcnt(0)
    s_lshl_b32 s68, s62, 17
    s_add_u32 s68, s68, s69
    s_mov_b32 s74, 0xf0000000
    s_mov_b32 s75, 0xf0000000
    v_and_b32 v0, 31, v2
    v_cmp_eq_u32 vcc, 28, v0
    v_mov_b32 v0, 0x3f803f80
    s_nop 0
    v_cndmask_b32 v1, 0, v0, vcc
    v_mul_f32 v160, v160, v48
    v_mul_f32 v161, v161, v49
    v_mul_f32 v162, v162, v50
    v_mul_f32 v163, v163, v51
    v_mul_f32 v164, v164, v52
    v_mul_f32 v165, v165, v53
    v_mul_f32 v166, v166, v54
    v_mul_f32 v167, v167, v55
    v_mul_f32 v168, v168, v56
    v_mul_f32 v169, v169, v57
    v_mul_f32 v170, v170, v58
    v_mul_f32 v171, v171, v59
    v_mul_f32 v172, v172, v60
    v_mul_f32 v173, v173, v61
    v_mul_f32 v174, v174, v62
    v_mul_f32 v175, v175, v63
    v_cvt_pk_bf16_f32 v160, v160, v161
    v_cvt_pk_bf16_f32 v161, v162, v163
    v_cvt_pk_bf16_f32 v162, v164, v165
    v_cvt_pk_bf16_f32 v163, v166, v167
    v_cvt_pk_bf16_f32 v164, v168, v169
    v_cvt_pk_bf16_f32 v165, v170, v171
    v_cvt_pk_bf16_f32 v166, v172, v173
    v_cvt_pk_bf16_f32 v167, v174, v175
    v_cndmask_b32 v160, v160, v1, s[74:75]
    v_cndmask_b32 v161, v161, v1, s[74:75]
    v_cndmask_b32 v162, v162, v1, s[74:75]
    v_cndmask_b32 v163, v163, v1, s[74:75]
    v_cndmask_b32 v164, v164, v1, s[74:75]
    v_cndmask_b32 v165, v165, v1, s[74:75]
    v_cndmask_b32 v166, v166, v1, s[74:75]
    v_cndmask_b32 v167, v167, v1, s[74:75]
    s_add_u32 s58, s68, 0
    buffer_store_dwordx4 v[160:163], v13, s[40:43], s58 offen sc1
    buffer_store_dwordx4 v[164:167], v13, s[40:43], s58 offen offset:1024 sc1
    v_mul_f32 v176, v176, v48
    v_mul_f32 v177, v177, v49
    v_mul_f32 v178, v178, v50
    v_mul_f32 v179, v179, v51
    v_mul_f32 v180, v180, v52
    v_mul_f32 v181, v181, v53
    v_mul_f32 v182, v182, v54
    v_mul_f32 v183, v183, v55
    v_mul_f32 v184, v184, v56
    v_mul_f32 v185, v185, v57
    v_mul_f32 v186, v186, v58
    v_mul_f32 v187, v187, v59
    v_mul_f32 v188, v188, v60
    v_mul_f32 v189, v189, v61
    v_mul_f32 v190, v190, v62
    v_mul_f32 v191, v191, v63
    v_cvt_pk_bf16_f32 v176, v176, v177
    v_cvt_pk_bf16_f32 v177, v178, v179
    v_cvt_pk_bf16_f32 v178, v180, v181
    v_cvt_pk_bf16_f32 v179, v182, v183
    v_cvt_pk_bf16_f32 v180, v184, v185
    v_cvt_pk_bf16_f32 v181, v186, v187
    v_cvt_pk_bf16_f32 v182, v188, v189
    v_cvt_pk_bf16_f32 v183, v190, v191
    v_cndmask_b32 v176, v176, v1, s[74:75]
    v_cndmask_b32 v177, v177, v1, s[74:75]
    v_cndmask_b32 v178, v178, v1, s[74:75]
    v_cndmask_b32 v179, v179, v1, s[74:75]
    v_cndmask_b32 v180, v180, v1, s[74:75]
    v_cndmask_b32 v181, v181, v1, s[74:75]
    v_cndmask_b32 v182, v182, v1, s[74:75]
    v_cndmask_b32 v183, v183, v1, s[74:75]
    s_add_u32 s58, s68, 131072
    buffer_store_dwordx4 v[176:179], v13, s[40:43], s58 offen sc1
    buffer_store_dwordx4 v[180:183], v13, s[40:43], s58 offen offset:1024 sc1
    v_mul_f32 v192, v192, v48
    v_mul_f32 v193, v193, v49
    v_mul_f32 v194, v194, v50
    v_mul_f32 v195, v195, v51
    v_mul_f32 v196, v196, v52
    v_mul_f32 v197, v197, v53
    v_mul_f32 v198, v198, v54
    v_mul_f32 v199, v199, v55
    v_mul_f32 v200, v200, v56
    v_mul_f32 v201, v201, v57
    v_mul_f32 v202, v202, v58
    v_mul_f32 v203, v203, v59
    v_mul_f32 v204, v204, v60
    v_mul_f32 v205, v205, v61
    v_mul_f32 v206, v206, v62
    v_mul_f32 v207, v207, v63
    v_cvt_pk_bf16_f32 v192, v192, v193
    v_cvt_pk_bf16_f32 v193, v194, v195
    v_cvt_pk_bf16_f32 v194, v196, v197
    v_cvt_pk_bf16_f32 v195, v198, v199
    v_cvt_pk_bf16_f32 v196, v200, v201
    v_cvt_pk_bf16_f32 v197, v202, v203
    v_cvt_pk_bf16_f32 v198, v204, v205
    v_cvt_pk_bf16_f32 v199, v206, v207
    v_cndmask_b32 v192, v192, v1, s[74:75]
    v_cndmask_b32 v193, v193, v1, s[74:75]
    v_cndmask_b32 v194, v194, v1, s[74:75]
    v_cndmask_b32 v195, v195, v1, s[74:75]
    v_cndmask_b32 v196, v196, v1, s[74:75]
    v_cndmask_b32 v197, v197, v1, s[74:75]
    v_cndmask_b32 v198, v198, v1, s[74:75]
    v_cndmask_b32 v199, v199, v1, s[74:75]
    s_add_u32 s58, s68, 262144
    buffer_store_dwordx4 v[192:195], v13, s[40:43], s58 offen sc1
    buffer_store_dwordx4 v[196:199], v13, s[40:43], s58 offen offset:1024 sc1
    v_mul_f32 v208, v208, v48
    v_mul_f32 v209, v209, v49
    v_mul_f32 v210, v210, v50
    v_mul_f32 v211, v211, v51
    v_mul_f32 v212, v212, v52
    v_mul_f32 v213, v213, v53
    v_mul_f32 v214, v214, v54
    v_mul_f32 v215, v215, v55
    v_mul_f32 v216, v216, v56
    v_mul_f32 v217, v217, v57
    v_mul_f32 v218, v218, v58
    v_mul_f32 v219, v219, v59
    v_mul_f32 v220, v220, v60
    v_mul_f32 v221, v221, v61
    v_mul_f32 v222, v222, v62
    v_mul_f32 v223, v223, v63
    v_cvt_pk_bf16_f32 v208, v208, v209
    v_cvt_pk_bf16_f32 v209, v210, v211
    v_cvt_pk_bf16_f32 v210, v212, v213
    v_cvt_pk_bf16_f32 v211, v214, v215
    v_cvt_pk_bf16_f32 v212, v216, v217
    v_cvt_pk_bf16_f32 v213, v218, v219
    v_cvt_pk_bf16_f32 v214, v220, v221
    v_cvt_pk_bf16_f32 v215, v222, v223
    v_cndmask_b32 v208, v208, v1, s[74:75]
    v_cndmask_b32 v209, v209, v1, s[74:75]
    v_cndmask_b32 v210, v210, v1, s[74:75]
    v_cndmask_b32 v211, v211, v1, s[74:75]
    v_cndmask_b32 v212, v212, v1, s[74:75]
    v_cndmask_b32 v213, v213, v1, s[74:75]
    v_cndmask_b32 v214, v214, v1, s[74:75]
    v_cndmask_b32 v215, v215, v1, s[74:75]
    s_add_u32 s58, s68, 393216
    buffer_store_dwordx4 v[208:211], v13, s[40:43], s58 offen sc1
    buffer_store_dwordx4 v[212:215], v13, s[40:43], s58 offen offset:1024 sc1
    s_branch L1_Ap
L1_Ax:
L1_Ap:
    v_mul_f32 v0, 0x3e8b97f6, v32
    s_lshl_b32 s57, s48, 12
    s_add_u32 s57, s57, 65536
    v_add_u32 v26, s57, v13
    v_mul_f32 v224, v224, v0
    v_mul_f32 v225, v225, v0
    v_mul_f32 v226, v226, v0
    v_mul_f32 v227, v227, v0
    v_mul_f32 v228, v228, v0
    v_mul_f32 v229, v229, v0
    v_mul_f32 v230, v230, v0
    v_mul_f32 v231, v231, v0
    v_mul_f32 v232, v232, v0
    v_mul_f32 v233, v233, v0
    v_mul_f32 v234, v234, v0
    v_mul_f32 v235, v235, v0
    v_mul_f32 v236, v236, v0
    v_mul_f32 v237, v237, v0
    v_mul_f32 v238, v238, v0
    v_mul_f32 v239, v239, v0
    v_cvt_pk_bf16_f32 v224, v224, v225
    v_cvt_pk_bf16_f32 v225, v226, v227
    v_cvt_pk_bf16_f32 v226, v228, v229
    v_cvt_pk_bf16_f32 v227, v230, v231
    v_cvt_pk_bf16_f32 v228, v232, v233
    v_cvt_pk_bf16_f32 v229, v234, v235
    v_cvt_pk_bf16_f32 v230, v236, v237
    v_cvt_pk_bf16_f32 v231, v238, v239
    v_cndmask_b32 v230, v230, 0, s[92:93]
    v_cndmask_b32 v231, v231, 0, s[92:93]
    ds_write_b128 v26, v[224:227] offset:0
    ds_write_b128 v26, v[228:231] offset:1024
    s_cmp_lg_u32 s48, 0
    s_cbranch_scc1 L1_nk
    ds_write_b128 v26, v[240:243] offset:2048
    ds_write_b128 v26, v[244:247] offset:3072
L1_nk:
    s_waitcnt vmcnt(0)
    s_lshl_b32 s59, s51, 2
    s_add_u32 s59, s59, 15695872
    s_lshl_b32 s57, s62, 7
    s_add_u32 s57, s57, s59
    s_sub_u32 s57, s57, 4160
    s_cmp_eq_u32 s60, 1
    s_cselect_b32 s57, s57, 0x7f000000
    v_lshl_add_u32 v46, v2, 7, s57
    s_lshl_b32 s57, s50, 7
    s_add_u32 s57, s57, s59
    v_writelane_b32 v46, s57, 0
    v_readfirstlane_b32 s95, v45
    v_mov_b32 v44, 0
    s_mov_b32 s65, 0x40000
L1_Agt:
    s_cmp_lg_u32 s95, 0
    s_cbranch_scc1 L1_Agtx
    s_sub_u32 s65, s65, 1
    s_cmp_eq_u32 s65, 0
    s_cbranch_scc1 L1_Agtx
    buffer_load_dword v45, v44, s[84:87], 0 offen sc1
    s_waitcnt vmcnt(0)
    v_readfirstlane_b32 s95, v45
    s_branch L1_Agt
L1_Agtx:
    v_mov_b32 v0, 130944
    v_mov_b32 v1, 1
    s_mov_b64 exec, 1
    ds_add_rtn_u32 v1, v0, v1 offset:8
    s_mov_b64 exec, 31
    s_waitcnt lgkmcnt(0)
    v_readfirstlane_b32 s57, v1
    v_mov_b32 v1, s95
    s_cmp_eq_u32 s57, 3
    s_cselect_b32 s58, 0, 0x7ff00000
    buffer_store_dword v1, v46, s[40:43], s58 offen sc1
    s_mov_b64 exec, -1
    s_setprio 0
    s_cmp_eq_u32 s60, 1
    s_cbranch_scc1 L1_Ay
    v_mul_f32 v36, v160, v160
    v_mul_f32 v37, v161, v161
    v_mul_f32 v38, v162, v162
    v_mul_f32 v39, v163, v163
    v_mul_f32 v40, v164, v164
    v_mul_f32 v41, v165, v165
    v_mul_f32 v42, v166, v166
    v_mul_f32 v43, v167, v167
    v_fma_f32 v36, v36, v34, v33
    v_fma_f32 v37, v37, v34, v33
    v_fma_f32 v38, v38, v34, v33
    v_fma_f32 v39, v39, v34, v33
    v_fma_f32 v40, v40, v34, v33
    v_fma_f32 v41, v41, v34, v33
    v_fma_f32 v42, v42, v34, v33
    v_fma_f32 v43, v43, v34, v33
    v_mul_f32 v36, v36, v160
    v_mul_f32 v37, v37, v161
    v_mul_f32 v38, v38, v162
    v_mul_f32 v39, v39, v163
    v_mul_f32 v40, v40, v164
    v_mul_f32 v41, v41, v165
    v_mul_f32 v42, v42, v166
    v_mul_f32 v43, v43, v167
    v_exp_f32 v36, v36
    v_mul_f32 v160, v160, v168
    v_exp_f32 v37, v37
    v_mul_f32 v161, v161, v169
    v_exp_f32 v38, v38
    v_mul_f32 v162, v162, v170
    v_exp_f32 v39, v39
    v_mul_f32 v163, v163, v171
    v_exp_f32 v40, v40
    v_mul_f32 v164, v164, v172
    v_exp_f32 v41, v41
    v_mul_f32 v165, v165, v173
    v_exp_f32 v42, v42
    v_mul_f32 v166, v166, v174
    v_exp_f32 v43, v43
    v_mul_f32 v167, v167, v175
    v_fma_f32 v36, v36, v10, v10
    v_fma_f32 v37, v37, v10, v10
    v_fma_f32 v38, v38, v10, v10
    v_fma_f32 v39, v39, v10, v10
    v_fma_f32 v40, v40, v10, v10
    v_fma_f32 v41, v41, v10, v10
    v_fma_f32 v42, v42, v10, v10
    v_fma_f32 v43, v43, v10, v10
    v_rcp_f32 v36, v36
    v_rcp_f32 v37, v37
    v_rcp_f32 v38, v38
    v_rcp_f32 v39, v39
    v_rcp_f32 v40, v40
    v_rcp_f32 v41, v41
    v_rcp_f32 v42, v42
    v_rcp_f32 v43, v43
    s_add_u32 s58, s66, 0
    v_mul_f32 v160, v160, v36
    v_mul_f32 v161, v161, v37
    v_mul_f32 v162, v162, v38
    v_mul_f32 v163, v163, v39
    v_mul_f32 v164, v164, v40
    v_mul_f32 v165, v165, v41
    v_mul_f32 v166, v166, v42
    v_mul_f32 v167, v167, v43
    v_cvt_pk_bf16_f32 v168, v160, v161
    v_cvt_pk_bf16_f32 v169, v162, v163
    v_cvt_pk_bf16_f32 v170, v164, v165
    v_cvt_pk_bf16_f32 v171, v166, v167
    s_add_u32 s57, s70, 98304
    v_add_u32 v11, s57, v13
    v_mul_f32 v36, v176, v176
    v_mul_f32 v37, v177, v177
    v_mul_f32 v38, v178, v178
    v_mul_f32 v39, v179, v179
    v_mul_f32 v40, v180, v180
    v_mul_f32 v41, v181, v181
    v_mul_f32 v42, v182, v182
    v_mul_f32 v43, v183, v183
    v_fma_f32 v36, v36, v34, v33
    v_fma_f32 v37, v37, v34, v33
    v_fma_f32 v38, v38, v34, v33
    v_fma_f32 v39, v39, v34, v33
    v_fma_f32 v40, v40, v34, v33
    v_fma_f32 v41, v41, v34, v33
    v_fma_f32 v42, v42, v34, v33
    v_fma_f32 v43, v43, v34, v33
    v_mul_f32 v36, v36, v176
    v_mul_f32 v37, v37, v177
    v_mul_f32 v38, v38, v178
    v_mul_f32 v39, v39, v179
    v_mul_f32 v40, v40, v180
    v_mul_f32 v41, v41, v181
    v_mul_f32 v42, v42, v182
    v_mul_f32 v43, v43, v183
    v_exp_f32 v36, v36
    v_mul_f32 v176, v176, v184
    v_exp_f32 v37, v37
    v_mul_f32 v177, v177, v185
    v_exp_f32 v38, v38
    v_mul_f32 v178, v178, v186
    v_exp_f32 v39, v39
    v_mul_f32 v179, v179, v187
    v_exp_f32 v40, v40
    v_mul_f32 v180, v180, v188
    v_exp_f32 v41, v41
    v_mul_f32 v181, v181, v189
    v_exp_f32 v42, v42
    v_mul_f32 v182, v182, v190
    v_exp_f32 v43, v43
    v_mul_f32 v183, v183, v191
    v_fma_f32 v36, v36, v10, v10
    v_fma_f32 v37, v37, v10, v10
    v_fma_f32 v38, v38, v10, v10
    v_fma_f32 v39, v39, v10, v10
    v_fma_f32 v40, v40, v10, v10
    v_fma_f32 v41, v41, v10, v10
    v_fma_f32 v42, v42, v10, v10
    v_fma_f32 v43, v43, v10, v10
    v_rcp_f32 v36, v36
    v_rcp_f32 v37, v37
    v_rcp_f32 v38, v38
    v_rcp_f32 v39, v39
    v_rcp_f32 v40, v40
    v_rcp_f32 v41, v41
    v_rcp_f32 v42, v42
    v_rcp_f32 v43, v43
    s_add_u32 s58, s66, 2048
    ds_read_b32 v1, v0 offset:8
    v_mul_f32 v176, v176, v36
    v_mul_f32 v177, v177, v37
    v_mul_f32 v178, v178, v38
    v_mul_f32 v179, v179, v39
    v_mul_f32 v180, v180, v40
    v_mul_f32 v181, v181, v41
    v_mul_f32 v182, v182, v42
    v_mul_f32 v183, v183, v43
    v_cvt_pk_bf16_f32 v184, v176, v177
    v_cvt_pk_bf16_f32 v185, v178, v179
    v_cvt_pk_bf16_f32 v186, v180, v181
    v_cvt_pk_bf16_f32 v187, v182, v183
L1_h6:
    s_waitcnt lgkmcnt(0)
    v_readfirstlane_b32 s57, v1
    s_cmp_eq_u32 s57, 4
    s_cbranch_scc1 L1_h7
    ds_read_b32 v1, v0 offset:8
    s_branch L1_h6
L1_h7:
    ds_write_b128 v11, v[168:171] offset:0
    v_mul_f32 v36, v192, v192
    v_mul_f32 v37, v193, v193
    v_mul_f32 v38, v194, v194
    v_mul_f32 v39, v195, v195
    v_mul_f32 v40, v196, v196
    v_mul_f32 v41, v197, v197
    v_mul_f32 v42, v198, v198
    v_mul_f32 v43, v199, v199
    v_fma_f32 v36, v36, v34, v33
    v_fma_f32 v37, v37, v34, v33
    v_fma_f32 v38, v38, v34, v33
    v_fma_f32 v39, v39, v34, v33
    v_fma_f32 v40, v40, v34, v33
    v_fma_f32 v41, v41, v34, v33
    v_fma_f32 v42, v42, v34, v33
    v_fma_f32 v43, v43, v34, v33
    v_mul_f32 v36, v36, v192
    v_mul_f32 v37, v37, v193
    v_mul_f32 v38, v38, v194
    v_mul_f32 v39, v39, v195
    v_mul_f32 v40, v40, v196
    v_mul_f32 v41, v41, v197
    v_mul_f32 v42, v42, v198
    v_mul_f32 v43, v43, v199
    v_exp_f32 v36, v36
    v_mul_f32 v192, v192, v200
    v_exp_f32 v37, v37
    v_mul_f32 v193, v193, v201
    v_exp_f32 v38, v38
    v_mul_f32 v194, v194, v202
    v_exp_f32 v39, v39
    v_mul_f32 v195, v195, v203
    v_exp_f32 v40, v40
    v_mul_f32 v196, v196, v204
    v_exp_f32 v41, v41
    v_mul_f32 v197, v197, v205
    v_exp_f32 v42, v42
    v_mul_f32 v198, v198, v206
    v_exp_f32 v43, v43
    v_mul_f32 v199, v199, v207
    v_fma_f32 v36, v36, v10, v10
    v_fma_f32 v37, v37, v10, v10
    v_fma_f32 v38, v38, v10, v10
    v_fma_f32 v39, v39, v10, v10
    v_fma_f32 v40, v40, v10, v10
    v_fma_f32 v41, v41, v10, v10
    v_fma_f32 v42, v42, v10, v10
    v_fma_f32 v43, v43, v10, v10
    v_rcp_f32 v36, v36
    v_rcp_f32 v37, v37
    v_rcp_f32 v38, v38
    v_rcp_f32 v39, v39
    v_rcp_f32 v40, v40
    v_rcp_f32 v41, v41
    v_rcp_f32 v42, v42
    v_rcp_f32 v43, v43
    s_add_u32 s58, s66, 4096
    v_mul_f32 v192, v192, v36
    v_mul_f32 v193, v193, v37
    v_mul_f32 v194, v194, v38
    v_mul_f32 v195, v195, v39
    v_mul_f32 v196, v196, v40
    v_mul_f32 v197, v197, v41
    v_mul_f32 v198, v198, v42
    v_mul_f32 v199, v199, v43
    v_cvt_pk_bf16_f32 v200, v192, v193
    v_cvt_pk_bf16_f32 v201, v194, v195
    v_cvt_pk_bf16_f32 v202, v196, v197
    v_cvt_pk_bf16_f32 v203, v198, v199
    ds_write_b128 v11, v[184:187] offset:1024
L1_Ay:
    s_lshl_b32 s74, s51, 7
    s_lshl_b32 s58, s61, 2
    s_add_u32 s74, s74, s58
    s_add_u32 s74, s74, 15699968
    s_cmp_eq_u32 s60, 1
    s_cselect_b32 s74, 0x7f000000, s74
    s_cselect_b32 s66, 0x7f000000, s66
    v_mov_b32 v8, s74
    v_lshlrev_b32 v3, 4, v2
    v_mov_b32 v6, 130944
    s_mov_b32 s55, 0
    s_lshl_b32 s56, s72, 17
    s_lshl_b32 s57, s48, 15
    s_add_u32 s57, s57, s56
    s_add_u32 s57, s57, 0x200000
    s_add_u32 s61, s56, 0x200000
    s_add_u32 s28, s22, s57
    s_addc_u32 s29, s23, 0
    s_mov_b32 s30, 32768
    s_mov_b32 s31, 0x00020000
    s_add_u32 s32, s28, 0x200000
    s_addc_u32 s33, s29, 0
    s_mov_b32 s34, 32768
    s_mov_b32 s35, 0x00020000
    s_lshl_b32 s57, s72, 7
    s_add_u32 s57, s57, 15695872
    v_lshl_add_u32 v5, v2, 2, s57
    s_cmp_eq_u32 s60, 0
    s_cbranch_scc1 L2_qx
L2_q:
    ds_read_b32 v7, v6 offset:8
    s_waitcnt lgkmcnt(0)
    v_readfirstlane_b32 s57, v7
    s_cmp_lg_u32 s57, 4
    s_cbranch_scc1 L2_q
L2_qx:
    v_add_u32 v4, 65536, v3
    ds_read_b128 v[144:147], v4 offset:2048
    ds_read_b128 v[148:151], v4 offset:3072
    s_xor_b32 s57, s48, 3
    s_lshl_b32 s57, s57, 12
    v_add_u32 v7, s57, v4
    ds_read_b128 v[48:51], v7 offset:0
    ds_read_b128 v[52:55], v7 offset:1024
    s_xor_b32 s57, s48, 2
    s_lshl_b32 s57, s57, 12
    v_add_u32 v7, s57, v4
    ds_read_b128 v[56:59], v7 offset:0
    ds_read_b128 v[60:63], v7 offset:1024
    s_xor_b32 s57, s48, 1
    s_lshl_b32 s57, s57, 12
    v_add_u32 v7, s57, v4
    ds_read_b128 v[64:67], v7 offset:0
    ds_read_b128 v[68:71], v7 offset:1024
    s_xor_b32 s57, s48, 0
    s_lshl_b32 s57, s57, 12
    v_add_u32 v7, s57, v4
    ds_read_b128 v[72:75], v7 offset:0
    ds_read_b128 v[76:79], v7 offset:1024
    s_mov_b32 s62, s48
    s_cmp_eq_u32 s60, 1
    s_cbranch_scc1 L2_Ay
    s_cmp_lg_u32 s48, 0
    s_cselect_b32 s57, 0x7f000000, 0
    s_mov_b64 exec, 0xffffffff
    buffer_load_dword v9, v5, s[40:43], s57 offen sc1
    s_mov_b64 exec, -1
    v_mul_f32 v36, v208, v208
    v_mul_f32 v37, v209, v209
    v_mul_f32 v38, v210, v210
    v_mul_f32 v39, v211, v211
    v_mul_f32 v40, v212, v212
    v_mul_f32 v41, v213, v213
    v_mul_f32 v42, v214, v214
    v_mul_f32 v43, v215, v215
    v_fma_f32 v36, v36, v34, v33
    v_fma_f32 v37, v37, v34, v33
    v_fma_f32 v38, v38, v34, v33
    v_fma_f32 v39, v39, v34, v33
    v_fma_f32 v40, v40, v34, v33
    v_fma_f32 v41, v41, v34, v33
    v_fma_f32 v42, v42, v34, v33
    v_fma_f32 v43, v43, v34, v33
    v_mul_f32 v36, v36, v208
    v_mul_f32 v37, v37, v209
    v_mul_f32 v38, v38, v210
    v_mul_f32 v39, v39, v211
    v_mul_f32 v40, v40, v212
    v_mul_f32 v41, v41, v213
    v_mul_f32 v42, v42, v214
    v_mul_f32 v43, v43, v215
    v_exp_f32 v36, v36
    v_mul_f32 v208, v208, v216
    v_exp_f32 v37, v37
    v_mul_f32 v209, v209, v217
    v_exp_f32 v38, v38
    v_mul_f32 v210, v210, v218
    v_exp_f32 v39, v39
    v_mul_f32 v211, v211, v219
    v_exp_f32 v40, v40
    v_mul_f32 v212, v212, v220
    v_exp_f32 v41, v41
    v_mul_f32 v213, v213, v221
    v_exp_f32 v42, v42
    v_mul_f32 v214, v214, v222
    v_exp_f32 v43, v43
    v_mul_f32 v215, v215, v223
    v_fma_f32 v36, v36, v10, v10
    v_fma_f32 v37, v37, v10, v10
    v_fma_f32 v38, v38, v10, v10
    v_fma_f32 v39, v39, v10, v10
    v_fma_f32 v40, v40, v10, v10
    v_fma_f32 v41, v41, v10, v10
    v_fma_f32 v42, v42, v10, v10
    s_waitcnt vmcnt(0)
    v_cmp_ne_u32 vcc, s95, v9
    v_mov_b32 v7, 1
    s_cmp_lg_u32 vcc_lo, 0
    s_cbranch_scc1 L2_Ax
    ds_write_b32 v6, v7 offset:52
    s_mov_b32 s62, 1
L2_Ax:
    ds_write_b128 v11, v[200:203] offset:2048
    v_fma_f32 v43, v43, v10, v10
    v_rcp_f32 v36, v36
    v_rcp_f32 v37, v37
    v_rcp_f32 v38, v38
    v_rcp_f32 v39, v39
    v_rcp_f32 v40, v40
    v_rcp_f32 v41, v41
    v_rcp_f32 v42, v42
    v_rcp_f32 v43, v43
    s_add_u32 s58, s66, 6144
    v_mul_f32 v208, v208, v36
    v_mul_f32 v209, v209, v37
    v_mul_f32 v210, v210, v38
    v_mul_f32 v211, v211, v39
    v_mul_f32 v212, v212, v40
    v_mul_f32 v213, v213, v41
    v_mul_f32 v214, v214, v42
    v_mul_f32 v215, v215, v43
    v_cvt_pk_bf16_f32 v216, v208, v209
    v_cvt_pk_bf16_f32 v217, v210, v211
    v_cvt_pk_bf16_f32 v218, v212, v213
    v_cvt_pk_bf16_f32 v219, v214, v215
    ds_write_b128 v11, v[216:219] offset:3072
    s_lshl_b32 s57, s48, 2
    v_add_u32 v4, s57, v6
    v_mov_b32 v7, 1
    ds_write_b32 v4, v7 offset:112
L2_Ay:
    s_cmp_lg_u32 s62, 0
    s_cbranch_scc1 L2_Aww
    s_mov_b32 s65, 0x40000
    s_mov_b64 exec, 0xffffffff
L2_Aw:
    buffer_load_dword v7, v5, s[40:43], 0 offen sc1
    s_sub_u32 s65, s65, 1
    s_cmp_eq_u32 s65, 0
    s_cbranch_scc1 L2_Awx
    s_waitcnt vmcnt(0)
    v_cmp_ne_u32 vcc, s95, v7
    s_cbranch_vccz L2_Awx
    s_mov_b64 exec, vcc
    s_sleep 4
    s_branch L2_Aw
L2_Awx:
    s_mov_b64 exec, -1
    v_mov_b32 v7, 1
    ds_write_b32 v6, v7 offset:52
    s_branch L2_Awd
L2_Aww:
    ds_read_b32 v7, v6 offset:52
    s_waitcnt lgkmcnt(0)
    v_readfirstlane_b32 s65, v7
    s_cmp_eq_u32 s65, 1
    s_cbranch_scc1 L2_Awd
    s_sleep 1
    s_branch L2_Aww
L2_Awd:
    s_waitcnt lgkmcnt(0)
    v_mov_b32 v7, 1
    s_mov_b64 exec, 1
    ds_add_u32 v6, v7 offset:72
    s_mov_b64 exec, -1
L2_Astart:
    s_and_b32 s78, s73, 3
    s_lshl_b32 s78, s78, 11
    s_xor_b32 s79, s78, 2048
    s_xor_b32 s57, s78, 4096
    s_setprio 3
    buffer_load_dwordx4 v[80:83], v3, s[28:31], s78 offen offset:0 sc1
    buffer_load_dwordx4 v[84:87], v3, s[28:31], s78 offen offset:1024 sc1
    buffer_load_dwordx4 v[112:115], v3, s[32:35], s78 offen offset:0 sc1
    buffer_load_dwordx4 v[116:119], v3, s[32:35], s78 offen offset:1024 sc1
    buffer_load_dwordx4 v[88:91], v3, s[28:31], s79 offen offset:0 sc1
    buffer_load_dwordx4 v[92:95], v3, s[28:31], s79 offen offset:1024 sc1
    v_mov_b32 v136, 0
    v_mov_b32 v152, 0
    v_mov_b32 v137, 0
    v_mov_b32 v153, 0
    v_mov_b32 v138, 0
    v_mov_b32 v154, 0
    v_mov_b32 v139, 0
    v_mov_b32 v155, 0
    v_mov_b32 v140, 0
    v_mov_b32 v156, 0
    v_mov_b32 v141, 0
    v_mov_b32 v157, 0
    v_mov_b32 v142, 0
    v_mov_b32 v158, 0
    v_mov_b32 v143, 0
    v_mov_b32 v159, 0
    buffer_load_dwordx4 v[120:123], v3, s[32:35], s79 offen offset:0 sc1
    buffer_load_dwordx4 v[124:127], v3, s[32:35], s79 offen offset:1024 sc1
    buffer_load_dwordx4 v[96:99], v3, s[28:31], s57 offen offset:0 sc1
    buffer_load_dwordx4 v[100:103], v3, s[28:31], s57 offen offset:1024 sc1
    v_mfma_f32_32x32x16_bf16 v[160:175], v[152:155], v[152:155], 0
    v_mfma_f32_32x32x16_bf16 v[176:191], v[152:155], v[152:155], 0
    v_mfma_f32_32x32x16_bf16 v[192:207], v[152:155], v[152:155], 0
    v_mfma_f32_32x32x16_bf16 v[208:223], v[152:155], v[152:155], 0
    s_cmp_eq_u32 s55, 1
    s_cbranch_scc1 L2_truemax
    v_mfma_f32_32x32x16_bf16 v[224:239], v[144:147], v[48:51], 0
    v_mfma_f32_32x32x16_bf16 v[224:239], v[148:151], v[52:55], v[224:239]
    v_mfma_f32_32x32x16_bf16 v[240:255], v[144:147], v[56:59], 0
    v_mfma_f32_32x32x16_bf16 v[240:255], v[148:151], v[60:63], v[240:255]
    s_nop 7
    s_nop 1
    v_max3_f32 v16, v224, v225, v226
    v_max3_f32 v20, v227, v228, v229
    v_max3_f32 v16, v16, v230, v231
    v_max3_f32 v20, v20, v232, v233
    v_max3_f32 v16, v16, v234, v235
    v_max3_f32 v20, v20, v236, v237
    v_max3_f32 v16, v16, v238, v239
    v_max_f32 v16, v16, v20
    v_mfma_f32_32x32x16_bf16 v[224:239], v[144:147], v[64:67], 0
    v_mfma_f32_32x32x16_bf16 v[224:239], v[148:151], v[68:71], v[224:239]
    v_max3_f32 v17, v240, v241, v242
    v_max3_f32 v20, v243, v244, v245
    v_max3_f32 v17, v17, v246, v247
    v_max3_f32 v20, v20, v248, v249
    v_max3_f32 v17, v17, v250, v251
    v_max3_f32 v20, v20, v252, v253
    v_max3_f32 v17, v17, v254, v255
    v_max_f32 v17, v17, v20
    v_mfma_f32_32x32x16_bf16 v[240:255], v[144:147], v[72:75], 0
    v_mfma_f32_32x32x16_bf16 v[240:255], v[148:151], v[76:79], v[240:255]
    s_nop 1
    v_max3_f32 v18, v224, v225, v226
    v_max3_f32 v20, v227, v228, v229
    v_max3_f32 v18, v18, v230, v231
    v_max3_f32 v20, v20, v232, v233
    v_max3_f32 v18, v18, v234, v235
    v_max3_f32 v20, v20, v236, v237
    v_max3_f32 v18, v18, v238, v239
    v_max_f32 v18, v18, v20
    s_nop 1
    v_max3_f32 v19, v240, v241, v242
    v_max3_f32 v20, v243, v244, v245
    v_max3_f32 v19, v19, v246, v247
    v_max3_f32 v20, v20, v248, v249
    v_max3_f32 v19, v19, v250, v251
    v_max3_f32 v20, v20, v252, v253
    v_max3_f32 v19, v19, v254, v255
    v_max_f32 v19, v19, v20
    s_mov_b32 s58, 0xc2c00000
    s_mov_b32 s64, 0x44000000
    v_max3_f32 v28, abs(v16), abs(v17), abs(v18)
    v_max_f32 v28, abs(v19), v28
    v_cvt_pk_bf16_f32 v20, -v16, s58
    v_cvt_pk_bf16_f32 v21, -v17, s58
    v_cvt_pk_bf16_f32 v22, -v18, s58
    v_cvt_pk_bf16_f32 v23, -v19, s58
    v_cmp_le_f32 s[76:77], s64, v28
L2_setm:
    v_cndmask_b32 v54, v54, v20, s[92:93]
    v_cndmask_b32 v62, v62, v21, s[92:93]
    v_cndmask_b32 v70, v70, v22, s[92:93]
    v_cndmask_b32 v78, v78, v23, s[92:93]
    buffer_load_dwordx4 v[128:131], v3, s[32:35], s57 offen offset:0 sc1
    buffer_load_dwordx4 v[132:135], v3, s[32:35], s57 offen offset:1024 sc1
    s_waitcnt vmcnt(10)
    v_mfma_f32_32x32x16_bf16 v[224:239], v[80:83], v[48:51], 0
    v_mfma_f32_32x32x16_bf16 v[224:239], v[84:87], v[52:55], v[224:239]
    s_nop 7
    s_setprio 1
    s_xor_b32 s63, s78, 6144
    s_mov_b32 s64, 6144
    s_mov_b32 s65, 4
    s_xor_b32 s66, s48, 3
    s_mul_i32 s66, s66, 12288
    s_add_u32 s66, s66, 0
    v_add_u32 v10, s66, v3
    s_xor_b32 s66, s48, 2
    s_mul_i32 s66, s66, 12288
    s_add_u32 s66, s66, 4096
    v_add_u32 v11, s66, v3
    s_xor_b32 s66, s48, 1
    s_mul_i32 s66, s66, 12288
    s_add_u32 s66, s66, 8192
    v_add_u32 v12, s66, v3
L2_loop:
    v_mfma_f32_32x32x16_bf16 v[240:255], v[80:83], v[56:59], 0
    v_exp_f32 v224, v224
    v_exp_f32 v225, v225
    v_exp_f32 v226, v226
    v_mfma_f32_32x32x16_bf16 v[240:255], v[84:87], v[60:63], v[240:255]
    v_exp_f32 v227, v227
    v_exp_f32 v228, v228
    v_exp_f32 v229, v229
    v_mfma_f32_32x32x16_bf16 v[208:223], v[136:139], v[152:155], v[208:223]
    v_exp_f32 v230, v230
    v_exp_f32 v231, v231
    v_exp_f32 v232, v232
    v_mfma_f32_32x32x16_bf16 v[208:223], v[140:143], v[156:159], v[208:223]
    v_cvt_pk_bf16_f32 v144, v224, v225
    v_cvt_pk_bf16_f32 v145, v226, v227
    v_exp_f32 v233, v233
    v_exp_f32 v234, v234
    v_exp_f32 v235, v235
    v_cvt_pk_bf16_f32 v146, v228, v229
    v_cvt_pk_bf16_f32 v147, v230, v231
    v_exp_f32 v236, v236
    v_exp_f32 v237, v237
    v_exp_f32 v238, v238
    v_exp_f32 v239, v239
    v_cvt_pk_bf16_f32 v148, v232, v233
    v_cvt_pk_bf16_f32 v149, v234, v235
    v_cvt_pk_bf16_f32 v150, v236, v237
    v_cvt_pk_bf16_f32 v151, v238, v239
    v_mfma_f32_32x32x16_bf16 v[224:239], v[80:83], v[64:67], 0
    v_exp_f32 v240, v240
    v_exp_f32 v241, v241
    v_exp_f32 v242, v242
    v_mfma_f32_32x32x16_bf16 v[224:239], v[84:87], v[68:71], v[224:239]
    v_exp_f32 v243, v243
    v_exp_f32 v244, v244
    v_exp_f32 v245, v245
    s_waitcnt vmcnt(8)
    v_mfma_f32_32x32x16_bf16 v[160:175], v[112:115], v[144:147], v[160:175]
    v_exp_f32 v246, v246
    v_exp_f32 v247, v247
    v_exp_f32 v248, v248
    v_mfma_f32_32x32x16_bf16 v[160:175], v[116:119], v[148:151], v[160:175]
    buffer_load_dwordx4 v[104:107], v3, s[28:31], s63 offen offset:0 sc1
    buffer_load_dwordx4 v[108:111], v3, s[28:31], s63 offen offset:1024 sc1
    buffer_load_dwordx4 v[136:139], v3, s[32:35], s63 offen offset:0 sc1
    buffer_load_dwordx4 v[140:143], v3, s[32:35], s63 offen offset:1024 sc1
    s_add_u32 s64, s64, 2048
    s_xor_b32 s63, s64, s78
    v_cvt_pk_bf16_f32 v152, v240, v241
    v_cvt_pk_bf16_f32 v153, v242, v243
    v_exp_f32 v249, v249
    v_exp_f32 v250, v250
    v_exp_f32 v251, v251
    v_cvt_pk_bf16_f32 v154, v244, v245
    v_cvt_pk_bf16_f32 v155, v246, v247
    v_exp_f32 v252, v252
    v_exp_f32 v253, v253
    v_exp_f32 v254, v254
    v_exp_f32 v255, v255
    v_cvt_pk_bf16_f32 v156, v248, v249
    v_cvt_pk_bf16_f32 v157, v250, v251
    v_cvt_pk_bf16_f32 v158, v252, v253
    v_cvt_pk_bf16_f32 v159, v254, v255
    v_mfma_f32_32x32x16_bf16 v[240:255], v[80:83], v[72:75], 0
    v_exp_f32 v224, v224
    v_exp_f32 v225, v225
    v_exp_f32 v226, v226
    v_mfma_f32_32x32x16_bf16 v[240:255], v[84:87], v[76:79], v[240:255]
    v_exp_f32 v227, v227
    v_exp_f32 v228, v228
    v_exp_f32 v229, v229
    v_mfma_f32_32x32x16_bf16 v[176:191], v[112:115], v[152:155], v[176:191]
    v_exp_f32 v230, v230
    v_exp_f32 v231, v231
    v_exp_f32 v232, v232
    v_mfma_f32_32x32x16_bf16 v[176:191], v[116:119], v[156:159], v[176:191]
    v_cvt_pk_bf16_f32 v144, v224, v225
    v_cvt_pk_bf16_f32 v145, v226, v227
    v_exp_f32 v233, v233
    v_exp_f32 v234, v234
    v_exp_f32 v235, v235
    v_cvt_pk_bf16_f32 v146, v228, v229
    v_cvt_pk_bf16_f32 v147, v230, v231
    v_exp_f32 v236, v236
    v_exp_f32 v237, v237
    v_exp_f32 v238, v238
    v_exp_f32 v239, v239
    v_cvt_pk_bf16_f32 v148, v232, v233
    v_cvt_pk_bf16_f32 v149, v234, v235
    v_cvt_pk_bf16_f32 v150, v236, v237
    v_cvt_pk_bf16_f32 v151, v238, v239
    s_waitcnt vmcnt(10)
    v_mfma_f32_32x32x16_bf16 v[224:239], v[88:91], v[48:51], 0
    v_exp_f32 v240, v240
    v_exp_f32 v241, v241
    v_exp_f32 v242, v242
    v_mfma_f32_32x32x16_bf16 v[224:239], v[92:95], v[52:55], v[224:239]
    v_exp_f32 v243, v243
    v_exp_f32 v244, v244
    v_exp_f32 v245, v245
    v_mfma_f32_32x32x16_bf16 v[192:207], v[112:115], v[144:147], v[192:207]
    v_exp_f32 v246, v246
    v_exp_f32 v247, v247
    v_exp_f32 v248, v248
    v_mfma_f32_32x32x16_bf16 v[192:207], v[116:119], v[148:151], v[192:207]
    v_cvt_pk_bf16_f32 v152, v240, v241
    v_cvt_pk_bf16_f32 v153, v242, v243
    v_exp_f32 v249, v249
    v_exp_f32 v250, v250
    v_exp_f32 v251, v251
    v_cvt_pk_bf16_f32 v154, v244, v245
    v_cvt_pk_bf16_f32 v155, v246, v247
    v_exp_f32 v252, v252
    v_exp_f32 v253, v253
    v_exp_f32 v254, v254
    v_exp_f32 v255, v255
    v_cvt_pk_bf16_f32 v156, v248, v249
    v_cvt_pk_bf16_f32 v157, v250, v251
    v_cvt_pk_bf16_f32 v158, v252, v253
    v_cvt_pk_bf16_f32 v159, v254, v255
    v_mfma_f32_32x32x16_bf16 v[240:255], v[88:91], v[56:59], 0
    v_exp_f32 v224, v224
    v_exp_f32 v225, v225
    v_exp_f32 v226, v226
    v_mfma_f32_32x32x16_bf16 v[240:255], v[92:95], v[60:63], v[240:255]
    v_exp_f32 v227, v227
    v_exp_f32 v228, v228
    v_exp_f32 v229, v229
    v_mfma_f32_32x32x16_bf16 v[208:223], v[112:115], v[152:155], v[208:223]
    v_exp_f32 v230, v230
    v_exp_f32 v231, v231
    v_exp_f32 v232, v232
    v_mfma_f32_32x32x16_bf16 v[208:223], v[116:119], v[156:159], v[208:223]
    v_cvt_pk_bf16_f32 v144, v224, v225
    v_cvt_pk_bf16_f32 v145, v226, v227
    v_exp_f32 v233, v233
    v_exp_f32 v234, v234
    v_exp_f32 v235, v235
    v_cvt_pk_bf16_f32 v146, v228, v229
    v_cvt_pk_bf16_f32 v147, v230, v231
    v_exp_f32 v236, v236
    v_exp_f32 v237, v237
    v_exp_f32 v238, v238
    v_exp_f32 v239, v239
    v_cvt_pk_bf16_f32 v148, v232, v233
    v_cvt_pk_bf16_f32 v149, v234, v235
    v_cvt_pk_bf16_f32 v150, v236, v237
    v_cvt_pk_bf16_f32 v151, v238, v239
    v_mfma_f32_32x32x16_bf16 v[224:239], v[88:91], v[64:67], 0
    v_exp_f32 v240, v240
    v_exp_f32 v241, v241
    v_exp_f32 v242, v242
    v_mfma_f32_32x32x16_bf16 v[224:239], v[92:95], v[68:71], v[224:239]
    v_exp_f32 v243, v243
    v_exp_f32 v244, v244
    v_exp_f32 v245, v245
    s_waitcnt vmcnt(8)
    v_mfma_f32_32x32x16_bf16 v[160:175], v[120:123], v[144:147], v[160:175]
    v_exp_f32 v246, v246
    v_exp_f32 v247, v247
    v_exp_f32 v248, v248
    v_mfma_f32_32x32x16_bf16 v[160:175], v[124:127], v[148:151], v[160:175]
    s_cmp_eq_u32 s65, 1
    s_cbranch_scc1 L2_nl1
    buffer_load_dwordx4 v[80:83], v3, s[28:31], s63 offen offset:0 sc1
    buffer_load_dwordx4 v[84:87], v3, s[28:31], s63 offen offset:1024 sc1
    buffer_load_dwordx4 v[112:115], v3, s[32:35], s63 offen offset:0 sc1
    buffer_load_dwordx4 v[116:119], v3, s[32:35], s63 offen offset:1024 sc1
    s_add_u32 s64, s64, 2048
    s_xor_b32 s63, s64, s78
L2_nr1:
    v_cvt_pk_bf16_f32 v152, v240, v241
    v_cvt_pk_bf16_f32 v153, v242, v243
    v_exp_f32 v249, v249
    v_exp_f32 v250, v250
    v_exp_f32 v251, v251
    v_cvt_pk_bf16_f32 v154, v244, v245
    v_cvt_pk_bf16_f32 v155, v246, v247
    v_exp_f32 v252, v252
    v_exp_f32 v253, v253
    v_exp_f32 v254, v254
    v_exp_f32 v255, v255
    v_cvt_pk_bf16_f32 v156, v248, v249
    v_cvt_pk_bf16_f32 v157, v250, v251
    v_cvt_pk_bf16_f32 v158, v252, v253
    v_cvt_pk_bf16_f32 v159, v254, v255
    v_mfma_f32_32x32x16_bf16 v[240:255], v[88:91], v[72:75], 0
    v_exp_f32 v224, v224
    v_exp_f32 v225, v225
    v_exp_f32 v226, v226
    v_mfma_f32_32x32x16_bf16 v[240:255], v[92:95], v[76:79], v[240:255]
    v_exp_f32 v227, v227
    v_exp_f32 v228, v228
    v_exp_f32 v229, v229
    v_mfma_f32_32x32x16_bf16 v[176:191], v[120:123], v[152:155], v[176:191]
    v_exp_f32 v230, v230
    v_exp_f32 v231, v231
    v_exp_f32 v232, v232
    v_mfma_f32_32x32x16_bf16 v[176:191], v[124:127], v[156:159], v[176:191]
    v_cvt_pk_bf16_f32 v144, v224, v225
    v_cvt_pk_bf16_f32 v145, v226, v227
    v_exp_f32 v233, v233
    v_exp_f32 v234, v234
    v_exp_f32 v235, v235
    v_cvt_pk_bf16_f32 v146, v228, v229
    v_cvt_pk_bf16_f32 v147, v230, v231
    v_exp_f32 v236, v236
    v_exp_f32 v237, v237
    v_exp_f32 v238, v238
    v_exp_f32 v239, v239
    v_cvt_pk_bf16_f32 v148, v232, v233
    v_cvt_pk_bf16_f32 v149, v234, v235
    v_cvt_pk_bf16_f32 v150, v236, v237
    v_cvt_pk_bf16_f32 v151, v238, v239
    s_waitcnt vmcnt(10)
    v_mfma_f32_32x32x16_bf16 v[224:239], v[96:99], v[48:51], 0
    v_exp_f32 v240, v240
    v_exp_f32 v241, v241
    v_exp_f32 v242, v242
    v_mfma_f32_32x32x16_bf16 v[224:239], v[100:103], v[52:55], v[224:239]
    v_exp_f32 v243, v243
    v_exp_f32 v244, v244
    v_exp_f32 v245, v245
    v_mfma_f32_32x32x16_bf16 v[192:207], v[120:123], v[144:147], v[192:207]
    v_exp_f32 v246, v246
    v_exp_f32 v247, v247
    v_exp_f32 v248, v248
    v_mfma_f32_32x32x16_bf16 v[192:207], v[124:127], v[148:151], v[192:207]
    v_cvt_pk_bf16_f32 v152, v240, v241
    v_cvt_pk_bf16_f32 v153, v242, v243
    v_exp_f32 v249, v249
    v_exp_f32 v250, v250
    v_exp_f32 v251, v251
    v_cvt_pk_bf16_f32 v154, v244, v245
    v_cvt_pk_bf16_f32 v155, v246, v247
    v_exp_f32 v252, v252
    v_exp_f32 v253, v253
    v_exp_f32 v254, v254
    v_exp_f32 v255, v255
    v_cvt_pk_bf16_f32 v156, v248, v249
    v_cvt_pk_bf16_f32 v157, v250, v251
    v_cvt_pk_bf16_f32 v158, v252, v253
    v_cvt_pk_bf16_f32 v159, v254, v255
    v_mfma_f32_32x32x16_bf16 v[240:255], v[96:99], v[56:59], 0
    v_exp_f32 v224, v224
    v_exp_f32 v225, v225
    v_exp_f32 v226, v226
    v_mfma_f32_32x32x16_bf16 v[240:255], v[100:103], v[60:63], v[240:255]
    v_exp_f32 v227, v227
    v_exp_f32 v228, v228
    v_exp_f32 v229, v229
    v_mfma_f32_32x32x16_bf16 v[208:223], v[120:123], v[152:155], v[208:223]
    v_exp_f32 v230, v230
    v_exp_f32 v231, v231
    v_exp_f32 v232, v232
    v_mfma_f32_32x32x16_bf16 v[208:223], v[124:127], v[156:159], v[208:223]
    v_cvt_pk_bf16_f32 v144, v224, v225
    v_cvt_pk_bf16_f32 v145, v226, v227
    v_exp_f32 v233, v233
    v_exp_f32 v234, v234
    v_exp_f32 v235, v235
    v_cvt_pk_bf16_f32 v146, v228, v229
    v_cvt_pk_bf16_f32 v147, v230, v231
    v_exp_f32 v236, v236
    v_exp_f32 v237, v237
    v_exp_f32 v238, v238
    v_exp_f32 v239, v239
    v_cvt_pk_bf16_f32 v148, v232, v233
    v_cvt_pk_bf16_f32 v149, v234, v235
    v_cvt_pk_bf16_f32 v150, v236, v237
    v_cvt_pk_bf16_f32 v151, v238, v239
    v_mfma_f32_32x32x16_bf16 v[224:239], v[96:99], v[64:67], 0
    v_exp_f32 v240, v240
    v_exp_f32 v241, v241
    v_exp_f32 v242, v242
    v_mfma_f32_32x32x16_bf16 v[224:239], v[100:103], v[68:71], v[224:239]
    v_exp_f32 v243, v243
    v_exp_f32 v244, v244
    v_exp_f32 v245, v245
    s_waitcnt vmcnt(8)
    v_mfma_f32_32x32x16_bf16 v[160:175], v[128:131], v[144:147], v[160:175]
    v_exp_f32 v246, v246
    v_exp_f32 v247, v247
    v_exp_f32 v248, v248
    v_mfma_f32_32x32x16_bf16 v[160:175], v[132:135], v[148:151], v[160:175]
    s_cmp_eq_u32 s65, 1
    s_cbranch_scc1 L2_nl2
    buffer_load_dwordx4 v[88:91], v3, s[28:31], s63 offen offset:0 sc1
    buffer_load_dwordx4 v[92:95], v3, s[28:31], s63 offen offset:1024 sc1
    buffer_load_dwordx4 v[120:123], v3, s[32:35], s63 offen offset:0 sc1
    buffer_load_dwordx4 v[124:127], v3, s[32:35], s63 offen offset:1024 sc1
    s_add_u32 s64, s64, 2048
    s_xor_b32 s63, s64, s78
L2_nl2:
    v_cvt_pk_bf16_f32 v152, v240, v241
    v_cvt_pk_bf16_f32 v153, v242, v243
    v_exp_f32 v249, v249
    v_exp_f32 v250, v250
    v_exp_f32 v251, v251
    v_cvt_pk_bf16_f32 v154, v244, v245
    v_cvt_pk_bf16_f32 v155, v246, v247
    v_exp_f32 v252, v252
    v_exp_f32 v253, v253
    v_exp_f32 v254, v254
    v_exp_f32 v255, v255
    v_cvt_pk_bf16_f32 v156, v248, v249
    v_cvt_pk_bf16_f32 v157, v250, v251
    v_cvt_pk_bf16_f32 v158, v252, v253
    v_cvt_pk_bf16_f32 v159, v254, v255
    v_mfma_f32_32x32x16_bf16 v[240:255], v[96:99], v[72:75], 0
    v_exp_f32 v224, v224
    v_exp_f32 v225, v225
    v_exp_f32 v226, v226
    v_mfma_f32_32x32x16_bf16 v[240:255], v[100:103], v[76:79], v[240:255]
    v_exp_f32 v227, v227
    v_exp_f32 v228, v228
    v_exp_f32 v229, v229
    v_mfma_f32_32x32x16_bf16 v[176:191], v[128:131], v[152:155], v[176:191]
    v_exp_f32 v230, v230
    v_exp_f32 v231, v231
    v_exp_f32 v232, v232
    v_mfma_f32_32x32x16_bf16 v[176:191], v[132:135], v[156:159], v[176:191]
    v_cvt_pk_bf16_f32 v144, v224, v225
    v_cvt_pk_bf16_f32 v145, v226, v227
    v_exp_f32 v233, v233
    v_exp_f32 v234, v234
    v_exp_f32 v235, v235
    v_cvt_pk_bf16_f32 v146, v228, v229
    v_cvt_pk_bf16_f32 v147, v230, v231
    v_exp_f32 v236, v236
    v_exp_f32 v237, v237
    v_exp_f32 v238, v238
    v_exp_f32 v239, v239
    v_cvt_pk_bf16_f32 v148, v232, v233
    v_cvt_pk_bf16_f32 v149, v234, v235
    v_cvt_pk_bf16_f32 v150, v236, v237
    v_cvt_pk_bf16_f32 v151, v238, v239
    s_waitcnt vmcnt(10)
    v_mfma_f32_32x32x16_bf16 v[224:239], v[104:107], v[48:51], 0
    v_exp_f32 v240, v240
    v_exp_f32 v241, v241
    v_exp_f32 v242, v242
    v_mfma_f32_32x32x16_bf16 v[224:239], v[108:111], v[52:55], v[224:239]
    v_exp_f32 v243, v243
    v_exp_f32 v244, v244
    v_exp_f32 v245, v245
    v_mfma_f32_32x32x16_bf16 v[192:207], v[128:131], v[144:147], v[192:207]
    v_exp_f32 v246, v246
    v_exp_f32 v247, v247
    v_exp_f32 v248, v248
    v_mfma_f32_32x32x16_bf16 v[192:207], v[132:135], v[148:151], v[192:207]
    v_cvt_pk_bf16_f32 v152, v240, v241
    v_cvt_pk_bf16_f32 v153, v242, v243
    v_exp_f32 v249, v249
    v_exp_f32 v250, v250
    v_exp_f32 v251, v251
    v_cvt_pk_bf16_f32 v154, v244, v245
    v_cvt_pk_bf16_f32 v155, v246, v247
    v_exp_f32 v252, v252
    v_exp_f32 v253, v253
    v_exp_f32 v254, v254
    v_exp_f32 v255, v255
    v_cvt_pk_bf16_f32 v156, v248, v249
    v_cvt_pk_bf16_f32 v157, v250, v251
    v_cvt_pk_bf16_f32 v158, v252, v253
    v_cvt_pk_bf16_f32 v159, v254, v255
    v_mfma_f32_32x32x16_bf16 v[240:255], v[104:107], v[56:59], 0
    v_exp_f32 v224, v224
    v_exp_f32 v225, v225
    v_exp_f32 v226, v226
    v_mfma_f32_32x32x16_bf16 v[240:255], v[108:111], v[60:63], v[240:255]
    v_exp_f32 v227, v227
    v_exp_f32 v228, v228
    v_exp_f32 v229, v229
    v_mfma_f32_32x32x16_bf16 v[208:223], v[128:131], v[152:155], v[208:223]
    v_exp_f32 v230, v230
    v_exp_f32 v231, v231
    v_exp_f32 v232, v232
    v_mfma_f32_32x32x16_bf16 v[208:223], v[132:135], v[156:159], v[208:223]
    v_cvt_pk_bf16_f32 v144, v224, v225
    v_cvt_pk_bf16_f32 v145, v226, v227
    v_exp_f32 v233, v233
    v_exp_f32 v234, v234
    v_exp_f32 v235, v235
    v_cvt_pk_bf16_f32 v146, v228, v229
    v_cvt_pk_bf16_f32 v147, v230, v231
    v_exp_f32 v236, v236
    v_exp_f32 v237, v237
    v_exp_f32 v238, v238
    v_exp_f32 v239, v239
    v_cvt_pk_bf16_f32 v148, v232, v233
    v_cvt_pk_bf16_f32 v149, v234, v235
    v_cvt_pk_bf16_f32 v150, v236, v237
    v_cvt_pk_bf16_f32 v151, v238, v239
    v_mfma_f32_32x32x16_bf16 v[224:239], v[104:107], v[64:67], 0
    v_exp_f32 v240, v240
    v_exp_f32 v241, v241
    v_exp_f32 v242, v242
    v_mfma_f32_32x32x16_bf16 v[224:239], v[108:111], v[68:71], v[224:239]
    v_exp_f32 v243, v243
    v_exp_f32 v244, v244
    v_exp_f32 v245, v245
    s_waitcnt vmcnt(8)
    v_mfma_f32_32x32x16_bf16 v[160:175], v[136:139], v[144:147], v[160:175]
    v_exp_f32 v246, v246
    v_exp_f32 v247, v247
    v_exp_f32 v248, v248
    v_mfma_f32_32x32x16_bf16 v[160:175], v[140:143], v[148:151], v[160:175]
    s_cmp_eq_u32 s65, 1
    s_cbranch_scc1 L2_nl3
    buffer_load_dwordx4 v[96:99], v3, s[28:31], s63 offen offset:0 sc1
    buffer_load_dwordx4 v[100:103], v3, s[28:31], s63 offen offset:1024 sc1
    buffer_load_dwordx4 v[128:131], v3, s[32:35], s63 offen offset:0 sc1
    buffer_load_dwordx4 v[132:135], v3, s[32:35], s63 offen offset:1024 sc1
    s_add_u32 s64, s64, 2048
    s_xor_b32 s63, s64, s78
L2_nl3:
    v_cvt_pk_bf16_f32 v152, v240, v241
    v_cvt_pk_bf16_f32 v153, v242, v243
    v_exp_f32 v249, v249
    v_exp_f32 v250, v250
    v_exp_f32 v251, v251
    v_cvt_pk_bf16_f32 v154, v244, v245
    v_cvt_pk_bf16_f32 v155, v246, v247
    v_exp_f32 v252, v252
    v_exp_f32 v253, v253
    v_exp_f32 v254, v254
    v_exp_f32 v255, v255
    v_cvt_pk_bf16_f32 v156, v248, v249
    v_cvt_pk_bf16_f32 v157, v250, v251
    v_cvt_pk_bf16_f32 v158, v252, v253
    v_cvt_pk_bf16_f32 v159, v254, v255
    v_mfma_f32_32x32x16_bf16 v[240:255], v[104:107], v[72:75], 0
    v_exp_f32 v224, v224
    v_exp_f32 v225, v225
    v_exp_f32 v226, v226
    v_mfma_f32_32x32x16_bf16 v[240:255], v[108:111], v[76:79], v[240:255]
    v_exp_f32 v227, v227
    v_exp_f32 v228, v228
    v_exp_f32 v229, v229
    v_mfma_f32_32x32x16_bf16 v[176:191], v[136:139], v[152:155], v[176:191]
    v_exp_f32 v230, v230
    v_exp_f32 v231, v231
    v_exp_f32 v232, v232
    v_mfma_f32_32x32x16_bf16 v[176:191], v[140:143], v[156:159], v[176:191]
    s_cmp_eq_u32 s65, 1
    s_cbranch_scc1 L2_hd14
L2_hr14:
    v_cvt_pk_bf16_f32 v144, v224, v225
    v_cvt_pk_bf16_f32 v145, v226, v227
    v_exp_f32 v233, v233
    v_exp_f32 v234, v234
    v_exp_f32 v235, v235
    v_cvt_pk_bf16_f32 v146, v228, v229
    v_cvt_pk_bf16_f32 v147, v230, v231
    v_exp_f32 v236, v236
    v_exp_f32 v237, v237
    v_exp_f32 v238, v238
    v_exp_f32 v239, v239
    v_cvt_pk_bf16_f32 v148, v232, v233
    v_cvt_pk_bf16_f32 v149, v234, v235
    v_cvt_pk_bf16_f32 v150, v236, v237
    v_cvt_pk_bf16_f32 v151, v238, v239
    s_waitcnt vmcnt(10)
    v_mfma_f32_32x32x16_bf16 v[224:239], v[80:83], v[48:51], 0
    v_exp_f32 v240, v240
    v_exp_f32 v241, v241
    v_exp_f32 v242, v242
    v_mfma_f32_32x32x16_bf16 v[224:239], v[84:87], v[52:55], v[224:239]
    v_exp_f32 v243, v243
    v_exp_f32 v244, v244
    v_exp_f32 v245, v245
    v_mfma_f32_32x32x16_bf16 v[192:207], v[136:139], v[144:147], v[192:207]
    v_exp_f32 v246, v246
    v_exp_f32 v247, v247
    v_exp_f32 v248, v248
    v_mfma_f32_32x32x16_bf16 v[192:207], v[140:143], v[148:151], v[192:207]
    s_cmp_eq_u32 s65, 1
    s_cbranch_scc1 L2_hd15
L2_hr15:
    s_sub_u32 s65, s65, 1
    s_cmp_lg_u32 s65, 0
    v_cvt_pk_bf16_f32 v152, v240, v241
    v_cvt_pk_bf16_f32 v153, v242, v243
    v_exp_f32 v249, v249
    v_exp_f32 v250, v250
    v_exp_f32 v251, v251
    v_cvt_pk_bf16_f32 v154, v244, v245
    v_cvt_pk_bf16_f32 v155, v246, v247
    v_exp_f32 v252, v252
    v_exp_f32 v253, v253
    v_exp_f32 v254, v254
    v_exp_f32 v255, v255
    v_cvt_pk_bf16_f32 v156, v248, v249
    v_cvt_pk_bf16_f32 v157, v250, v251
    v_cvt_pk_bf16_f32 v158, v252, v253
    v_cvt_pk_bf16_f32 v159, v254, v255
    s_cbranch_scc1 L2_loop
    s_nop 0
    v_mfma_f32_32x32x16_bf16 v[208:223], v[136:139], v[152:155], v[208:223]
    v_mfma_f32_32x32x16_bf16 v[208:223], v[140:143], v[156:159], v[208:223]
    ds_write_b128 v12, v[192:195] offset:0
    ds_write_b128 v12, v[196:199] offset:1024
    ds_write_b128 v12, v[200:203] offset:2048
    ds_write_b128 v12, v[204:207] offset:3072
    s_lshl_b32 s67, s55, 2
    v_add_u32 v5, s67, v6
    v_mov_b32 v7, 1
    s_mov_b64 exec, 1
    ds_add_u32 v5, v7
    s_mov_b64 exec, -1
    s_mul_i32 s66, s48, 12288
    v_add_u32 v4, s66, v3
    s_mov_b32 s64, 0x7b800000
L2_rdy:
    ds_read_b32 v7, v5
    ds_read_b32 v8, v6 offset:12
    ds_read_b128 v[160:163], v4 offset:0
    ds_read_b128 v[164:167], v4 offset:1024
    ds_read_b128 v[168:171], v4 offset:2048
    ds_read_b128 v[172:175], v4 offset:3072
    ds_read_b128 v[176:179], v4 offset:4096
    ds_read_b128 v[180:183], v4 offset:5120
    ds_read_b128 v[184:187], v4 offset:6144
    ds_read_b128 v[188:191], v4 offset:7168
    ds_read_b128 v[192:195], v4 offset:8192
    ds_read_b128 v[196:199], v4 offset:9216
    ds_read_b128 v[200:203], v4 offset:10240
    ds_read_b128 v[204:207], v4 offset:11264
    s_waitcnt lgkmcnt(12)
    v_readfirstlane_b32 s66, v7
    v_readfirstlane_b32 s67, v8
    s_add_u32 s66, s66, s67
    s_cmp_lg_u32 s66, 8
    s_cbranch_scc1 L2_rdy
    s_waitcnt lgkmcnt(8)
    v_pk_add_f32 v[160:161], v[160:161], v[208:209]
    v_pk_add_f32 v[162:163], v[162:163], v[210:211]
    v_pk_add_f32 v[164:165], v[164:165], v[212:213]
    v_pk_add_f32 v[166:167], v[166:167], v[214:215]
    v_pk_add_f32 v[168:169], v[168:169], v[216:217]
    v_pk_add_f32 v[170:171], v[170:171], v[218:219]
    v_pk_add_f32 v[172:173], v[172:173], v[220:221]
    v_pk_add_f32 v[174:175], v[174:175], v[222:223]
    s_waitcnt lgkmcnt(0)
    v_pk_add_f32 v[192:193], v[192:193], v[176:177]
    v_pk_add_f32 v[194:195], v[194:195], v[178:179]
    v_pk_add_f32 v[196:197], v[196:197], v[180:181]
    v_pk_add_f32 v[198:199], v[198:199], v[182:183]
    v_pk_add_f32 v[200:201], v[200:201], v[184:185]
    v_pk_add_f32 v[202:203], v[202:203], v[186:187]
    v_pk_add_f32 v[204:205], v[204:205], v[188:189]
    v_pk_add_f32 v[206:207], v[206:207], v[190:191]
    v_add_f32 v16, v172, v204
    v_mov_b32 v17, v16
    v_pk_add_f32 v[160:161], v[160:161], v[192:193]
    v_pk_add_f32 v[162:163], v[162:163], v[194:195]
    v_pk_add_f32 v[164:165], v[164:165], v[196:197]
    v_pk_add_f32 v[166:167], v[166:167], v[198:199]
    v_pk_add_f32 v[168:169], v[168:169], v[200:201]
    v_pk_add_f32 v[170:171], v[170:171], v[202:203]
    v_pk_add_f32 v[172:173], v[172:173], v[204:205]
    v_pk_add_f32 v[174:175], v[174:175], v[206:207]
    v_maximum3_f32 v18, abs(v160), abs(v161), abs(v162)
    v_maximum3_f32 v19, abs(v163), abs(v164), abs(v175)
    v_maximum3_f32 v18, v18, abs(v165), abs(v166)
    v_maximum3_f32 v19, v19, abs(v167), abs(v168)
    v_maximum3_f32 v18, v18, abs(v169), abs(v170)
    v_maximum3_f32 v19, v19, abs(v171), abs(v172)
    v_maximum3_f32 v18, v18, abs(v173), abs(v174)
    v_maximum3_f32 v18, v18, v19, v19
    v_cmp_ngt_f32 vcc, s64, v18
    v_permlane32_swap_b32 v16, v17
    v_rcp_f32 v16, v17
    v_rcp_f32 v17, v17
    s_nop 0
    v_pk_mul_f32 v[160:161], v[160:161], v[16:17]
    v_pk_mul_f32 v[162:163], v[162:163], v[16:17]
    v_pk_mul_f32 v[164:165], v[164:165], v[16:17]
    v_pk_mul_f32 v[166:167], v[166:167], v[16:17]
    v_pk_mul_f32 v[168:169], v[168:169], v[16:17]
    v_pk_mul_f32 v[170:171], v[170:171], v[16:17]
    v_pk_mul_f32 v[172:173], v[172:173], v[16:17]
    v_pk_mul_f32 v[174:175], v[174:175], v[16:17]
    v_cvt_pk_bf16_f32 v144, v160, v161
    v_cvt_pk_bf16_f32 v145, v162, v163
    v_cvt_pk_bf16_f32 v146, v164, v165
    v_cvt_pk_bf16_f32 v147, v166, v167
    v_cvt_pk_bf16_f32 v148, v168, v169
    v_cvt_pk_bf16_f32 v149, v170, v171
    v_cvt_pk_bf16_f32 v150, v172, v173
    v_cvt_pk_bf16_f32 v151, v174, v175
    v_cndmask_b32 v150, v150, 0, s[92:93]
    v_cndmask_b32 v151, v151, 0, s[92:93]
    s_or_b64 vcc, vcc, s[76:77]
    s_cselect_b32 s68, 0x101, 1
    s_cmp_eq_u32 s55, 1
    s_cselect_b32 s68, 1, s68
    s_cmp_eq_u32 s68, 1
    s_cselect_b32 s66, s71, 0x7f000000
    buffer_store_dwordx4 v[144:147], v3, s[40:43], s66 offen sc1
    buffer_store_dwordx4 v[148:151], v3, s[40:43], s66 offen offset:2048 sc1
    v_mov_b32 v7, s68
    s_mov_b64 exec, 1
    ds_add_u32 v5, v7 offset:84
    s_mov_b64 exec, -1
L2_verdict:
    ds_read_b32 v7, v5 offset:84
    s_waitcnt lgkmcnt(0)
    v_readfirstlane_b32 s66, v7
    s_and_b32 s69, s66, 0xff
    s_cmp_lg_u32 s69, 4
    s_cbranch_scc1 L2_verdict
    s_cmp_gt_u32 s66, 0xff
    s_cbranch_scc1 L2_Aredo
    s_endpgm
L2_hd14:
    ds_write_b128 v10, v[160:163] offset:0
    ds_write_b128 v10, v[164:167] offset:1024
    ds_write_b128 v10, v[168:171] offset:2048
    ds_write_b128 v10, v[172:175] offset:3072
    s_branch L2_hr14
L2_hd15:
    ds_write_b128 v11, v[176:179] offset:0
    ds_write_b128 v11, v[180:183] offset:1024
    ds_write_b128 v11, v[184:187] offset:2048
    ds_write_b128 v11, v[188:191] offset:3072
    s_branch L2_hr15
L2_nl1:
    ds_read_b32 v7, v6 offset:72
    s_waitcnt vmcnt(0) lgkmcnt(0)
    v_readfirstlane_b32 s66, v7
    s_cmp_lg_u32 s66, 8
    s_cbranch_scc1 L2_nl1
    s_branch L2_nr1
L2_Aredo:
    s_mov_b32 s55, 1
    s_mov_b32 s66, 0x7f000000
    v_mov_b32 v8, s66
    s_waitcnt vmcnt(0)
    s_branch L2_Astart
L2_truemax:
    s_mov_b32 s67, s61
    s_mov_b32 s65, 64
    v_mov_b32 v16, 0xff800000
    v_cndmask_b32 v54, v54, 0, s[92:93]
    v_cndmask_b32 v55, v55, 0, s[92:93]
    v_mov_b32 v17, 0xff800000
    v_cndmask_b32 v62, v62, 0, s[92:93]
    v_cndmask_b32 v63, v63, 0, s[92:93]
    v_mov_b32 v18, 0xff800000
    v_cndmask_b32 v70, v70, 0, s[92:93]
    v_cndmask_b32 v71, v71, 0, s[92:93]
    v_mov_b32 v19, 0xff800000
    v_cndmask_b32 v78, v78, 0, s[92:93]
    v_cndmask_b32 v79, v79, 0, s[92:93]
L2_tmloop:
    s_waitcnt vmcnt(0)
    buffer_load_dwordx4 v[144:147], v3, s[40:43], s67 offen offset:0 sc1
    buffer_load_dwordx4 v[148:151], v3, s[40:43], s67 offen offset:1024 sc1
    s_waitcnt vmcnt(0)
    v_mfma_f32_32x32x16_bf16 v[224:239], v[144:147], v[48:51], 0
    v_mfma_f32_32x32x16_bf16 v[224:239], v[148:151], v[52:55], v[224:239]
    v_mfma_f32_32x32x16_bf16 v[240:255], v[144:147], v[56:59], 0
    v_mfma_f32_32x32x16_bf16 v[240:255], v[148:151], v[60:63], v[240:255]
    s_nop 7
    s_nop 1
    v_max3_f32 v16, v16, v224, v225
    v_max3_f32 v20, v226, v227, v228
    v_max_f32 v16, v16, v229
    v_max3_f32 v16, v16, v230, v231
    v_max3_f32 v20, v20, v232, v233
    v_max3_f32 v16, v16, v234, v235
    v_max3_f32 v20, v20, v236, v237
    v_max3_f32 v16, v16, v238, v239
    v_max_f32 v16, v16, v20
    v_mfma_f32_32x32x16_bf16 v[224:239], v[144:147], v[64:67], 0
    v_mfma_f32_32x32x16_bf16 v[224:239], v[148:151], v[68:71], v[224:239]
    v_max3_f32 v17, v17, v240, v241
    v_max3_f32 v20, v242, v243, v244
    v_max_f32 v17, v17, v245
    v_max3_f32 v17, v17, v246, v247
    v_max3_f32 v20, v20, v248, v249
    v_max3_f32 v17, v17, v250, v251
    v_max3_f32 v20, v20, v252, v253
    v_max3_f32 v17, v17, v254, v255
    v_max_f32 v17, v17, v20
    v_mfma_f32_32x32x16_bf16 v[240:255], v[144:147], v[72:75], 0
    v_mfma_f32_32x32x16_bf16 v[240:255], v[148:151], v[76:79], v[240:255]
    s_nop 1
    v_max3_f32 v18, v18, v224, v225
    v_max3_f32 v20, v226, v227, v228
    v_max_f32 v18, v18, v229
    v_max3_f32 v18, v18, v230, v231
    v_max3_f32 v20, v20, v232, v233
    v_max3_f32 v18, v18, v234, v235
    v_max3_f32 v20, v20, v236, v237
    v_max3_f32 v18, v18, v238, v239
    v_max_f32 v18, v18, v20
    s_nop 1
    v_max3_f32 v19, v19, v240, v241
    v_max3_f32 v20, v242, v243, v244
    v_max_f32 v19, v19, v245
    v_max3_f32 v19, v19, v246, v247
    v_max3_f32 v20, v20, v248, v249
    v_max3_f32 v19, v19, v250, v251
    v_max3_f32 v20, v20, v252, v253
    v_max3_f32 v19, v19, v254, v255
    v_max_f32 v19, v19, v20
    s_add_u32 s67, s67, 2048
    s_sub_u32 s65, s65, 1
    s_cmp_lg_u32 s65, 0
    s_cbranch_scc1 L2_tmloop
    v_mov_b32 v20, v16
    v_mov_b32 v21, v17
    v_mov_b32 v22, v18
    v_mov_b32 v23, v19
    s_nop 0
    v_permlane32_swap_b32 v16, v20
    v_permlane32_swap_b32 v17, v21
    v_permlane32_swap_b32 v18, v22
    v_permlane32_swap_b32 v19, v23
    v_max_f32 v16, v16, v20
    v_max_f32 v17, v17, v21
    v_max_f32 v18, v18, v22
    v_max_f32 v19, v19, v23
    v_and_b32 v20, s90, v16
    v_and_b32 v21, s90, v17
    v_and_b32 v22, s90, v18
    v_and_b32 v23, s90, v19
    v_sub_f32 v16, v16, v20
    v_sub_f32 v17, v17, v21
    v_sub_f32 v18, v18, v22
    v_sub_f32 v19, v19, v23
    v_and_b32 v24, s90, v16
    v_and_b32 v25, s90, v17
    v_and_b32 v26, s90, v18
    v_and_b32 v27, s90, v19
    v_sub_f32 v16, v16, v24
    v_sub_f32 v17, v17, v25
    v_sub_f32 v18, v18, v26
    v_sub_f32 v19, v19, v27
    v_cvt_pk_bf16_f32 v20, -v20, -v24
    v_cvt_pk_bf16_f32 v21, -v21, -v25
    v_cvt_pk_bf16_f32 v22, -v22, -v26
    v_cvt_pk_bf16_f32 v23, -v23, -v27
    v_cvt_pk_bf16_f32 v16, -v16, 0
    v_cvt_pk_bf16_f32 v17, -v17, 0
    v_cvt_pk_bf16_f32 v18, -v18, 0
    v_cvt_pk_bf16_f32 v19, -v19, 0
    v_cndmask_b32 v55, v55, v16, s[92:93]
    v_cndmask_b32 v63, v63, v17, s[92:93]
    v_cndmask_b32 v71, v71, v18, s[92:93]
    v_cndmask_b32 v79, v79, v19, s[92:93]
    s_branch L2_setm
L1_roleB:
    s_waitcnt vmcnt(8)
    v_add_u32 v252, 65536, v252
    v_add_u32 v253, 65536, v253
    v_add_u32 v254, 65536, v254
    v_add_u32 v255, 65536, v255
    ds_read_b128 v[80:83], v252 offset:0
    ds_read_b128 v[84:87], v253 offset:0
    ds_read_b128 v[88:91], v254 offset:0
    ds_read_b128 v[92:95], v255 offset:0
    s_waitcnt vmcnt(4)
    ds_read_b128 v[96:99], v252 offset:16384
    ds_read_b128 v[100:103], v253 offset:16384
    ds_read_b128 v[104:107], v254 offset:16384
    ds_read_b128 v[108:111], v255 offset:16384
    s_waitcnt lgkmcnt(4)
    v_dot2c_f32_bf16 v226, s89, v80
    v_dot2c_f32_bf16 v227, v80, v80
    v_dot2c_f32_bf16 v228, s89, v81
    v_dot2c_f32_bf16 v229, v81, v81
    v_dot2c_f32_bf16 v226, s89, v82
    v_dot2c_f32_bf16 v227, v82, v82
    v_dot2c_f32_bf16 v228, s89, v83
    v_dot2c_f32_bf16 v229, v83, v83
    v_dot2c_f32_bf16 v226, s89, v84
    v_dot2c_f32_bf16 v227, v84, v84
    v_dot2c_f32_bf16 v228, s89, v85
    v_dot2c_f32_bf16 v229, v85, v85
    v_dot2c_f32_bf16 v226, s89, v86
    v_dot2c_f32_bf16 v227, v86, v86
    v_dot2c_f32_bf16 v228, s89, v87
    v_dot2c_f32_bf16 v229, v87, v87
    v_dot2c_f32_bf16 v226, s89, v88
    v_dot2c_f32_bf16 v227, v88, v88
    v_dot2c_f32_bf16 v228, s89, v89
    v_dot2c_f32_bf16 v229, v89, v89
    v_dot2c_f32_bf16 v226, s89, v90
    v_dot2c_f32_bf16 v227, v90, v90
    v_dot2c_f32_bf16 v228, s89, v91
    v_dot2c_f32_bf16 v229, v91, v91
    v_dot2c_f32_bf16 v226, s89, v92
    v_dot2c_f32_bf16 v227, v92, v92
    v_dot2c_f32_bf16 v228, s89, v93
    v_dot2c_f32_bf16 v229, v93, v93
    v_dot2c_f32_bf16 v226, s89, v94
    v_dot2c_f32_bf16 v227, v94, v94
    v_dot2c_f32_bf16 v228, s89, v95
    v_dot2c_f32_bf16 v229, v95, v95
    s_waitcnt vmcnt(0)
    ds_read_b128 v[112:115], v252 offset:32768
    ds_read_b128 v[116:119], v253 offset:32768
    ds_read_b128 v[120:123], v254 offset:32768
    ds_read_b128 v[124:127], v255 offset:32768
    s_waitcnt lgkmcnt(4)
    v_dot2c_f32_bf16 v226, s89, v96
    v_dot2c_f32_bf16 v227, v96, v96
    v_dot2c_f32_bf16 v228, s89, v97
    v_dot2c_f32_bf16 v229, v97, v97
    v_dot2c_f32_bf16 v226, s89, v98
    v_dot2c_f32_bf16 v227, v98, v98
    v_dot2c_f32_bf16 v228, s89, v99
    v_dot2c_f32_bf16 v229, v99, v99
    v_dot2c_f32_bf16 v226, s89, v100
    v_dot2c_f32_bf16 v227, v100, v100
    v_dot2c_f32_bf16 v228, s89, v101
    v_dot2c_f32_bf16 v229, v101, v101
    v_dot2c_f32_bf16 v226, s89, v102
    v_dot2c_f32_bf16 v227, v102, v102
    v_dot2c_f32_bf16 v228, s89, v103
    v_dot2c_f32_bf16 v229, v103, v103
    v_dot2c_f32_bf16 v226, s89, v104
    v_dot2c_f32_bf16 v227, v104, v104
    v_dot2c_f32_bf16 v228, s89, v105
    v_dot2c_f32_bf16 v229, v105, v105
    v_dot2c_f32_bf16 v226, s89, v106
    v_dot2c_f32_bf16 v227, v106, v106
    v_dot2c_f32_bf16 v228, s89, v107
    v_dot2c_f32_bf16 v229, v107, v107
    v_dot2c_f32_bf16 v226, s89, v108
    v_dot2c_f32_bf16 v227, v108, v108
    v_dot2c_f32_bf16 v228, s89, v109
    v_dot2c_f32_bf16 v229, v109, v109
    v_dot2c_f32_bf16 v226, s89, v110
    v_dot2c_f32_bf16 v227, v110, v110
    v_dot2c_f32_bf16 v228, s89, v111
    v_dot2c_f32_bf16 v229, v111, v111
    s_waitcnt lgkmcnt(0)
    v_dot2c_f32_bf16 v226, s89, v112
    v_dot2c_f32_bf16 v227, v112, v112
    v_dot2c_f32_bf16 v228, s89, v113
    v_dot2c_f32_bf16 v229, v113, v113
    v_dot2c_f32_bf16 v226, s89, v114
    v_dot2c_f32_bf16 v227, v114, v114
    v_dot2c_f32_bf16 v228, s89, v115
    v_dot2c_f32_bf16 v229, v115, v115
    v_dot2c_f32_bf16 v226, s89, v116
    v_dot2c_f32_bf16 v227, v116, v116
    v_dot2c_f32_bf16 v228, s89, v117
    v_dot2c_f32_bf16 v229, v117, v117
    v_dot2c_f32_bf16 v226, s89, v118
    v_dot2c_f32_bf16 v227, v118, v118
    v_dot2c_f32_bf16 v228, s89, v119
    v_dot2c_f32_bf16 v229, v119, v119
    v_dot2c_f32_bf16 v226, s89, v120
    v_dot2c_f32_bf16 v227, v120, v120
    v_dot2c_f32_bf16 v228, s89, v121
    v_dot2c_f32_bf16 v229, v121, v121
    v_dot2c_f32_bf16 v226, s89, v122
    v_dot2c_f32_bf16 v227, v122, v122
    v_dot2c_f32_bf16 v228, s89, v123
    v_dot2c_f32_bf16 v229, v123, v123
    v_dot2c_f32_bf16 v226, s89, v124
    v_dot2c_f32_bf16 v227, v124, v124
    v_dot2c_f32_bf16 v228, s89, v125
    v_dot2c_f32_bf16 v229, v125, v125
    v_dot2c_f32_bf16 v226, s89, v126
    v_dot2c_f32_bf16 v227, v126, v126
    v_dot2c_f32_bf16 v228, s89, v127
    v_dot2c_f32_bf16 v229, v127, v127
    s_nop 1
    v_add_f32 v226, v226, v228
    v_add_f32 v227, v227, v229
    ds_write_b64 v234, v[226:227]
    s_waitcnt lgkmcnt(0)
    s_barrier
    ds_read_b64 v[228:229], v235
    v_subrev_u32 v252, 65536, v252
    v_subrev_u32 v253, 65536, v253
    v_subrev_u32 v254, 65536, v254
    v_subrev_u32 v255, 65536, v255
    ds_read_b128 v[16:19], v252 offset:0
    ds_read_b128 v[20:23], v253 offset:0
    ds_read_b128 v[24:27], v254 offset:0
    ds_read_b128 v[28:31], v255 offset:0
    ds_read_b128 v[32:35], v252 offset:16384
    ds_read_b128 v[36:39], v253 offset:16384
    ds_read_b128 v[40:43], v254 offset:16384
    ds_read_b128 v[44:47], v255 offset:16384
    ds_read_b128 v[48:51], v252 offset:32768
    ds_read_b128 v[52:55], v253 offset:32768
    ds_read_b128 v[56:59], v254 offset:32768
    ds_read_b128 v[60:63], v255 offset:32768
    ds_read_b128 v[64:67], v252 offset:49152
    ds_read_b128 v[68:71], v253 offset:49152
    ds_read_b128 v[72:75], v254 offset:49152
    ds_read_b128 v[76:79], v255 offset:49152
    s_waitcnt lgkmcnt(15)
    v_add_f32 v226, v226, v228
    v_add_f32 v227, v227, v229
    v_mov_b32 v228, v226
    v_mov_b32 v229, v227
    s_mov_b32 s58, 0xbb124925
    v_mov_b32 v230, 0x3727c5ac
    v_permlane32_swap_b32 v226, v228
    v_permlane32_swap_b32 v227, v229
    v_add_f32 v226, v226, v228
    v_add_f32 v227, v227, v229
    v_mul_f32 v9, s58, v226
    v_fma_f32 v227, -v227, s58, v230
    v_fma_f32 v227, -v9, v9, v227
    v_max_f32 v10, v227, v230
    s_waitcnt lgkmcnt(0)
    s_barrier
    s_add_u32 s74, s56, 1
    s_sub_u32 s75, s74, 7
    s_cmp_lt_u32 s74, 7
    s_cselect_b32 s74, s74, s75
    s_add_u32 m0, s70, 149504
    s_mul_i32 s74, s74, 172032
    s_add_u32 s75, s74, 896
    buffer_load_dwordx4 v238, s[36:39], s74 offen lds
    s_add_u32 m0, s70, 150528
    s_nop 0
    buffer_load_dwordx4 v238, s[36:39], s75 offen lds
    s_barrier
    s_add_u32 s74, s56, 2
    s_sub_u32 s75, s74, 7
    s_cmp_lt_u32 s74, 7
    s_cselect_b32 s74, s74, s75
    s_add_u32 m0, s70, 0
    s_mul_i32 s74, s74, s88
    s_add_u32 s75, s74, s52
    buffer_load_dwordx4 v236, s[76:79], s74 offen lds
    v_lshlrev_b32 v152, 16, v16
    v_and_b32 v153, s90, v16
    v_lshlrev_b32 v154, 16, v17
    v_and_b32 v155, s90, v17
    v_lshlrev_b32 v156, 16, v18
    v_and_b32 v157, s90, v18
    v_lshlrev_b32 v158, 16, v19
    v_and_b32 v159, s90, v19
    v_add_f32 v152, v152, v9
    buffer_load_dwordx4 v236, s[76:79], s75 offen offset:1024 lds
    v_add_f32 v153, v153, v9
    v_add_f32 v154, v154, v9
    v_add_f32 v155, v155, v9
    v_add_f32 v156, v156, v9
    v_add_f32 v157, v157, v9
    v_add_f32 v158, v158, v9
    v_add_f32 v159, v159, v9
    v_cvt_pk_bf16_f32 v16, v152, v153
    s_add_u32 m0, s70, 2048
    s_nop 0
    buffer_load_dwordx4 v237, s[80:83], s74 offen lds
    v_cvt_pk_bf16_f32 v17, v154, v155
    v_cvt_pk_bf16_f32 v18, v156, v157
    v_cvt_pk_bf16_f32 v19, v158, v159
    v_lshlrev_b32 v152, 16, v20
    v_and_b32 v153, s90, v20
    v_lshlrev_b32 v154, 16, v21
    v_and_b32 v155, s90, v21
    v_lshlrev_b32 v156, 16, v22
    buffer_load_dwordx4 v237, s[80:83], s75 offen offset:1024 lds
    v_and_b32 v157, s90, v22
    v_lshlrev_b32 v158, 16, v23
    v_and_b32 v159, s90, v23
    v_add_f32 v152, v152, v9
    v_add_f32 v153, v153, v9
    v_add_f32 v154, v154, v9
    v_add_f32 v155, v155, v9
    v_add_f32 v156, v156, v9
    s_add_u32 s74, s56, 2
    s_sub_u32 s75, s74, 7
    s_cmp_lt_u32 s74, 7
    s_cselect_b32 s74, s74, s75
    s_add_u32 m0, s70, 16384
    s_mul_i32 s74, s74, 172032
    s_add_u32 s75, s74, 896
    buffer_load_dwordx4 v238, s[36:39], s74 offen lds
    v_add_f32 v157, v157, v9
    v_add_f32 v158, v158, v9
    v_add_f32 v159, v159, v9
    v_cvt_pk_bf16_f32 v20, v152, v153
    v_cvt_pk_bf16_f32 v21, v154, v155
    v_cvt_pk_bf16_f32 v22, v156, v157
    v_cvt_pk_bf16_f32 v23, v158, v159
    v_lshlrev_b32 v152, 16, v24
    s_add_u32 m0, s70, 17408
    s_nop 0
    buffer_load_dwordx4 v238, s[36:39], s75 offen lds
    v_and_b32 v153, s90, v24
    v_lshlrev_b32 v154, 16, v25
    v_and_b32 v155, s90, v25
    v_lshlrev_b32 v156, 16, v26
    v_and_b32 v157, s90, v26
    v_lshlrev_b32 v158, 16, v27
    v_and_b32 v159, s90, v27
    v_add_f32 v152, v152, v9
    v_add_f32 v153, v153, v9
    s_add_u32 s74, s56, 3
    s_sub_u32 s75, s74, 7
    s_cmp_lt_u32 s74, 7
    s_cselect_b32 s74, s74, s75
    s_add_u32 m0, s70, 32768
    s_mul_i32 s74, s74, s88
    s_add_u32 s75, s74, s52
    buffer_load_dwordx4 v236, s[76:79], s74 offen lds
    v_add_f32 v154, v154, v9
    v_add_f32 v155, v155, v9
    v_add_f32 v156, v156, v9
    v_add_f32 v157, v157, v9
    v_add_f32 v158, v158, v9
    v_add_f32 v159, v159, v9
    v_cvt_pk_bf16_f32 v24, v152, v153
    v_cvt_pk_bf16_f32 v25, v154, v155
    buffer_load_dwordx4 v236, s[76:79], s75 offen offset:1024 lds
    v_cvt_pk_bf16_f32 v26, v156, v157
    v_cvt_pk_bf16_f32 v27, v158, v159
    v_lshlrev_b32 v152, 16, v28
    v_and_b32 v153, s90, v28
    v_lshlrev_b32 v154, 16, v29
    v_and_b32 v155, s90, v29
    v_lshlrev_b32 v156, 16, v30
    v_and_b32 v157, s90, v30
    s_add_u32 m0, s70, 34816
    s_nop 0
    buffer_load_dwordx4 v237, s[80:83], s74 offen lds
    v_lshlrev_b32 v158, 16, v31
    v_and_b32 v159, s90, v31
    v_add_f32 v152, v152, v9
    v_add_f32 v153, v153, v9
    v_add_f32 v154, v154, v9
    v_add_f32 v155, v155, v9
    v_add_f32 v156, v156, v9
    v_add_f32 v157, v157, v9
    buffer_load_dwordx4 v237, s[80:83], s75 offen offset:1024 lds
    v_add_f32 v158, v158, v9
    v_add_f32 v159, v159, v9
    v_cvt_pk_bf16_f32 v28, v152, v153
    v_cvt_pk_bf16_f32 v29, v154, v155
    v_cvt_pk_bf16_f32 v30, v156, v157
    v_cvt_pk_bf16_f32 v31, v158, v159
    v_lshlrev_b32 v152, 16, v32
    v_and_b32 v153, s90, v32
    s_waitcnt vmcnt(10)
    s_barrier
    s_add_u32 s74, s56, 3
    s_sub_u32 s75, s74, 7
    s_cmp_lt_u32 s74, 7
    s_cselect_b32 s74, s74, s75
    s_add_u32 m0, s70, 18432
    s_mul_i32 s74, s74, 172032
    s_add_u32 s75, s74, 896
    buffer_load_dwordx4 v238, s[36:39], s74 offen lds
    v_lshlrev_b32 v154, 16, v33
    v_and_b32 v155, s90, v33
    v_lshlrev_b32 v156, 16, v34
    v_and_b32 v157, s90, v34
    v_lshlrev_b32 v158, 16, v35
    v_and_b32 v159, s90, v35
    v_add_f32 v152, v152, v9
    v_add_f32 v153, v153, v9
    v_add_f32 v154, v154, v9
    v_add_f32 v155, v155, v9
    v_add_f32 v156, v156, v9
    s_add_u32 m0, s70, 19456
    s_nop 0
    buffer_load_dwordx4 v238, s[36:39], s75 offen lds
    v_add_f32 v157, v157, v9
    v_add_f32 v158, v158, v9
    v_add_f32 v159, v159, v9
    v_cvt_pk_bf16_f32 v32, v152, v153
    v_cvt_pk_bf16_f32 v33, v154, v155
    v_cvt_pk_bf16_f32 v34, v156, v157
    v_cvt_pk_bf16_f32 v35, v158, v159
    v_lshlrev_b32 v152, 16, v36
    v_and_b32 v153, s90, v36
    v_lshlrev_b32 v154, 16, v37
    s_add_u32 s74, s56, 4
    s_sub_u32 s75, s74, 7
    s_cmp_lt_u32 s74, 7
    s_cselect_b32 s74, s74, s75
    s_add_u32 m0, s70, 49152
    s_mul_i32 s74, s74, s88
    s_add_u32 s75, s74, s52
    buffer_load_dwordx4 v236, s[76:79], s74 offen lds
    v_and_b32 v155, s90, v37
    v_lshlrev_b32 v156, 16, v38
    v_and_b32 v157, s90, v38
    v_lshlrev_b32 v158, 16, v39
    v_and_b32 v159, s90, v39
    v_add_f32 v152, v152, v9
    v_add_f32 v153, v153, v9
    v_add_f32 v154, v154, v9
    v_add_f32 v155, v155, v9
    v_add_f32 v156, v156, v9
    buffer_load_dwordx4 v236, s[76:79], s75 offen offset:1024 lds
    v_add_f32 v157, v157, v9
    v_add_f32 v158, v158, v9
    v_add_f32 v159, v159, v9
    v_cvt_pk_bf16_f32 v36, v152, v153
    v_cvt_pk_bf16_f32 v37, v154, v155
    v_cvt_pk_bf16_f32 v38, v156, v157
    v_cvt_pk_bf16_f32 v39, v158, v159
    v_lshlrev_b32 v152, 16, v40
    v_and_b32 v153, s90, v40
    v_lshlrev_b32 v154, 16, v41
    s_add_u32 m0, s70, 51200
    s_nop 0
    buffer_load_dwordx4 v237, s[80:83], s74 offen lds
    v_and_b32 v155, s90, v41
    v_lshlrev_b32 v156, 16, v42
    v_and_b32 v157, s90, v42
    v_lshlrev_b32 v158, 16, v43
    v_and_b32 v159, s90, v43
    v_add_f32 v152, v152, v9
    v_add_f32 v153, v153, v9
    v_add_f32 v154, v154, v9
    v_add_f32 v155, v155, v9
    v_add_f32 v156, v156, v9
    v_add_f32 v157, v157, v9
    buffer_load_dwordx4 v237, s[80:83], s75 offen offset:1024 lds
    v_add_f32 v158, v158, v9
    v_add_f32 v159, v159, v9
    v_cvt_pk_bf16_f32 v40, v152, v153
    v_cvt_pk_bf16_f32 v41, v154, v155
    v_cvt_pk_bf16_f32 v42, v156, v157
    v_cvt_pk_bf16_f32 v43, v158, v159
    v_lshlrev_b32 v152, 16, v44
    v_and_b32 v153, s90, v44
    v_lshlrev_b32 v154, 16, v45
    v_and_b32 v155, s90, v45
    s_add_u32 s74, s56, 4
    s_sub_u32 s75, s74, 7
    s_cmp_lt_u32 s74, 7
    s_cselect_b32 s74, s74, s75
    s_add_u32 m0, s70, 65536
    s_mul_i32 s74, s74, 172032
    s_add_u32 s75, s74, 896
    buffer_load_dwordx4 v238, s[36:39], s74 offen lds
    v_lshlrev_b32 v156, 16, v46
    v_and_b32 v157, s90, v46
    v_lshlrev_b32 v158, 16, v47
    v_and_b32 v159, s90, v47
    v_add_f32 v152, v152, v9
    v_add_f32 v153, v153, v9
    v_add_f32 v154, v154, v9
    v_add_f32 v155, v155, v9
    v_add_f32 v156, v156, v9
    v_add_f32 v157, v157, v9
    s_add_u32 m0, s70, 66560
    s_nop 0
    buffer_load_dwordx4 v238, s[36:39], s75 offen lds
    v_add_f32 v158, v158, v9
    v_add_f32 v159, v159, v9
    v_cvt_pk_bf16_f32 v44, v152, v153
    v_cvt_pk_bf16_f32 v45, v154, v155
    v_cvt_pk_bf16_f32 v46, v156, v157
    v_cvt_pk_bf16_f32 v47, v158, v159
    v_lshlrev_b32 v152, 16, v48
    v_and_b32 v153, s90, v48
    v_lshlrev_b32 v154, 16, v49
    v_and_b32 v155, s90, v49
    s_waitcnt vmcnt(12)
    s_barrier
    s_add_u32 s74, s56, 5
    s_sub_u32 s75, s74, 7
    s_cmp_lt_u32 s74, 7
    s_cselect_b32 s74, s74, s75
    s_add_u32 m0, s70, 81920
    s_mul_i32 s74, s74, s88
    s_add_u32 s75, s74, s52
    buffer_load_dwordx4 v236, s[76:79], s74 offen lds
    v_lshlrev_b32 v156, 16, v50
    v_and_b32 v157, s90, v50
    v_lshlrev_b32 v158, 16, v51
    v_and_b32 v159, s90, v51
    v_add_f32 v152, v152, v9
    v_add_f32 v153, v153, v9
    v_add_f32 v154, v154, v9
    v_add_f32 v155, v155, v9
    v_add_f32 v156, v156, v9
    buffer_load_dwordx4 v236, s[76:79], s75 offen offset:1024 lds
    v_add_f32 v157, v157, v9
    v_add_f32 v158, v158, v9
    v_add_f32 v159, v159, v9
    v_cvt_pk_bf16_f32 v48, v152, v153
    v_cvt_pk_bf16_f32 v49, v154, v155
    v_cvt_pk_bf16_f32 v50, v156, v157
    v_cvt_pk_bf16_f32 v51, v158, v159
    v_lshlrev_b32 v152, 16, v52
    s_add_u32 m0, s70, 83968
    s_nop 0
    buffer_load_dwordx4 v237, s[80:83], s74 offen lds
    v_and_b32 v153, s90, v52
    v_lshlrev_b32 v154, 16, v53
    v_and_b32 v155, s90, v53
    v_lshlrev_b32 v156, 16, v54
    v_and_b32 v157, s90, v54
    v_lshlrev_b32 v158, 16, v55
    v_and_b32 v159, s90, v55
    v_add_f32 v152, v152, v9
    buffer_load_dwordx4 v237, s[80:83], s75 offen offset:1024 lds
    v_add_f32 v153, v153, v9
    v_add_f32 v154, v154, v9
    v_add_f32 v155, v155, v9
    v_add_f32 v156, v156, v9
    v_add_f32 v157, v157, v9
    v_add_f32 v158, v158, v9
    v_add_f32 v159, v159, v9
    v_cvt_pk_bf16_f32 v52, v152, v153
    s_add_u32 s74, s56, 5
    s_sub_u32 s75, s74, 7
    s_cmp_lt_u32 s74, 7
    s_cselect_b32 s74, s74, s75
    s_add_u32 m0, s70, 67584
    s_mul_i32 s74, s74, 172032
    s_add_u32 s75, s74, 896
    buffer_load_dwordx4 v238, s[36:39], s74 offen lds
    v_cvt_pk_bf16_f32 v53, v154, v155
    v_cvt_pk_bf16_f32 v54, v156, v157
    v_cvt_pk_bf16_f32 v55, v158, v159
    v_lshlrev_b32 v152, 16, v56
    v_and_b32 v153, s90, v56
    v_lshlrev_b32 v154, 16, v57
    v_and_b32 v155, s90, v57
    v_lshlrev_b32 v156, 16, v58
    s_add_u32 m0, s70, 68608
    s_nop 0
    buffer_load_dwordx4 v238, s[36:39], s75 offen lds
    v_and_b32 v157, s90, v58
    v_lshlrev_b32 v158, 16, v59
    v_and_b32 v159, s90, v59
    v_add_f32 v152, v152, v9
    v_add_f32 v153, v153, v9
    v_add_f32 v154, v154, v9
    v_add_f32 v155, v155, v9
    v_add_f32 v156, v156, v9
    v_add_f32 v157, v157, v9
    s_add_u32 s74, s56, 6
    s_sub_u32 s75, s74, 7
    s_cmp_lt_u32 s74, 7
    s_cselect_b32 s74, s74, s75
    s_add_u32 m0, s70, 98304
    s_mul_i32 s74, s74, s88
    s_add_u32 s75, s74, s52
    buffer_load_dwordx4 v236, s[76:79], s74 offen lds
    v_add_f32 v158, v158, v9
    v_add_f32 v159, v159, v9
    v_cvt_pk_bf16_f32 v56, v152, v153
    v_cvt_pk_bf16_f32 v57, v154, v155
    v_cvt_pk_bf16_f32 v58, v156, v157
    v_cvt_pk_bf16_f32 v59, v158, v159
    v_lshlrev_b32 v152, 16, v60
    v_and_b32 v153, s90, v60
    buffer_load_dwordx4 v236, s[76:79], s75 offen offset:1024 lds
    v_lshlrev_b32 v154, 16, v61
    v_and_b32 v155, s90, v61
    v_lshlrev_b32 v156, 16, v62
    v_and_b32 v157, s90, v62
    v_lshlrev_b32 v158, 16, v63
    v_and_b32 v159, s90, v63
    v_add_f32 v152, v152, v9
    v_add_f32 v153, v153, v9
    s_add_u32 m0, s70, 100352
    s_nop 0
    buffer_load_dwordx4 v237, s[80:83], s74 offen lds
    v_add_f32 v154, v154, v9
    v_add_f32 v155, v155, v9
    v_add_f32 v156, v156, v9
    v_add_f32 v157, v157, v9
    v_add_f32 v158, v158, v9
    v_add_f32 v159, v159, v9
    v_cvt_pk_bf16_f32 v60, v152, v153
    v_cvt_pk_bf16_f32 v61, v154, v155
    buffer_load_dwordx4 v237, s[80:83], s75 offen offset:1024 lds
    v_cvt_pk_bf16_f32 v62, v156, v157
    v_cvt_pk_bf16_f32 v63, v158, v159
    v_lshlrev_b32 v152, 16, v64
    v_and_b32 v153, s90, v64
    v_lshlrev_b32 v154, 16, v65
    v_and_b32 v155, s90, v65
    v_lshlrev_b32 v156, 16, v66
    v_and_b32 v157, s90, v66
    s_waitcnt vmcnt(16)
    s_barrier
    s_add_u32 s74, s56, 6
    s_sub_u32 s75, s74, 7
    s_cmp_lt_u32 s74, 7
    s_cselect_b32 s74, s74, s75
    s_add_u32 m0, s70, 114688
    s_mul_i32 s74, s74, 172032
    s_add_u32 s75, s74, 896
    buffer_load_dwordx4 v238, s[36:39], s74 offen lds
    v_lshlrev_b32 v158, 16, v67
    v_and_b32 v159, s90, v67
    v_add_f32 v152, v152, v9
    v_add_f32 v153, v153, v9
    v_add_f32 v154, v154, v9
    v_add_f32 v155, v155, v9
    v_add_f32 v156, v156, v9
    v_add_f32 v157, v157, v9
    v_add_f32 v158, v158, v9
    v_add_f32 v159, v159, v9
    v_cvt_pk_bf16_f32 v64, v152, v153
    v_cvt_pk_bf16_f32 v65, v154, v155
    v_cvt_pk_bf16_f32 v66, v156, v157
    v_cvt_pk_bf16_f32 v67, v158, v159
    s_add_u32 m0, s70, 115712
    s_nop 0
    buffer_load_dwordx4 v238, s[36:39], s75 offen lds
    v_lshlrev_b32 v152, 16, v68
    v_and_b32 v153, s90, v68
    v_lshlrev_b32 v154, 16, v69
    v_and_b32 v155, s90, v69
    v_lshlrev_b32 v156, 16, v70
    v_and_b32 v157, s90, v70
    v_lshlrev_b32 v158, 16, v71
    v_and_b32 v159, s90, v71
    v_add_f32 v152, v152, v9
    v_add_f32 v153, v153, v9
    v_add_f32 v154, v154, v9
    v_add_f32 v155, v155, v9
    v_add_f32 v156, v156, v9
    v_add_f32 v157, v157, v9
    s_add_u32 s74, s56, 0
    s_sub_u32 s75, s74, 7
    s_cmp_lt_u32 s74, 7
    s_cselect_b32 s74, s74, s75
    s_add_u32 m0, s70, 131072
    s_mul_i32 s74, s74, 229376
    s_add_u32 s75, s74, 27648
    buffer_load_dwordx4 v239, s[28:31], s74 offen lds
    v_add_f32 v158, v158, v9
    v_add_f32 v159, v159, v9
    v_cvt_pk_bf16_f32 v68, v152, v153
    v_cvt_pk_bf16_f32 v69, v154, v155
    v_cvt_pk_bf16_f32 v70, v156, v157
    v_cvt_pk_bf16_f32 v71, v158, v159
    v_lshlrev_b32 v152, 16, v72
    v_and_b32 v153, s90, v72
    v_lshlrev_b32 v154, 16, v73
    v_and_b32 v155, s90, v73
    v_lshlrev_b32 v156, 16, v74
    v_and_b32 v157, s90, v74
    v_lshlrev_b32 v158, 16, v75
    buffer_load_dwordx4 v239, s[28:31], s75 offen offset:1024 lds
    v_and_b32 v159, s90, v75
    v_add_f32 v152, v152, v9
    v_add_f32 v153, v153, v9
    v_add_f32 v154, v154, v9
    v_add_f32 v155, v155, v9
    v_add_f32 v156, v156, v9
    v_add_f32 v157, v157, v9
    v_add_f32 v158, v158, v9
    v_add_f32 v159, v159, v9
    v_cvt_pk_bf16_f32 v72, v152, v153
    v_cvt_pk_bf16_f32 v73, v154, v155
    v_cvt_pk_bf16_f32 v74, v156, v157
    v_cvt_pk_bf16_f32 v75, v158, v159
    v_lshlrev_b32 v152, 16, v76
    s_add_u32 m0, s70, 133120
    s_nop 0
    buffer_load_dwordx4 v243, s[32:35], s74 offen lds
    v_and_b32 v153, s90, v76
    v_lshlrev_b32 v154, 16, v77
    v_and_b32 v155, s90, v77
    v_lshlrev_b32 v156, 16, v78
    v_and_b32 v157, s90, v78
    v_lshlrev_b32 v158, 16, v79
    v_and_b32 v159, s90, v79
    v_add_f32 v152, v152, v9
    v_add_f32 v153, v153, v9
    v_add_f32 v154, v154, v9
    v_add_f32 v155, v155, v9
    v_add_f32 v156, v156, v9
    v_add_f32 v157, v157, v9
    v_add_f32 v158, v158, v9
    buffer_load_dwordx4 v243, s[32:35], s75 offen offset:1024 lds
    v_add_f32 v159, v159, v9
    v_cvt_pk_bf16_f32 v76, v152, v153
    v_cvt_pk_bf16_f32 v77, v154, v155
    v_cvt_pk_bf16_f32 v78, v156, v157
    v_cvt_pk_bf16_f32 v79, v158, v159
    v_lshlrev_b32 v152, 16, v80
    v_and_b32 v153, s90, v80
    v_lshlrev_b32 v154, 16, v81
    v_and_b32 v155, s90, v81
    v_lshlrev_b32 v156, 16, v82
    v_and_b32 v157, s90, v82
    v_lshlrev_b32 v158, 16, v83
    v_and_b32 v159, s90, v83
    s_waitcnt vmcnt(16)
    s_barrier
    s_add_u32 s74, s56, 1
    s_sub_u32 s75, s74, 7
    s_cmp_lt_u32 s74, 7
    s_cselect_b32 s74, s74, s75
    s_add_u32 m0, s70, 147456
    s_mul_i32 s74, s74, 229376
    s_add_u32 s75, s74, 27648
    buffer_load_dwordx4 v239, s[28:31], s74 offen lds
    v_add_f32 v152, v152, v9
    v_add_f32 v153, v153, v9
    v_add_f32 v154, v154, v9
    v_add_f32 v155, v155, v9
    v_add_f32 v156, v156, v9
    v_add_f32 v157, v157, v9
    v_add_f32 v158, v158, v9
    v_add_f32 v159, v159, v9
    v_lshlrev_b32 v0, 2, v224
    v_add_u32 v0, 130944, v0
    v_mov_b32 v1, 0
    ds_write_b32 v0, v1
    s_waitcnt lgkmcnt(0)
    buffer_load_dwordx4 v239, s[28:31], s75 offen offset:1024 lds
    v_cvt_pk_bf16_f32 v80, v152, v153
    v_cvt_pk_bf16_f32 v81, v154, v155
    v_cvt_pk_bf16_f32 v82, v156, v157
    v_cvt_pk_bf16_f32 v83, v158, v159
    v_lshlrev_b32 v152, 16, v84
    v_and_b32 v153, s90, v84
    v_lshlrev_b32 v154, 16, v85
    v_and_b32 v155, s90, v85
    v_lshlrev_b32 v156, 16, v86
    s_add_u32 m0, s70, 149504
    s_nop 0
    buffer_load_dwordx4 v243, s[32:35], s74 offen lds
    v_and_b32 v157, s90, v86
    v_lshlrev_b32 v158, 16, v87
    v_and_b32 v159, s90, v87
    v_add_f32 v152, v152, v9
    v_add_f32 v153, v153, v9
    v_add_f32 v154, v154, v9
    v_add_f32 v155, v155, v9
    v_add_f32 v156, v156, v9
    v_add_f32 v157, v157, v9
    v_add_f32 v158, v158, v9
    buffer_load_dwordx4 v243, s[32:35], s75 offen offset:1024 lds
    v_add_f32 v159, v159, v9
    v_cvt_pk_bf16_f32 v84, v152, v153
    v_cvt_pk_bf16_f32 v85, v154, v155
    v_cvt_pk_bf16_f32 v86, v156, v157
    v_cvt_pk_bf16_f32 v87, v158, v159
    v_lshlrev_b32 v152, 16, v88
    v_and_b32 v153, s90, v88
    v_lshlrev_b32 v154, 16, v89
    v_and_b32 v155, s90, v89
    v_lshlrev_b32 v156, 16, v90
    s_add_u32 s74, s56, 2
    s_sub_u32 s75, s74, 7
    s_cmp_lt_u32 s74, 7
    s_cselect_b32 s74, s74, s75
    s_add_u32 m0, s70, 0
    s_mul_i32 s74, s74, 229376
    s_add_u32 s75, s74, 27648
    buffer_load_dwordx4 v239, s[28:31], s74 offen lds
    v_and_b32 v157, s90, v90
    v_lshlrev_b32 v158, 16, v91
    v_and_b32 v159, s90, v91
    v_add_f32 v152, v152, v9
    v_add_f32 v153, v153, v9
    v_add_f32 v154, v154, v9
    v_add_f32 v155, v155, v9
    v_add_f32 v156, v156, v9
    v_add_f32 v157, v157, v9
    v_add_f32 v158, v158, v9
    v_add_f32 v159, v159, v9
    buffer_load_dwordx4 v239, s[28:31], s75 offen offset:1024 lds
    v_cvt_pk_bf16_f32 v88, v152, v153
    v_cvt_pk_bf16_f32 v89, v154, v155
    v_cvt_pk_bf16_f32 v90, v156, v157
    v_cvt_pk_bf16_f32 v91, v158, v159
    v_lshlrev_b32 v152, 16, v92
    v_and_b32 v153, s90, v92
    v_lshlrev_b32 v154, 16, v93
    v_and_b32 v155, s90, v93
    v_lshlrev_b32 v156, 16, v94
    v_and_b32 v157, s90, v94
    s_add_u32 m0, s70, 2048
    s_nop 0
    buffer_load_dwordx4 v243, s[32:35], s74 offen lds
    v_lshlrev_b32 v158, 16, v95
    v_and_b32 v159, s90, v95
    v_add_f32 v152, v152, v9
    v_add_f32 v153, v153, v9
    v_add_f32 v154, v154, v9
    v_add_f32 v155, v155, v9
    v_add_f32 v156, v156, v9
    v_add_f32 v157, v157, v9
    v_add_f32 v158, v158, v9
    v_add_f32 v159, v159, v9
    buffer_load_dwordx4 v243, s[32:35], s75 offen offset:1024 lds
    v_cvt_pk_bf16_f32 v92, v152, v153
    v_cvt_pk_bf16_f32 v93, v154, v155
    v_cvt_pk_bf16_f32 v94, v156, v157
    v_cvt_pk_bf16_f32 v95, v158, v159
    v_lshlrev_b32 v152, 16, v96
    v_and_b32 v153, s90, v96
    v_lshlrev_b32 v154, 16, v97
    v_and_b32 v155, s90, v97
    v_lshlrev_b32 v156, 16, v98
    v_and_b32 v157, s90, v98
    s_waitcnt vmcnt(18)
    s_barrier
    s_add_u32 s74, s56, 3
    s_sub_u32 s75, s74, 7
    s_cmp_lt_u32 s74, 7
    s_cselect_b32 s74, s74, s75
    s_add_u32 m0, s70, 16384
    s_mul_i32 s74, s74, 229376
    s_add_u32 s75, s74, 27648
    buffer_load_dwordx4 v239, s[28:31], s74 offen lds
    v_lshlrev_b32 v158, 16, v99
    v_and_b32 v159, s90, v99
    v_add_f32 v152, v152, v9
    v_add_f32 v153, v153, v9
    v_add_f32 v154, v154, v9
    v_add_f32 v155, v155, v9
    v_add_f32 v156, v156, v9
    v_add_f32 v157, v157, v9
    v_add_f32 v158, v158, v9
    v_add_f32 v159, v159, v9
    v_cvt_pk_bf16_f32 v96, v152, v153
    buffer_load_dwordx4 v239, s[28:31], s75 offen offset:1024 lds
    v_cvt_pk_bf16_f32 v97, v154, v155
    v_cvt_pk_bf16_f32 v98, v156, v157
    v_cvt_pk_bf16_f32 v99, v158, v159
    v_lshlrev_b32 v152, 16, v100
    v_and_b32 v153, s90, v100
    v_lshlrev_b32 v154, 16, v101
    v_and_b32 v155, s90, v101
    v_lshlrev_b32 v156, 16, v102
    v_and_b32 v157, s90, v102
    v_lshlrev_b32 v158, 16, v103
    s_add_u32 m0, s70, 18432
    s_nop 0
    buffer_load_dwordx4 v243, s[32:35], s74 offen lds
    v_and_b32 v159, s90, v103
    v_add_f32 v152, v152, v9
    v_add_f32 v153, v153, v9
    v_add_f32 v154, v154, v9
    v_add_f32 v155, v155, v9
    v_add_f32 v156, v156, v9
    v_add_f32 v157, v157, v9
    v_add_f32 v158, v158, v9
    v_add_f32 v159, v159, v9
    v_cvt_pk_bf16_f32 v100, v152, v153
    buffer_load_dwordx4 v243, s[32:35], s75 offen offset:1024 lds
    v_cvt_pk_bf16_f32 v101, v154, v155
    v_cvt_pk_bf16_f32 v102, v156, v157
    v_cvt_pk_bf16_f32 v103, v158, v159
    v_lshlrev_b32 v152, 16, v104
    v_and_b32 v153, s90, v104
    v_lshlrev_b32 v154, 16, v105
    v_and_b32 v155, s90, v105
    v_lshlrev_b32 v156, 16, v106
    v_and_b32 v157, s90, v106
    v_lshlrev_b32 v158, 16, v107
    s_add_u32 s74, s56, 4
    s_sub_u32 s75, s74, 7
    s_cmp_lt_u32 s74, 7
    s_cselect_b32 s74, s74, s75
    s_add_u32 m0, s70, 32768
    s_mul_i32 s74, s74, 229376
    s_add_u32 s75, s74, 27648
    buffer_load_dwordx4 v239, s[28:31], s74 offen lds
    v_and_b32 v159, s90, v107
    v_add_f32 v152, v152, v9
    v_add_f32 v153, v153, v9
    v_add_f32 v154, v154, v9
    v_add_f32 v155, v155, v9
    v_add_f32 v156, v156, v9
    v_add_f32 v157, v157, v9
    v_add_f32 v158, v158, v9
    v_add_f32 v159, v159, v9
    v_cvt_pk_bf16_f32 v104, v152, v153
    v_cvt_pk_bf16_f32 v105, v154, v155
    buffer_load_dwordx4 v239, s[28:31], s75 offen offset:1024 lds
    v_cvt_pk_bf16_f32 v106, v156, v157
    v_cvt_pk_bf16_f32 v107, v158, v159
    v_lshlrev_b32 v152, 16, v108
    v_and_b32 v153, s90, v108
    v_lshlrev_b32 v154, 16, v109
    v_and_b32 v155, s90, v109
    v_lshlrev_b32 v156, 16, v110
    v_and_b32 v157, s90, v110
    v_lshlrev_b32 v158, 16, v111
    v_and_b32 v159, s90, v111
    s_add_u32 m0, s70, 34816
    s_nop 0
    buffer_load_dwordx4 v243, s[32:35], s74 offen lds
    v_add_f32 v152, v152, v9
    v_add_f32 v153, v153, v9
    v_add_f32 v154, v154, v9
    v_add_f32 v155, v155, v9
    v_add_f32 v156, v156, v9
    v_add_f32 v157, v157, v9
    v_add_f32 v158, v158, v9
    v_add_f32 v159, v159, v9
    v_cvt_pk_bf16_f32 v108, v152, v153
    v_cvt_pk_bf16_f32 v109, v154, v155
    buffer_load_dwordx4 v243, s[32:35], s75 offen offset:1024 lds
    v_cvt_pk_bf16_f32 v110, v156, v157
    v_cvt_pk_bf16_f32 v111, v158, v159
    v_lshlrev_b32 v152, 16, v112
    v_and_b32 v153, s90, v112
    v_lshlrev_b32 v154, 16, v113
    v_and_b32 v155, s90, v113
    v_lshlrev_b32 v156, 16, v114
    v_and_b32 v157, s90, v114
    v_lshlrev_b32 v158, 16, v115
    v_and_b32 v159, s90, v115
    s_waitcnt vmcnt(20)
    s_barrier
    s_add_u32 s74, s56, 5
    s_sub_u32 s75, s74, 7
    s_cmp_lt_u32 s74, 7
    s_cselect_b32 s74, s74, s75
    s_add_u32 m0, s70, 49152
    s_mul_i32 s74, s74, 229376
    s_add_u32 s75, s74, 27648
    buffer_load_dwordx4 v239, s[28:31], s74 offen lds
    v_add_f32 v152, v152, v9
    v_add_f32 v153, v153, v9
    v_add_f32 v154, v154, v9
    v_add_f32 v155, v155, v9
    v_add_f32 v156, v156, v9
    v_add_f32 v157, v157, v9
    v_add_f32 v158, v158, v9
    v_add_f32 v159, v159, v9
    v_cvt_pk_bf16_f32 v112, v152, v153
    v_cvt_pk_bf16_f32 v113, v154, v155
    v_cvt_pk_bf16_f32 v114, v156, v157
    v_cvt_pk_bf16_f32 v115, v158, v159
    v_lshlrev_b32 v152, 16, v116
    v_and_b32 v153, s90, v116
    v_lshlrev_b32 v154, 16, v117
    v_and_b32 v155, s90, v117
    v_lshlrev_b32 v156, 16, v118
    v_and_b32 v157, s90, v118
    v_lshlrev_b32 v158, 16, v119
    v_and_b32 v159, s90, v119
    v_add_f32 v152, v152, v9
    buffer_load_dwordx4 v239, s[28:31], s75 offen offset:1024 lds
    v_add_f32 v153, v153, v9
    v_add_f32 v154, v154, v9
    v_add_f32 v155, v155, v9
    v_add_f32 v156, v156, v9
    v_add_f32 v157, v157, v9
    v_add_f32 v158, v158, v9
    v_add_f32 v159, v159, v9
    v_cvt_pk_bf16_f32 v116, v152, v153
    v_cvt_pk_bf16_f32 v117, v154, v155
    v_cvt_pk_bf16_f32 v118, v156, v157
    v_cvt_pk_bf16_f32 v119, v158, v159
    v_lshlrev_b32 v152, 16, v120
    v_and_b32 v153, s90, v120
    v_lshlrev_b32 v154, 16, v121
    v_and_b32 v155, s90, v121
    v_lshlrev_b32 v156, 16, v122
    v_and_b32 v157, s90, v122
    v_lshlrev_b32 v158, 16, v123
    v_and_b32 v159, s90, v123
    v_add_f32 v152, v152, v9
    s_add_u32 m0, s70, 51200
    s_nop 0
    buffer_load_dwordx4 v243, s[32:35], s74 offen lds
    v_add_f32 v153, v153, v9
    v_add_f32 v154, v154, v9
    v_add_f32 v155, v155, v9
    v_add_f32 v156, v156, v9
    v_add_f32 v157, v157, v9
    v_add_f32 v158, v158, v9
    v_add_f32 v159, v159, v9
    v_cvt_pk_bf16_f32 v120, v152, v153
    v_cvt_pk_bf16_f32 v121, v154, v155
    v_cvt_pk_bf16_f32 v122, v156, v157
    v_cvt_pk_bf16_f32 v123, v158, v159
    v_lshlrev_b32 v152, 16, v124
    v_and_b32 v153, s90, v124
    v_lshlrev_b32 v154, 16, v125
    v_and_b32 v155, s90, v125
    v_lshlrev_b32 v156, 16, v126
    v_and_b32 v157, s90, v126
    v_lshlrev_b32 v158, 16, v127
    v_and_b32 v159, s90, v127
    v_add_f32 v152, v152, v9
    buffer_load_dwordx4 v243, s[32:35], s75 offen offset:1024 lds
    v_add_f32 v153, v153, v9
    v_add_f32 v154, v154, v9
    v_add_f32 v155, v155, v9
    v_add_f32 v156, v156, v9
    v_add_f32 v157, v157, v9
    v_add_f32 v158, v158, v9
    v_add_f32 v159, v159, v9
    v_cvt_pk_bf16_f32 v124, v152, v153
    v_cvt_pk_bf16_f32 v125, v154, v155
    v_cvt_pk_bf16_f32 v126, v156, v157
    v_cvt_pk_bf16_f32 v127, v158, v159
    v_rsq_f32 v240, v10
    s_nop 0
    v_mul_f32 v241, 0xc0135761, v240
    v_mul_f32 v242, v240, v240
    v_mul_f32 v242, v242, v240
    v_mul_f32 v242, 0xbdd2d3e8, v242
    v_mov_b32 v11, 130944
    v_mov_b32 v12, 1
    s_waitcnt vmcnt(4)
    s_barrier
    s_setprio 2
    v_add_u32 v3, 131072, v3
    v_add_u32 v4, 131072, v4
    v_add_u32 v5, 131072, v5
    v_add_u32 v6, 131072, v6
    ds_read_b64_tr_b16 v[128:129], v3 offset:0
    ds_read_b64_tr_b16 v[130:131], v3 offset:512
    ds_read_b64_tr_b16 v[132:133], v4 offset:0
    ds_read_b64_tr_b16 v[134:135], v4 offset:512
    ds_read_b64_tr_b16 v[136:137], v5 offset:0
    ds_read_b64_tr_b16 v[138:139], v5 offset:512
    ds_read_b64_tr_b16 v[140:141], v6 offset:0
    ds_read_b64_tr_b16 v[142:143], v6 offset:512
    ds_read_b64_tr_b16 v[144:145], v3 offset:4096
    ds_read_b64_tr_b16 v[146:147], v3 offset:4608
    ds_read_b64_tr_b16 v[148:149], v4 offset:4096
    ds_read_b64_tr_b16 v[150:151], v4 offset:4608
    ds_read_b64_tr_b16 v[152:153], v5 offset:4096
    ds_read_b64_tr_b16 v[154:155], v5 offset:4608
    s_add_u32 s74, s56, 6
    s_sub_u32 s75, s74, 7
    s_cmp_lt_u32 s74, 7
    s_cselect_b32 s74, s74, s75
    s_add_u32 m0, s70, 81920
    s_mul_i32 s74, s74, 229376
    s_add_u32 s75, s74, 27648
    buffer_load_dwordx4 v239, s[28:31], s74 offen lds
    buffer_load_dwordx4 v239, s[28:31], s75 offen offset:1024 lds
    s_add_u32 m0, s70, 83968
    s_nop 0
    buffer_load_dwordx4 v243, s[32:35], s74 offen lds
    buffer_load_dwordx4 v243, s[32:35], s75 offen offset:1024 lds
    s_waitcnt lgkmcnt(10)
    v_mfma_f32_32x32x16_bf16 v[160:175], v[128:131], v[16:19], 0
    ds_read_b64_tr_b16 v[156:157], v6 offset:4096
    ds_read_b64_tr_b16 v[158:159], v6 offset:4608
    v_mfma_f32_32x32x16_bf16 v[176:191], v[132:135], v[16:19], 0
    ds_read_b64_tr_b16 v[128:129], v3 offset:8192
    ds_read_b64_tr_b16 v[130:131], v3 offset:8704
    s_waitcnt lgkmcnt(10)
    v_mfma_f32_32x32x16_bf16 v[192:207], v[136:139], v[16:19], 0
    ds_read_b64_tr_b16 v[132:133], v4 offset:8192
    ds_read_b64_tr_b16 v[134:135], v4 offset:8704
    v_mfma_f32_32x32x16_bf16 v[208:223], v[140:143], v[16:19], 0
    ds_read_b64_tr_b16 v[136:137], v5 offset:8192
    ds_read_b64_tr_b16 v[138:139], v5 offset:8704
    s_waitcnt lgkmcnt(10)
    v_mfma_f32_32x32x16_bf16 v[160:175], v[144:147], v[20:23], v[160:175]
    ds_read_b64_tr_b16 v[140:141], v6 offset:8192
    ds_read_b64_tr_b16 v[142:143], v6 offset:8704
    v_mfma_f32_32x32x16_bf16 v[176:191], v[148:151], v[20:23], v[176:191]
    ds_read_b64_tr_b16 v[144:145], v3 offset:12288
    ds_read_b64_tr_b16 v[146:147], v3 offset:12800
    s_waitcnt lgkmcnt(10)
    v_mfma_f32_32x32x16_bf16 v[192:207], v[152:155], v[20:23], v[192:207]
    ds_read_b64_tr_b16 v[148:149], v4 offset:12288
    ds_read_b64_tr_b16 v[150:151], v4 offset:12800
    v_mfma_f32_32x32x16_bf16 v[208:223], v[156:159], v[20:23], v[208:223]
    ds_read_b64_tr_b16 v[152:153], v5 offset:12288
    ds_read_b64_tr_b16 v[154:155], v5 offset:12800
    s_waitcnt lgkmcnt(10)
    v_mfma_f32_32x32x16_bf16 v[160:175], v[128:131], v[24:27], v[160:175]
    ds_read_b64_tr_b16 v[156:157], v6 offset:12288
    ds_read_b64_tr_b16 v[158:159], v6 offset:12800
    v_mfma_f32_32x32x16_bf16 v[176:191], v[132:135], v[24:27], v[176:191]
    ds_read_b64_tr_b16 v[128:129], v3 offset:16384
    ds_read_b64_tr_b16 v[130:131], v3 offset:16896
    s_waitcnt lgkmcnt(10)
    v_mfma_f32_32x32x16_bf16 v[192:207], v[136:139], v[24:27], v[192:207]
    ds_read_b64_tr_b16 v[132:133], v4 offset:16384
    ds_read_b64_tr_b16 v[134:135], v4 offset:16896
    v_mfma_f32_32x32x16_bf16 v[208:223], v[140:143], v[24:27], v[208:223]
    ds_read_b64_tr_b16 v[136:137], v5 offset:16384
    ds_read_b64_tr_b16 v[138:139], v5 offset:16896
    s_waitcnt lgkmcnt(10)
    v_mfma_f32_32x32x16_bf16 v[160:175], v[144:147], v[28:31], v[160:175]
    ds_read_b64_tr_b16 v[140:141], v6 offset:16384
    ds_read_b64_tr_b16 v[142:143], v6 offset:16896
    v_mfma_f32_32x32x16_bf16 v[176:191], v[148:151], v[28:31], v[176:191]
    ds_read_b64_tr_b16 v[144:145], v3 offset:20480
    ds_read_b64_tr_b16 v[146:147], v3 offset:20992
    s_waitcnt lgkmcnt(10)
    v_mfma_f32_32x32x16_bf16 v[192:207], v[152:155], v[28:31], v[192:207]
    ds_read_b64_tr_b16 v[148:149], v4 offset:20480
    ds_read_b64_tr_b16 v[150:151], v4 offset:20992
    v_mfma_f32_32x32x16_bf16 v[208:223], v[156:159], v[28:31], v[208:223]
    ds_read_b64_tr_b16 v[152:153], v5 offset:20480
    ds_read_b64_tr_b16 v[154:155], v5 offset:20992
    s_waitcnt lgkmcnt(10)
    v_mfma_f32_32x32x16_bf16 v[160:175], v[128:131], v[32:35], v[160:175]
    ds_read_b64_tr_b16 v[156:157], v6 offset:20480
    ds_read_b64_tr_b16 v[158:159], v6 offset:20992
    v_mfma_f32_32x32x16_bf16 v[176:191], v[132:135], v[32:35], v[176:191]
    ds_read_b64_tr_b16 v[128:129], v3 offset:24576
    ds_read_b64_tr_b16 v[130:131], v3 offset:25088
    s_waitcnt lgkmcnt(10)
    v_mfma_f32_32x32x16_bf16 v[192:207], v[136:139], v[32:35], v[192:207]
    ds_read_b64_tr_b16 v[132:133], v4 offset:24576
    ds_read_b64_tr_b16 v[134:135], v4 offset:25088
    v_mfma_f32_32x32x16_bf16 v[208:223], v[140:143], v[32:35], v[208:223]
    ds_read_b64_tr_b16 v[136:137], v5 offset:24576
    ds_read_b64_tr_b16 v[138:139], v5 offset:25088
    s_waitcnt lgkmcnt(10)
    v_mfma_f32_32x32x16_bf16 v[160:175], v[144:147], v[36:39], v[160:175]
    ds_read_b64_tr_b16 v[140:141], v6 offset:24576
    ds_read_b64_tr_b16 v[142:143], v6 offset:25088
    v_mfma_f32_32x32x16_bf16 v[176:191], v[148:151], v[36:39], v[176:191]
    ds_read_b64_tr_b16 v[144:145], v3 offset:28672
    ds_read_b64_tr_b16 v[146:147], v3 offset:29184
    s_waitcnt lgkmcnt(10)
    v_mfma_f32_32x32x16_bf16 v[192:207], v[152:155], v[36:39], v[192:207]
    ds_read_b64_tr_b16 v[148:149], v4 offset:28672
    ds_read_b64_tr_b16 v[150:151], v4 offset:29184
    v_mfma_f32_32x32x16_bf16 v[208:223], v[156:159], v[36:39], v[208:223]
    ds_read_b64_tr_b16 v[152:153], v5 offset:28672
    ds_read_b64_tr_b16 v[154:155], v5 offset:29184
    s_waitcnt lgkmcnt(10)
    v_mfma_f32_32x32x16_bf16 v[160:175], v[128:131], v[40:43], v[160:175]
    ds_read_b64_tr_b16 v[156:157], v6 offset:28672
    ds_read_b64_tr_b16 v[158:159], v6 offset:29184
    v_mfma_f32_32x32x16_bf16 v[176:191], v[132:135], v[40:43], v[176:191]
    v_subrev_u32 v3, 131072, v3
    v_subrev_u32 v4, 131072, v4
    v_subrev_u32 v5, 131072, v5
    v_subrev_u32 v6, 131072, v6
    ds_read_b64_tr_b16 v[128:129], v3 offset:0
    ds_read_b64_tr_b16 v[130:131], v3 offset:512
    s_waitcnt lgkmcnt(10)
    v_mfma_f32_32x32x16_bf16 v[192:207], v[136:139], v[40:43], v[192:207]
    ds_read_b64_tr_b16 v[132:133], v4 offset:0
    ds_read_b64_tr_b16 v[134:135], v4 offset:512
    v_mfma_f32_32x32x16_bf16 v[208:223], v[140:143], v[40:43], v[208:223]
    ds_read_b64_tr_b16 v[136:137], v5 offset:0
    ds_read_b64_tr_b16 v[138:139], v5 offset:512
    s_waitcnt lgkmcnt(10)
    v_mfma_f32_32x32x16_bf16 v[160:175], v[144:147], v[44:47], v[160:175]
    ds_read_b64_tr_b16 v[140:141], v6 offset:0
    ds_read_b64_tr_b16 v[142:143], v6 offset:512
    v_mfma_f32_32x32x16_bf16 v[176:191], v[148:151], v[44:47], v[176:191]
    ds_read_b64_tr_b16 v[144:145], v3 offset:4096
    ds_read_b64_tr_b16 v[146:147], v3 offset:4608
    s_waitcnt lgkmcnt(10)
    v_mfma_f32_32x32x16_bf16 v[192:207], v[152:155], v[44:47], v[192:207]
    ds_read_b64_tr_b16 v[148:149], v4 offset:4096
    ds_read_b64_tr_b16 v[150:151], v4 offset:4608
    v_mfma_f32_32x32x16_bf16 v[208:223], v[156:159], v[44:47], v[208:223]
    ds_read_b64_tr_b16 v[152:153], v5 offset:4096
    ds_read_b64_tr_b16 v[154:155], v5 offset:4608
    s_waitcnt lgkmcnt(10)
    v_mfma_f32_32x32x16_bf16 v[160:175], v[128:131], v[48:51], v[160:175]
    ds_read_b64_tr_b16 v[156:157], v6 offset:4096
    ds_read_b64_tr_b16 v[158:159], v6 offset:4608
    v_mfma_f32_32x32x16_bf16 v[176:191], v[132:135], v[48:51], v[176:191]
    ds_read_b64_tr_b16 v[128:129], v3 offset:8192
    ds_read_b64_tr_b16 v[130:131], v3 offset:8704
    s_waitcnt lgkmcnt(10)
    v_mfma_f32_32x32x16_bf16 v[192:207], v[136:139], v[48:51], v[192:207]
    ds_read_b64_tr_b16 v[132:133], v4 offset:8192
    ds_read_b64_tr_b16 v[134:135], v4 offset:8704
    v_mfma_f32_32x32x16_bf16 v[208:223], v[140:143], v[48:51], v[208:223]
    ds_read_b64_tr_b16 v[136:137], v5 offset:8192
    ds_read_b64_tr_b16 v[138:139], v5 offset:8704
    s_waitcnt lgkmcnt(10)
    v_mfma_f32_32x32x16_bf16 v[160:175], v[144:147], v[52:55], v[160:175]
    ds_read_b64_tr_b16 v[140:141], v6 offset:8192
    ds_read_b64_tr_b16 v[142:143], v6 offset:8704
    v_mfma_f32_32x32x16_bf16 v[176:191], v[148:151], v[52:55], v[176:191]
    ds_read_b64_tr_b16 v[144:145], v3 offset:12288
    ds_read_b64_tr_b16 v[146:147], v3 offset:12800
    s_waitcnt lgkmcnt(10)
    v_mfma_f32_32x32x16_bf16 v[192:207], v[152:155], v[52:55], v[192:207]
    ds_read_b64_tr_b16 v[148:149], v4 offset:12288
    ds_read_b64_tr_b16 v[150:151], v4 offset:12800
    v_mfma_f32_32x32x16_bf16 v[208:223], v[156:159], v[52:55], v[208:223]
    ds_read_b64_tr_b16 v[152:153], v5 offset:12288
    ds_read_b64_tr_b16 v[154:155], v5 offset:12800
    s_waitcnt lgkmcnt(10)
    v_mfma_f32_32x32x16_bf16 v[160:175], v[128:131], v[56:59], v[160:175]
    ds_read_b64_tr_b16 v[156:157], v6 offset:12288
    ds_read_b64_tr_b16 v[158:159], v6 offset:12800
    v_mfma_f32_32x32x16_bf16 v[176:191], v[132:135], v[56:59], v[176:191]
    ds_read_b64_tr_b16 v[128:129], v3 offset:16384
    ds_read_b64_tr_b16 v[130:131], v3 offset:16896
    s_waitcnt lgkmcnt(10)
    v_mfma_f32_32x32x16_bf16 v[192:207], v[136:139], v[56:59], v[192:207]
    ds_read_b64_tr_b16 v[132:133], v4 offset:16384
    ds_read_b64_tr_b16 v[134:135], v4 offset:16896
    v_mfma_f32_32x32x16_bf16 v[208:223], v[140:143], v[56:59], v[208:223]
    ds_read_b64_tr_b16 v[136:137], v5 offset:16384
    ds_read_b64_tr_b16 v[138:139], v5 offset:16896
    s_waitcnt lgkmcnt(10)
    v_mfma_f32_32x32x16_bf16 v[160:175], v[144:147], v[60:63], v[160:175]
    ds_read_b64_tr_b16 v[140:141], v6 offset:16384
    ds_read_b64_tr_b16 v[142:143], v6 offset:16896
    v_mfma_f32_32x32x16_bf16 v[176:191], v[148:151], v[60:63], v[176:191]
    ds_read_b64_tr_b16 v[144:145], v3 offset:20480
    ds_read_b64_tr_b16 v[146:147], v3 offset:20992
    s_waitcnt lgkmcnt(10)
    v_mfma_f32_32x32x16_bf16 v[192:207], v[152:155], v[60:63], v[192:207]
    ds_read_b64_tr_b16 v[148:149], v4 offset:20480
    ds_read_b64_tr_b16 v[150:151], v4 offset:20992
    v_mfma_f32_32x32x16_bf16 v[208:223], v[156:159], v[60:63], v[208:223]
    ds_read_b64_tr_b16 v[152:153], v5 offset:20480
    ds_read_b64_tr_b16 v[154:155], v5 offset:20992
    s_waitcnt lgkmcnt(10)
    v_mfma_f32_32x32x16_bf16 v[160:175], v[128:131], v[64:67], v[160:175]
    ds_read_b64_tr_b16 v[156:157], v6 offset:20480
    ds_read_b64_tr_b16 v[158:159], v6 offset:20992
    v_mfma_f32_32x32x16_bf16 v[176:191], v[132:135], v[64:67], v[176:191]
    ds_read_b64_tr_b16 v[128:129], v3 offset:24576
    ds_read_b64_tr_b16 v[130:131], v3 offset:25088
    s_waitcnt lgkmcnt(10)
    v_mfma_f32_32x32x16_bf16 v[192:207], v[136:139], v[64:67], v[192:207]
    ds_read_b64_tr_b16 v[132:133], v4 offset:24576
    ds_read_b64_tr_b16 v[134:135], v4 offset:25088
    v_mfma_f32_32x32x16_bf16 v[208:223], v[140:143], v[64:67], v[208:223]
    ds_read_b64_tr_b16 v[136:137], v5 offset:24576
    ds_read_b64_tr_b16 v[138:139], v5 offset:25088
    s_waitcnt lgkmcnt(10)
    v_mfma_f32_32x32x16_bf16 v[160:175], v[144:147], v[68:71], v[160:175]
    ds_read_b64_tr_b16 v[140:141], v6 offset:24576
    ds_read_b64_tr_b16 v[142:143], v6 offset:25088
    v_mfma_f32_32x32x16_bf16 v[176:191], v[148:151], v[68:71], v[176:191]
    ds_read_b64_tr_b16 v[144:145], v3 offset:28672
    ds_read_b64_tr_b16 v[146:147], v3 offset:29184
    s_waitcnt lgkmcnt(10)
    v_mfma_f32_32x32x16_bf16 v[192:207], v[152:155], v[68:71], v[192:207]
    ds_read_b64_tr_b16 v[148:149], v4 offset:28672
    ds_read_b64_tr_b16 v[150:151], v4 offset:29184
    v_mfma_f32_32x32x16_bf16 v[208:223], v[156:159], v[68:71], v[208:223]
    ds_read_b64_tr_b16 v[152:153], v5 offset:28672
    ds_read_b64_tr_b16 v[154:155], v5 offset:29184
    s_waitcnt lgkmcnt(10)
    v_mfma_f32_32x32x16_bf16 v[160:175], v[128:131], v[72:75], v[160:175]
    ds_read_b64_tr_b16 v[156:157], v6 offset:28672
    ds_read_b64_tr_b16 v[158:159], v6 offset:29184
    v_mfma_f32_32x32x16_bf16 v[176:191], v[132:135], v[72:75], v[176:191]
    ds_read_b64_tr_b16 v[128:129], v3 offset:32768
    ds_read_b64_tr_b16 v[130:131], v3 offset:33280
    s_waitcnt lgkmcnt(10)
    v_mfma_f32_32x32x16_bf16 v[192:207], v[136:139], v[72:75], v[192:207]
    ds_read_b64_tr_b16 v[132:133], v4 offset:32768
    ds_read_b64_tr_b16 v[134:135], v4 offset:33280
    v_mfma_f32_32x32x16_bf16 v[208:223], v[140:143], v[72:75], v[208:223]
    ds_read_b64_tr_b16 v[136:137], v5 offset:32768
    ds_read_b64_tr_b16 v[138:139], v5 offset:33280
    s_waitcnt lgkmcnt(10)
    v_mfma_f32_32x32x16_bf16 v[160:175], v[144:147], v[76:79], v[160:175]
    ds_read_b64_tr_b16 v[140:141], v6 offset:32768
    ds_read_b64_tr_b16 v[142:143], v6 offset:33280
    v_mfma_f32_32x32x16_bf16 v[176:191], v[148:151], v[76:79], v[176:191]
    ds_read_b64_tr_b16 v[144:145], v3 offset:36864
    ds_read_b64_tr_b16 v[146:147], v3 offset:37376
    s_waitcnt lgkmcnt(10)
    v_mfma_f32_32x32x16_bf16 v[192:207], v[152:155], v[76:79], v[192:207]
    ds_read_b64_tr_b16 v[148:149], v4 offset:36864
    ds_read_b64_tr_b16 v[150:151], v4 offset:37376
    v_mfma_f32_32x32x16_bf16 v[208:223], v[156:159], v[76:79], v[208:223]
    ds_read_b64_tr_b16 v[152:153], v5 offset:36864
    ds_read_b64_tr_b16 v[154:155], v5 offset:37376
    s_waitcnt lgkmcnt(10)
    v_mfma_f32_32x32x16_bf16 v[160:175], v[128:131], v[80:83], v[160:175]
    ds_read_b64_tr_b16 v[156:157], v6 offset:36864
    ds_read_b64_tr_b16 v[158:159], v6 offset:37376
    v_mfma_f32_32x32x16_bf16 v[176:191], v[132:135], v[80:83], v[176:191]
    ds_read_b64_tr_b16 v[128:129], v3 offset:40960
    ds_read_b64_tr_b16 v[130:131], v3 offset:41472
    s_waitcnt lgkmcnt(10)
    v_mfma_f32_32x32x16_bf16 v[192:207], v[136:139], v[80:83], v[192:207]
    ds_read_b64_tr_b16 v[132:133], v4 offset:40960
    ds_read_b64_tr_b16 v[134:135], v4 offset:41472
    v_mfma_f32_32x32x16_bf16 v[208:223], v[140:143], v[80:83], v[208:223]
    ds_read_b64_tr_b16 v[136:137], v5 offset:40960
    ds_read_b64_tr_b16 v[138:139], v5 offset:41472
    s_waitcnt lgkmcnt(10)
    v_mfma_f32_32x32x16_bf16 v[160:175], v[144:147], v[84:87], v[160:175]
    ds_read_b64_tr_b16 v[140:141], v6 offset:40960
    ds_read_b64_tr_b16 v[142:143], v6 offset:41472
    v_mfma_f32_32x32x16_bf16 v[176:191], v[148:151], v[84:87], v[176:191]
    s_waitcnt vmcnt(0)
    s_mov_b64 exec, 1
    ds_add_u32 v11, v12 offset:80
    s_mov_b64 exec, -1
    ds_read_b64_tr_b16 v[144:145], v3 offset:45056
    ds_read_b64_tr_b16 v[146:147], v3 offset:45568
    s_waitcnt lgkmcnt(11)
    v_mfma_f32_32x32x16_bf16 v[192:207], v[152:155], v[84:87], v[192:207]
    ds_read_b64_tr_b16 v[148:149], v4 offset:45056
    ds_read_b64_tr_b16 v[150:151], v4 offset:45568
    v_mfma_f32_32x32x16_bf16 v[208:223], v[156:159], v[84:87], v[208:223]
    ds_read_b64_tr_b16 v[152:153], v5 offset:45056
    ds_read_b64_tr_b16 v[154:155], v5 offset:45568
    s_waitcnt lgkmcnt(11)
    v_mfma_f32_32x32x16_bf16 v[160:175], v[128:131], v[88:91], v[160:175]
    ds_read_b64_tr_b16 v[156:157], v6 offset:45056
    ds_read_b64_tr_b16 v[158:159], v6 offset:45568
    v_mfma_f32_32x32x16_bf16 v[176:191], v[132:135], v[88:91], v[176:191]
L1_bx:
    ds_read_b32 v0, v11 offset:80
    s_waitcnt lgkmcnt(0)
    v_readfirstlane_b32 s57, v0
    s_cmp_lg_u32 s57, 4
    s_cbranch_scc1 L1_bx
    ds_read_b64_tr_b16 v[128:129], v3 offset:49152
    ds_read_b64_tr_b16 v[130:131], v3 offset:49664
    v_mfma_f32_32x32x16_bf16 v[192:207], v[136:139], v[88:91], v[192:207]
    ds_read_b64_tr_b16 v[132:133], v4 offset:49152
    ds_read_b64_tr_b16 v[134:135], v4 offset:49664
    v_mfma_f32_32x32x16_bf16 v[208:223], v[140:143], v[88:91], v[208:223]
    ds_read_b64_tr_b16 v[136:137], v5 offset:49152
    ds_read_b64_tr_b16 v[138:139], v5 offset:49664
    v_mfma_f32_32x32x16_bf16 v[160:175], v[144:147], v[92:95], v[160:175]
    ds_read_b64_tr_b16 v[140:141], v6 offset:49152
    ds_read_b64_tr_b16 v[142:143], v6 offset:49664
    v_mfma_f32_32x32x16_bf16 v[176:191], v[148:151], v[92:95], v[176:191]
    ds_read_b64_tr_b16 v[144:145], v3 offset:53248
    ds_read_b64_tr_b16 v[146:147], v3 offset:53760
    v_mfma_f32_32x32x16_bf16 v[192:207], v[152:155], v[92:95], v[192:207]
    ds_read_b64_tr_b16 v[148:149], v4 offset:53248
    ds_read_b64_tr_b16 v[150:151], v4 offset:53760
    v_mfma_f32_32x32x16_bf16 v[208:223], v[156:159], v[92:95], v[208:223]
    ds_read_b64_tr_b16 v[152:153], v5 offset:53248
    ds_read_b64_tr_b16 v[154:155], v5 offset:53760
    s_waitcnt lgkmcnt(10)
    v_mfma_f32_32x32x16_bf16 v[160:175], v[128:131], v[96:99], v[160:175]
    ds_read_b64_tr_b16 v[156:157], v6 offset:53248
    ds_read_b64_tr_b16 v[158:159], v6 offset:53760
    v_mfma_f32_32x32x16_bf16 v[176:191], v[132:135], v[96:99], v[176:191]
    ds_read_b64_tr_b16 v[128:129], v3 offset:57344
    ds_read_b64_tr_b16 v[130:131], v3 offset:57856
    s_waitcnt lgkmcnt(10)
    v_mfma_f32_32x32x16_bf16 v[192:207], v[136:139], v[96:99], v[192:207]
    ds_read_b64_tr_b16 v[132:133], v4 offset:57344
    ds_read_b64_tr_b16 v[134:135], v4 offset:57856
    v_mfma_f32_32x32x16_bf16 v[208:223], v[140:143], v[96:99], v[208:223]
    ds_read_b64_tr_b16 v[136:137], v5 offset:57344
    ds_read_b64_tr_b16 v[138:139], v5 offset:57856
    s_waitcnt lgkmcnt(10)
    v_mfma_f32_32x32x16_bf16 v[160:175], v[144:147], v[100:103], v[160:175]
    ds_read_b64_tr_b16 v[140:141], v6 offset:57344
    ds_read_b64_tr_b16 v[142:143], v6 offset:57856
    v_mfma_f32_32x32x16_bf16 v[176:191], v[148:151], v[100:103], v[176:191]
    ds_read_b64_tr_b16 v[144:145], v3 offset:61440
    ds_read_b64_tr_b16 v[146:147], v3 offset:61952
    s_waitcnt lgkmcnt(10)
    v_mfma_f32_32x32x16_bf16 v[192:207], v[152:155], v[100:103], v[192:207]
    ds_read_b64_tr_b16 v[148:149], v4 offset:61440
    ds_read_b64_tr_b16 v[150:151], v4 offset:61952
    v_mfma_f32_32x32x16_bf16 v[208:223], v[156:159], v[100:103], v[208:223]
    ds_read_b64_tr_b16 v[152:153], v5 offset:61440
    ds_read_b64_tr_b16 v[154:155], v5 offset:61952
    s_waitcnt lgkmcnt(10)
    v_mfma_f32_32x32x16_bf16 v[160:175], v[128:131], v[104:107], v[160:175]
    ds_read_b64_tr_b16 v[156:157], v6 offset:61440
    ds_read_b64_tr_b16 v[158:159], v6 offset:61952
    v_mfma_f32_32x32x16_bf16 v[176:191], v[132:135], v[104:107], v[176:191]
    v_add_u32 v3, 81920, v3
    v_add_u32 v4, 81920, v4
    v_add_u32 v5, 81920, v5
    v_add_u32 v6, 81920, v6
    ds_read_b64_tr_b16 v[128:129], v3 offset:0
    ds_read_b64_tr_b16 v[130:131], v3 offset:512
    s_waitcnt lgkmcnt(10)
    v_mfma_f32_32x32x16_bf16 v[192:207], v[136:139], v[104:107], v[192:207]
    ds_read_b64_tr_b16 v[132:133], v4 offset:0
    ds_read_b64_tr_b16 v[134:135], v4 offset:512
    v_mfma_f32_32x32x16_bf16 v[208:223], v[140:143], v[104:107], v[208:223]
    ds_read_b64_tr_b16 v[136:137], v5 offset:0
    ds_read_b64_tr_b16 v[138:139], v5 offset:512
    s_waitcnt lgkmcnt(10)
    v_mfma_f32_32x32x16_bf16 v[160:175], v[144:147], v[108:111], v[160:175]
    ds_read_b64_tr_b16 v[140:141], v6 offset:0
    ds_read_b64_tr_b16 v[142:143], v6 offset:512
    v_mfma_f32_32x32x16_bf16 v[176:191], v[148:151], v[108:111], v[176:191]
    ds_read_b64_tr_b16 v[144:145], v3 offset:4096
    ds_read_b64_tr_b16 v[146:147], v3 offset:4608
    s_waitcnt lgkmcnt(10)
    v_mfma_f32_32x32x16_bf16 v[192:207], v[152:155], v[108:111], v[192:207]
    ds_read_b64_tr_b16 v[148:149], v4 offset:4096
    ds_read_b64_tr_b16 v[150:151], v4 offset:4608
    v_mfma_f32_32x32x16_bf16 v[208:223], v[156:159], v[108:111], v[208:223]
    ds_read_b64_tr_b16 v[152:153], v5 offset:4096
    ds_read_b64_tr_b16 v[154:155], v5 offset:4608
    s_waitcnt lgkmcnt(10)
    v_mfma_f32_32x32x16_bf16 v[160:175], v[128:131], v[112:115], v[160:175]
    ds_read_b64_tr_b16 v[156:157], v6 offset:4096
    ds_read_b64_tr_b16 v[158:159], v6 offset:4608
    v_mfma_f32_32x32x16_bf16 v[176:191], v[132:135], v[112:115], v[176:191]
    ds_read_b64_tr_b16 v[128:129], v3 offset:8192
    ds_read_b64_tr_b16 v[130:131], v3 offset:8704
    s_waitcnt lgkmcnt(10)
    v_mfma_f32_32x32x16_bf16 v[192:207], v[136:139], v[112:115], v[192:207]
    ds_read_b64_tr_b16 v[132:133], v4 offset:8192
    ds_read_b64_tr_b16 v[134:135], v4 offset:8704
    v_mfma_f32_32x32x16_bf16 v[208:223], v[140:143], v[112:115], v[208:223]
    ds_read_b64_tr_b16 v[136:137], v5 offset:8192
    ds_read_b64_tr_b16 v[138:139], v5 offset:8704
    s_waitcnt lgkmcnt(10)
    v_mfma_f32_32x32x16_bf16 v[160:175], v[144:147], v[116:119], v[160:175]
    ds_read_b64_tr_b16 v[140:141], v6 offset:8192
    ds_read_b64_tr_b16 v[142:143], v6 offset:8704
    v_mfma_f32_32x32x16_bf16 v[176:191], v[148:151], v[116:119], v[176:191]
    ds_read_b64_tr_b16 v[144:145], v3 offset:12288
    ds_read_b64_tr_b16 v[146:147], v3 offset:12800
    s_waitcnt lgkmcnt(10)
    v_mfma_f32_32x32x16_bf16 v[192:207], v[152:155], v[116:119], v[192:207]
    ds_read_b64_tr_b16 v[148:149], v4 offset:12288
    ds_read_b64_tr_b16 v[150:151], v4 offset:12800
    v_mfma_f32_32x32x16_bf16 v[208:223], v[156:159], v[116:119], v[208:223]
    ds_read_b64_tr_b16 v[152:153], v5 offset:12288
    ds_read_b64_tr_b16 v[154:155], v5 offset:12800
    s_waitcnt lgkmcnt(10)
    v_mfma_f32_32x32x16_bf16 v[160:175], v[128:131], v[120:123], v[160:175]
    ds_read_b64_tr_b16 v[156:157], v6 offset:12288
    ds_read_b64_tr_b16 v[158:159], v6 offset:12800
    v_mfma_f32_32x32x16_bf16 v[176:191], v[132:135], v[120:123], v[176:191]
    s_waitcnt lgkmcnt(8)
    v_mfma_f32_32x32x16_bf16 v[192:207], v[136:139], v[120:123], v[192:207]
    v_mfma_f32_32x32x16_bf16 v[208:223], v[140:143], v[120:123], v[208:223]
    s_waitcnt lgkmcnt(4)
    v_mfma_f32_32x32x16_bf16 v[160:175], v[144:147], v[124:127], v[160:175]
    v_mfma_f32_32x32x16_bf16 v[176:191], v[148:151], v[124:127], v[176:191]
    s_waitcnt lgkmcnt(0)
    v_mfma_f32_32x32x16_bf16 v[192:207], v[152:155], v[124:127], v[192:207]
    v_mfma_f32_32x32x16_bf16 v[208:223], v[156:159], v[124:127], v[208:223]
    v_mov_b32 v0, 0
    buffer_load_dword v129, v0, s[84:87], 0 offen
    s_lshl_b32 s57, s51, 7
    s_lshl_b32 s58, s61, 2
    s_add_u32 s57, s57, s58
    s_add_u32 s57, s57, 15699968
    v_mov_b32 v130, s57
    s_add_u32 s57, s57, 4
    s_add_u32 s67, s66, 8192
    s_cmp_eq_u32 s60, 1
    s_cselect_b32 s57, 0x7f000000, s57
    s_cselect_b32 s67, 0x7f000000, s67
    v_mov_b32 v131, s57
    s_add_u32 s68, s67, 4096
    s_lshl_b32 s57, s48, 2
    v_add_u32 v4, s57, v11
    s_add_u32 s57, s70, 98304
    v_add_u32 v5, s57, v13
L1_Bw:
    ds_read_b32 v7, v4 offset:112
    ds_read_b128 v[16:19], v5 offset:0
    ds_read_b128 v[20:23], v5 offset:1024
    ds_read_b128 v[24:27], v5 offset:2048
    ds_read_b128 v[28:31], v5 offset:3072
    s_waitcnt lgkmcnt(4)
    v_readfirstlane_b32 s57, v7
    s_or_b32 s57, s57, s60
    s_cbranch_scc1 L1_Bw2
    s_sleep 1
    s_branch L1_Bw
L1_Bw2:
    s_waitcnt lgkmcnt(0)
    s_mov_b64 exec, 1
    ds_add_u32 v11, v12 offset:72
    s_mov_b64 exec, -1
    buffer_store_dwordx4 v[16:19], v13, s[40:43], s67 offen offset:0 sc1
    buffer_store_dwordx4 v[20:23], v13, s[40:43], s67 offen offset:2048 sc1
    buffer_store_dwordx4 v[24:27], v13, s[40:43], s68 offen offset:0 sc1
    buffer_store_dwordx4 v[28:31], v13, s[40:43], s68 offen offset:2048 sc1
    s_cmp_lt_u32 s48, 4
    s_cselect_b32 s94, s66, 0x7f000000
    s_cselect_b32 s69, 0x7f000000, s66
    v_mul_f32 v244, v160, v160
    v_mul_f32 v245, v161, v161
    v_mul_f32 v246, v162, v162
    v_mul_f32 v247, v163, v163
    v_mul_f32 v248, v164, v164
    v_mul_f32 v249, v165, v165
    v_mul_f32 v250, v166, v166
    v_mul_f32 v251, v167, v167
    v_fma_f32 v244, v244, v242, v241
    v_fma_f32 v245, v245, v242, v241
    v_fma_f32 v246, v246, v242, v241
    v_fma_f32 v247, v247, v242, v241
    v_fma_f32 v248, v248, v242, v241
    v_fma_f32 v249, v249, v242, v241
    v_fma_f32 v250, v250, v242, v241
    v_fma_f32 v251, v251, v242, v241
    v_mul_f32 v244, v244, v160
    v_mul_f32 v245, v245, v161
    v_mul_f32 v246, v246, v162
    v_mul_f32 v247, v247, v163
    v_mul_f32 v248, v248, v164
    v_mul_f32 v249, v249, v165
    v_mul_f32 v250, v250, v166
    v_mul_f32 v251, v251, v167
    v_exp_f32 v244, v244
    v_mul_f32 v160, v160, v168
    v_exp_f32 v245, v245
    v_mul_f32 v161, v161, v169
    v_exp_f32 v246, v246
    v_mul_f32 v162, v162, v170
    v_exp_f32 v247, v247
    v_mul_f32 v163, v163, v171
    v_exp_f32 v248, v248
    v_mul_f32 v164, v164, v172
    v_exp_f32 v249, v249
    v_mul_f32 v165, v165, v173
    v_exp_f32 v250, v250
    v_mul_f32 v166, v166, v174
    v_exp_f32 v251, v251
    v_mul_f32 v167, v167, v175
    v_fma_f32 v244, v244, v10, v10
    v_fma_f32 v245, v245, v10, v10
    v_fma_f32 v246, v246, v10, v10
    v_fma_f32 v247, v247, v10, v10
    v_fma_f32 v248, v248, v10, v10
    v_fma_f32 v249, v249, v10, v10
    v_fma_f32 v250, v250, v10, v10
    v_fma_f32 v251, v251, v10, v10
    v_rcp_f32 v244, v244
    v_rcp_f32 v245, v245
    v_rcp_f32 v246, v246
    v_rcp_f32 v247, v247
    v_rcp_f32 v248, v248
    v_rcp_f32 v249, v249
    v_rcp_f32 v250, v250
    v_rcp_f32 v251, v251
    s_add_u32 s58, s66, 0
    v_mul_f32 v160, v160, v244
    v_mul_f32 v161, v161, v245
    v_mul_f32 v162, v162, v246
    v_mul_f32 v163, v163, v247
    v_mul_f32 v164, v164, v248
    v_mul_f32 v165, v165, v249
    v_mul_f32 v166, v166, v250
    v_mul_f32 v167, v167, v251
    v_cvt_pk_bf16_f32 v168, v160, v161
    v_cvt_pk_bf16_f32 v169, v162, v163
    v_cvt_pk_bf16_f32 v170, v164, v165
    v_cvt_pk_bf16_f32 v171, v166, v167
    v_mul_f32 v244, v176, v176
    v_mul_f32 v245, v177, v177
    v_mul_f32 v246, v178, v178
    v_mul_f32 v247, v179, v179
    v_mul_f32 v248, v180, v180
    v_mul_f32 v249, v181, v181
    v_mul_f32 v250, v182, v182
    v_mul_f32 v251, v183, v183
    v_fma_f32 v244, v244, v242, v241
    v_fma_f32 v245, v245, v242, v241
    v_fma_f32 v246, v246, v242, v241
    v_fma_f32 v247, v247, v242, v241
    v_fma_f32 v248, v248, v242, v241
    v_fma_f32 v249, v249, v242, v241
    v_fma_f32 v250, v250, v242, v241
    v_fma_f32 v251, v251, v242, v241
    v_mul_f32 v244, v244, v176
    v_mul_f32 v245, v245, v177
    v_mul_f32 v246, v246, v178
    v_mul_f32 v247, v247, v179
    v_mul_f32 v248, v248, v180
    v_mul_f32 v249, v249, v181
    v_mul_f32 v250, v250, v182
    v_mul_f32 v251, v251, v183
    v_exp_f32 v244, v244
    v_mul_f32 v176, v176, v184
    v_exp_f32 v245, v245
    v_mul_f32 v177, v177, v185
    v_exp_f32 v246, v246
    v_mul_f32 v178, v178, v186
    v_exp_f32 v247, v247
    v_mul_f32 v179, v179, v187
    v_exp_f32 v248, v248
    v_mul_f32 v180, v180, v188
    v_exp_f32 v249, v249
    v_mul_f32 v181, v181, v189
    v_exp_f32 v250, v250
    v_mul_f32 v182, v182, v190
    v_exp_f32 v251, v251
    v_mul_f32 v183, v183, v191
    v_fma_f32 v244, v244, v10, v10
    v_fma_f32 v245, v245, v10, v10
    v_fma_f32 v246, v246, v10, v10
    v_fma_f32 v247, v247, v10, v10
    v_fma_f32 v248, v248, v10, v10
    v_fma_f32 v249, v249, v10, v10
    v_fma_f32 v250, v250, v10, v10
    v_fma_f32 v251, v251, v10, v10
    v_rcp_f32 v244, v244
    v_rcp_f32 v245, v245
    v_rcp_f32 v246, v246
    v_rcp_f32 v247, v247
    v_rcp_f32 v248, v248
    v_rcp_f32 v249, v249
    v_rcp_f32 v250, v250
    v_rcp_f32 v251, v251
    s_add_u32 s58, s66, 2048
    v_mul_f32 v176, v176, v244
    v_mul_f32 v177, v177, v245
    v_mul_f32 v178, v178, v246
    v_mul_f32 v179, v179, v247
    v_mul_f32 v180, v180, v248
    v_mul_f32 v181, v181, v249
    v_mul_f32 v182, v182, v250
    v_mul_f32 v183, v183, v251
    v_cvt_pk_bf16_f32 v184, v176, v177
    v_cvt_pk_bf16_f32 v185, v178, v179
    v_cvt_pk_bf16_f32 v186, v180, v181
    v_cvt_pk_bf16_f32 v187, v182, v183
    s_waitcnt vmcnt(0)
    v_readfirstlane_b32 s95, v129
    v_mov_b32 v128, 0
    s_mov_b32 s65, 0x40000
L1_Bgt:
    s_cmp_lg_u32 s95, 0
    s_cbranch_scc1 L1_Bgtx
    s_sub_u32 s65, s65, 1
    s_cmp_eq_u32 s65, 0
    s_cbranch_scc1 L1_Bgtx
    buffer_load_dword v129, v128, s[84:87], 0 offen sc1
    s_waitcnt vmcnt(0)
    v_readfirstlane_b32 s95, v129
    s_branch L1_Bgt
L1_Bgtx:
    v_mov_b32 v0, 130944
    v_mov_b32 v1, 1
    s_mov_b64 exec, 1
    ds_add_rtn_u32 v1, v0, v1 offset:64
    s_mov_b64 exec, 1
    s_waitcnt lgkmcnt(0)
    v_readfirstlane_b32 s57, v1
    v_mov_b32 v1, s95
    s_cmp_eq_u32 s57, 3
    s_cselect_b32 s58, 0, 0x7ff00000
    buffer_store_dword v1, v131, s[40:43], s58 offen sc1
    s_mov_b64 exec, -1
    v_mul_f32 v244, v192, v192
    v_mul_f32 v245, v193, v193
    v_mul_f32 v246, v194, v194
    v_mul_f32 v247, v195, v195
    v_mul_f32 v248, v196, v196
    v_mul_f32 v249, v197, v197
    v_mul_f32 v250, v198, v198
    v_mul_f32 v251, v199, v199
    v_fma_f32 v244, v244, v242, v241
    v_fma_f32 v245, v245, v242, v241
    v_fma_f32 v246, v246, v242, v241
    v_fma_f32 v247, v247, v242, v241
    v_fma_f32 v248, v248, v242, v241
    v_fma_f32 v249, v249, v242, v241
    v_fma_f32 v250, v250, v242, v241
    v_fma_f32 v251, v251, v242, v241
    v_mul_f32 v244, v244, v192
    v_mul_f32 v245, v245, v193
    v_mul_f32 v246, v246, v194
    v_mul_f32 v247, v247, v195
    v_mul_f32 v248, v248, v196
    v_mul_f32 v249, v249, v197
    v_mul_f32 v250, v250, v198
    v_mul_f32 v251, v251, v199
    v_exp_f32 v244, v244
    v_mul_f32 v192, v192, v200
    v_exp_f32 v245, v245
    v_mul_f32 v193, v193, v201
    v_exp_f32 v246, v246
    v_mul_f32 v194, v194, v202
    v_exp_f32 v247, v247
    v_mul_f32 v195, v195, v203
    v_exp_f32 v248, v248
    v_mul_f32 v196, v196, v204
    v_exp_f32 v249, v249
    v_mul_f32 v197, v197, v205
    v_exp_f32 v250, v250
    v_mul_f32 v198, v198, v206
    v_exp_f32 v251, v251
    v_mul_f32 v199, v199, v207
    v_fma_f32 v244, v244, v10, v10
    v_fma_f32 v245, v245, v10, v10
    v_fma_f32 v246, v246, v10, v10
    v_fma_f32 v247, v247, v10, v10
    v_fma_f32 v248, v248, v10, v10
    v_fma_f32 v249, v249, v10, v10
    v_fma_f32 v250, v250, v10, v10
    v_fma_f32 v251, v251, v10, v10
    v_rcp_f32 v244, v244
    v_rcp_f32 v245, v245
    v_rcp_f32 v246, v246
    v_rcp_f32 v247, v247
    v_rcp_f32 v248, v248
    v_rcp_f32 v249, v249
    v_rcp_f32 v250, v250
    v_rcp_f32 v251, v251
    s_add_u32 s58, s66, 4096
    v_mul_f32 v192, v192, v244
    v_mul_f32 v193, v193, v245
    v_mul_f32 v194, v194, v246
    v_mul_f32 v195, v195, v247
    v_mul_f32 v196, v196, v248
    v_mul_f32 v197, v197, v249
    v_mul_f32 v198, v198, v250
    v_mul_f32 v199, v199, v251
    v_cvt_pk_bf16_f32 v200, v192, v193
    v_cvt_pk_bf16_f32 v201, v194, v195
    v_cvt_pk_bf16_f32 v202, v196, v197
    v_cvt_pk_bf16_f32 v203, v198, v199
    v_mul_f32 v244, v208, v208
    v_mul_f32 v245, v209, v209
    v_mul_f32 v246, v210, v210
    v_mul_f32 v247, v211, v211
    v_mul_f32 v248, v212, v212
    v_mul_f32 v249, v213, v213
    v_mul_f32 v250, v214, v214
    v_mul_f32 v251, v215, v215
    v_fma_f32 v244, v244, v242, v241
    v_fma_f32 v245, v245, v242, v241
    v_fma_f32 v246, v246, v242, v241
    v_fma_f32 v247, v247, v242, v241
    v_fma_f32 v248, v248, v242, v241
    v_fma_f32 v249, v249, v242, v241
    v_fma_f32 v250, v250, v242, v241
    v_fma_f32 v251, v251, v242, v241
    v_mul_f32 v244, v244, v208
    v_mul_f32 v245, v245, v209
    v_mul_f32 v246, v246, v210
    v_mul_f32 v247, v247, v211
    v_mul_f32 v248, v248, v212
    v_mul_f32 v249, v249, v213
    v_mul_f32 v250, v250, v214
    v_mul_f32 v251, v251, v215
    v_exp_f32 v244, v244
    v_mul_f32 v208, v208, v216
    v_exp_f32 v245, v245
    v_mul_f32 v209, v209, v217
    v_exp_f32 v246, v246
    v_mul_f32 v210, v210, v218
    v_exp_f32 v247, v247
    v_mul_f32 v211, v211, v219
    v_exp_f32 v248, v248
    v_mul_f32 v212, v212, v220
    v_exp_f32 v249, v249
    v_mul_f32 v213, v213, v221
    v_exp_f32 v250, v250
    v_mul_f32 v214, v214, v222
    v_exp_f32 v251, v251
    v_mul_f32 v215, v215, v223
    v_fma_f32 v244, v244, v10, v10
    v_fma_f32 v245, v245, v10, v10
    v_fma_f32 v246, v246, v10, v10
    v_fma_f32 v247, v247, v10, v10
    v_fma_f32 v248, v248, v10, v10
    v_fma_f32 v249, v249, v10, v10
    v_fma_f32 v250, v250, v10, v10
    v_fma_f32 v251, v251, v10, v10
    v_rcp_f32 v244, v244
    v_rcp_f32 v245, v245
    v_rcp_f32 v246, v246
    v_rcp_f32 v247, v247
    v_rcp_f32 v248, v248
    v_rcp_f32 v249, v249
    v_rcp_f32 v250, v250
    v_rcp_f32 v251, v251
    s_add_u32 s58, s66, 6144
    v_mul_f32 v208, v208, v244
    v_mul_f32 v209, v209, v245
    v_mul_f32 v210, v210, v246
    v_mul_f32 v211, v211, v247
    v_mul_f32 v212, v212, v248
    v_mul_f32 v213, v213, v249
    v_mul_f32 v214, v214, v250
    v_mul_f32 v215, v215, v251
    v_cvt_pk_bf16_f32 v216, v208, v209
    v_cvt_pk_bf16_f32 v217, v210, v211
    v_cvt_pk_bf16_f32 v218, v212, v213
    v_cvt_pk_bf16_f32 v219, v214, v215
    s_mov_b32 s72, s50
    s_mov_b32 s73, s51
    s_mov_b32 s57, s54
    s_lshr_b32 s71, s57, 1
    s_lshl_b32 s71, s71, 16
    s_and_b32 s58, s57, 1
    s_lshl_b32 s58, s58, 10
    s_add_u32 s71, s71, s58
    s_lshl_b32 s58, s72, 12
    s_add_u32 s71, s71, s58
    s_add_u32 s71, s71, 15728640
    v_lshlrev_b32 v3, 4, v2
    v_mov_b32 v6, 130944
    v_mov_b32 v248, -1
    v_mov_b32 v249, -1
    v_mov_b32 v250, -1
    v_mov_b32 v251, -1
    s_lshl_b32 s57, s73, 7
    s_lshl_b32 s59, s72, 2
    s_add_u32 s57, s57, s59
    s_add_u32 s57, s57, 15708160
    v_mov_b32 v11, s57
    s_and_b32 s50, s2, 7
    s_lshr_b32 s51, s2, 3
    s_cmp_lt_u32 s51, 28
    s_cbranch_scc1 L2_gt
    s_add_u32 s58, s94, 0
    buffer_store_dwordx4 v[168:171], v3, s[40:43], s58 offen sc1
    s_add_u32 s58, s94, 2048
    buffer_store_dwordx4 v[184:187], v3, s[40:43], s58 offen sc1
    s_add_u32 s58, s94, 4096
    buffer_store_dwordx4 v[200:203], v3, s[40:43], s58 offen sc1
    s_add_u32 s58, s94, 6144
    buffer_store_dwordx4 v[216:219], v3, s[40:43], s58 offen sc1
    buffer_store_dwordx4 v[248:251], v3, s[40:43], s71 offen sc1
    buffer_store_dwordx4 v[248:251], v3, s[40:43], s71 offen offset:2048 sc1
    s_waitcnt vmcnt(0)
    v_mov_b32 v0, 130944
    v_mov_b32 v1, 1
    s_mov_b64 exec, 1
    ds_add_rtn_u32 v1, v0, v1 offset:48
    s_mov_b64 exec, 1
    s_waitcnt lgkmcnt(0)
    v_readfirstlane_b32 s57, v1
    v_mov_b32 v1, s95
    s_cmp_eq_u32 s57, 3
    s_cselect_b32 s58, 0, 0x7ff00000
    buffer_store_dword v1, v130, s[40:43], s58 offen sc1
    s_mov_b64 exec, -1
    v_mov_b32 v0, 130944
    v_mov_b32 v1, 1
    s_mov_b64 exec, 1
    ds_add_rtn_u32 v1, v0, v1 offset:12
    s_mov_b64 exec, 1
    s_waitcnt lgkmcnt(0)
    v_readfirstlane_b32 s57, v1
    v_mov_b32 v1, s95
    s_cmp_eq_u32 s57, 3
    s_cselect_b32 s58, 0, 0x7ff00000
    buffer_store_dword v1, v11, s[40:43], s58 offen sc1
    s_mov_b64 exec, -1
    s_endpgm
L2_gt:
    s_mul_i32 s54, s51, 9363
    s_lshr_b32 s54, s54, 16
    s_mul_i32 s55, s54, 7
    s_sub_u32 s55, s51, s55
    s_lshl_b32 s56, s50, 2
    s_add_u32 s54, s54, s56
    s_and_b32 s74, s48, 1
    s_lshr_b32 s75, s48, 1
    v_lshrrev_b32 v4, 3, v2
    v_and_b32 v5, 7, v2
    v_bfe_u32 v7, v2, 4, 1
    v_xor_b32 v5, v5, v7
    v_mul_u32_u24 v4, 896, v4
    v_lshl_add_u32 v4, v5, 4, v4
    s_lshl_b32 s56, s55, 7
    v_add_u32 v8, s56, v4
    s_mul_i32 s60, s48, 344064
    s_mul_i32 s52, s48, 57344
    s_add_u32 s52, s52, 1376256
    s_lshl_b32 s70, s48, 13
    s_add_u32 s70, s70, 131072
    s_mov_b32 s32, s16
    s_mov_b32 s33, s17
    s_mov_b32 s34, 1605632
    s_mov_b32 s35, 0x00020000
    s_add_u32 s57, s54, s55
    s_and_b32 s57, s57, 0
    s_xor_b32 s58, s57, 0
    s_mul_i32 s76, s58, 14336
    s_lshl_b32 s80, s58, 11
    s_xor_b32 s58, s57, 1
    s_mul_i32 s77, s58, 14336
    s_lshl_b32 s81, s58, 11
    s_xor_b32 s58, s57, 2
    s_mul_i32 s78, s58, 14336
    s_lshl_b32 s82, s58, 11
    s_xor_b32 s58, s57, 3
    s_mul_i32 s79, s58, 14336
    s_lshl_b32 s83, s58, 11
    s_add_u32 m0, s70, 0
    s_add_u32 s61, s60, s76
    s_add_u32 s62, s61, 63488
    s_add_u32 s61, s61, 57344
    buffer_load_dwordx4 v8, s[32:35], s61 offen lds
    buffer_load_dwordx4 v8, s[32:35], s62 offen offset:1024 lds
    s_add_u32 m0, s70, 2048
    s_add_u32 s61, s60, s77
    s_add_u32 s62, s61, 63488
    s_add_u32 s61, s61, 57344
    buffer_load_dwordx4 v8, s[32:35], s61 offen lds
    buffer_load_dwordx4 v8, s[32:35], s62 offen offset:1024 lds
    s_add_u32 m0, s70, 4096
    s_add_u32 s61, s60, s78
    s_add_u32 s62, s61, 63488
    s_add_u32 s61, s61, 57344
    buffer_load_dwordx4 v8, s[32:35], s61 offen lds
    buffer_load_dwordx4 v8, s[32:35], s62 offen offset:1024 lds
    s_add_u32 m0, s70, 6144
    s_add_u32 s61, s60, s79
    s_add_u32 s62, s61, 63488
    s_add_u32 s61, s61, 57344
    buffer_load_dwordx4 v8, s[32:35], s61 offen lds
    buffer_load_dwordx4 v8, s[32:35], s62 offen offset:1024 lds
    s_mul_i32 s68, s48, 49152
    s_lshl_b32 s69, s48, 13
    s_add_u32 s69, s69, 196608
    s_mul_i32 s59, s54, 229376
    s_add_u32 s59, s59, 6291456
    s_lshl_b32 s56, s75, 10
    v_add_u32 v9, s56, v3
    v_xor_b32 v10, 1024, v9
    s_add_u32 s28, s22, s59
    s_addc_u32 s29, s23, 0
    s_mov_b32 s30, 229376
    s_mov_b32 s31, 0x00020000
    v_lshrrev_b32 v4, 5, v2
    v_bfe_u32 v5, v2, 2, 2
    v_lshl_add_u32 v4, v4, 2, v5
    v_lshlrev_b32 v4, 7, v4
    v_and_b32 v5, 1, v2
    v_lshl_add_u32 v4, v5, 5, v4
    v_bfe_u32 v5, v2, 4, 1
    v_xor_b32 v5, s74, v5
    v_lshl_add_u32 v4, v5, 6, v4
    v_bfe_u32 v5, v2, 3, 1
    v_lshl_add_u32 v4, v5, 4, v4
    v_bfe_u32 v5, v2, 1, 1
    v_lshl_add_u32 v4, v5, 3, v4
    v_add_u32 v12, s70, v4
    v_xor_b32 v13, 16, v12
    s_lshr_b32 s56, s54, 1
    s_lshl_b32 s56, s56, 7
    s_add_u32 s57, s56, 15699968
    v_lshl_add_u32 v5, v2, 3, s57
    v_add_u32 v252, 4, v5
    s_add_u32 s57, s57, 48
    v_lshl_add_u32 v4, v2, 2, s57
    v_cmp_le_u32 vcc, 12, v2
    s_add_u32 s57, s56, 15708112
    v_lshl_add_u32 v7, v2, 2, s57
    v_cndmask_b32 v5, v5, v4, vcc
    v_cndmask_b32 v252, v252, v7, vcc
    s_mov_b32 s36, s18
    s_mov_b32 s37, s19
    s_mov_b32 s38, 1835008
    s_mov_b32 s39, 0x00020000
    s_mov_b32 s44, s8
    s_mov_b32 s45, s9
    s_mov_b32 s46, 401408
    s_mov_b32 s47, 0x00020000
    s_mul_i32 s64, s74, 224
    s_mul_i32 s57, s75, 112
    s_add_u32 s64, s64, s57
    s_lshl_b32 s90, s64, 7
    s_add_u32 s90, s90, 72576
    s_mul_i32 s91, s64, 896
    v_and_b32 v4, 31, v2
    s_lshl_b32 s88, s54, 6
    s_lshl_b32 s64, s75, 5
    s_add_u32 s88, s88, s64
    v_mul_u32_u24 v4, 896, v4
    v_lshrrev_b32 v7, 5, v2
    v_lshl_add_u32 v253, v7, 5, v4
    s_mul_i32 s88, s88, 896
    s_lshl_b32 s64, s55, 7
    s_add_u32 s88, s88, s64
    s_lshl_b32 s64, s74, 6
    s_add_u32 s88, s88, s64
    s_lshl_b32 s66, s48, 2
    v_add_u32 v254, s66, v6
    s_setprio 0
    v_mov_b32 v255, v5
    s_cmp_lg_u32 s48, 0
    s_cbranch_scc1 L2_Gww
    s_mov_b32 s65, 0x40000
    s_mov_b64 exec, 0xfff
L2_Gw:
    buffer_load_dword v7, v252, s[40:43], 0 offen sc1
    s_sub_u32 s65, s65, 1
    s_cmp_eq_u32 s65, 0
    s_cbranch_scc1 L2_Gwx
    s_waitcnt vmcnt(0)
    v_cmp_ne_u32 vcc, s95, v7
    s_cbranch_vccz L2_Gwx
    s_mov_b64 exec, vcc
    s_sleep 4
    s_branch L2_Gw
L2_Gwx:
    s_mov_b64 exec, -1
    v_mov_b32 v7, 1
    ds_write_b32 v6, v7 offset:56
    s_branch L2_Gwd
L2_Gww:
    ds_read_b32 v7, v6 offset:56
    s_waitcnt lgkmcnt(0)
    v_readfirstlane_b32 s65, v7
    s_cmp_eq_u32 s65, 1
    s_cbranch_scc1 L2_Gwd
    s_sleep 1
    s_branch L2_Gww
L2_Gwd:
    s_add_u32 s63, s68, s80
    s_add_u32 s63, s63, 8192
    buffer_load_dwordx4 v[80:83], v9, s[28:31], s63 offen sc1
    buffer_load_dwordx4 v[84:87], v10, s[28:31], s63 offen sc1
    s_add_u32 s63, s68, s81
    s_add_u32 s63, s63, 8192
    buffer_load_dwordx4 v[88:91], v9, s[28:31], s63 offen sc1
    buffer_load_dwordx4 v[92:95], v10, s[28:31], s63 offen sc1
    s_add_u32 s63, s68, s82
    s_add_u32 s63, s63, 8192
    buffer_load_dwordx4 v[96:99], v9, s[28:31], s63 offen sc1
    buffer_load_dwordx4 v[100:103], v10, s[28:31], s63 offen sc1
    s_add_u32 s63, s68, s83
    s_add_u32 s63, s63, 8192
    buffer_load_dwordx4 v[104:107], v9, s[28:31], s63 offen sc1
    buffer_load_dwordx4 v[108:111], v10, s[28:31], s63 offen sc1
    s_add_u32 s58, s94, 0
    buffer_store_dwordx4 v[168:171], v3, s[40:43], s58 offen sc1
    s_add_u32 s58, s94, 2048
    buffer_store_dwordx4 v[184:187], v3, s[40:43], s58 offen sc1
    s_add_u32 s58, s94, 4096
    buffer_store_dwordx4 v[200:203], v3, s[40:43], s58 offen sc1
    s_add_u32 s58, s94, 6144
    buffer_store_dwordx4 v[216:219], v3, s[40:43], s58 offen sc1
    s_waitcnt vmcnt(18)
    ds_read_b64_tr_b16 v[224:225], v12 offset:0
    ds_read_b64_tr_b16 v[226:227], v12 offset:1024
    ds_read_b64_tr_b16 v[228:229], v13 offset:0
    ds_read_b64_tr_b16 v[230:231], v13 offset:1024
    s_waitcnt vmcnt(16)
    s_waitcnt vmcnt(10)
    s_waitcnt lgkmcnt(0)
    ds_read_b64_tr_b16 v[232:233], v12 offset:2048
    ds_read_b64_tr_b16 v[234:235], v12 offset:3072
    ds_read_b64_tr_b16 v[236:237], v13 offset:2048
    ds_read_b64_tr_b16 v[238:239], v13 offset:3072
    v_mfma_f32_32x32x16_bf16 v[16:31], v[224:227], v[80:83], 0
    s_add_u32 m0, s70, 0
    s_add_u32 s61, s60, s76
    s_add_u32 s62, s61, 178176
    s_add_u32 s61, s61, 172032
    buffer_load_dwordx4 v8, s[32:35], s61 offen lds
    v_mfma_f32_32x32x16_bf16 v[32:47], v[228:231], v[80:83], 0
    buffer_load_dwordx4 v8, s[32:35], s62 offen offset:1024 lds
    v_mfma_f32_32x32x16_bf16 v[48:63], v[224:227], v[84:87], 0
    s_add_u32 s63, s68, s80
    s_add_u32 s63, s63, 24576
    buffer_load_dwordx4 v[80:83], v9, s[28:31], s63 offen sc1
    v_mfma_f32_32x32x16_bf16 v[64:79], v[228:231], v[84:87], 0
    buffer_load_dwordx4 v[84:87], v10, s[28:31], s63 offen sc1
    s_waitcnt vmcnt(12)
    s_waitcnt lgkmcnt(0)
    ds_read_b64_tr_b16 v[224:225], v12 offset:4096
    ds_read_b64_tr_b16 v[226:227], v12 offset:5120
    ds_read_b64_tr_b16 v[228:229], v13 offset:4096
    ds_read_b64_tr_b16 v[230:231], v13 offset:5120
    v_mfma_f32_32x32x16_bf16 v[16:31], v[232:235], v[88:91], v[16:31]
    s_add_u32 m0, s70, 2048
    s_add_u32 s61, s60, s77
    s_add_u32 s62, s61, 178176
    s_add_u32 s61, s61, 172032
    buffer_load_dwordx4 v8, s[32:35], s61 offen lds
    v_mfma_f32_32x32x16_bf16 v[32:47], v[236:239], v[88:91], v[32:47]
    buffer_load_dwordx4 v8, s[32:35], s62 offen offset:1024 lds
    v_mfma_f32_32x32x16_bf16 v[48:63], v[232:235], v[92:95], v[48:63]
    s_add_u32 s63, s68, s81
    s_add_u32 s63, s63, 24576
    buffer_load_dwordx4 v[88:91], v9, s[28:31], s63 offen sc1
    v_mfma_f32_32x32x16_bf16 v[64:79], v[236:239], v[92:95], v[64:79]
    buffer_load_dwordx4 v[92:95], v10, s[28:31], s63 offen sc1
    buffer_store_dwordx4 v[248:251], v3, s[40:43], s71 offen sc1
    buffer_store_dwordx4 v[248:251], v3, s[40:43], s71 offen offset:2048 sc1
    s_waitcnt vmcnt(16)
    s_waitcnt lgkmcnt(0)
    ds_read_b64_tr_b16 v[232:233], v12 offset:6144
    ds_read_b64_tr_b16 v[234:235], v12 offset:7168
    ds_read_b64_tr_b16 v[236:237], v13 offset:6144
    ds_read_b64_tr_b16 v[238:239], v13 offset:7168
    v_mfma_f32_32x32x16_bf16 v[16:31], v[224:227], v[96:99], v[16:31]
    s_add_u32 m0, s70, 4096
    s_add_u32 s61, s60, s78
    s_add_u32 s62, s61, 178176
    s_add_u32 s61, s61, 172032
    buffer_load_dwordx4 v8, s[32:35], s61 offen lds
    v_mfma_f32_32x32x16_bf16 v[32:47], v[228:231], v[96:99], v[32:47]
    buffer_load_dwordx4 v8, s[32:35], s62 offen offset:1024 lds
    v_mfma_f32_32x32x16_bf16 v[48:63], v[224:227], v[100:103], v[48:63]
    s_add_u32 s63, s68, s82
    s_add_u32 s63, s63, 24576
    buffer_load_dwordx4 v[96:99], v9, s[28:31], s63 offen sc1
    v_mfma_f32_32x32x16_bf16 v[64:79], v[228:231], v[100:103], v[64:79]
    buffer_load_dwordx4 v[100:103], v10, s[28:31], s63 offen sc1
    s_waitcnt vmcnt(12)
    s_waitcnt lgkmcnt(0)
    ds_read_b64_tr_b16 v[224:225], v12 offset:0
    ds_read_b64_tr_b16 v[226:227], v12 offset:1024
    ds_read_b64_tr_b16 v[228:229], v13 offset:0
    ds_read_b64_tr_b16 v[230:231], v13 offset:1024
    v_mfma_f32_32x32x16_bf16 v[16:31], v[232:235], v[104:107], v[16:31]
    s_add_u32 m0, s70, 6144
    s_add_u32 s61, s60, s79
    s_add_u32 s62, s61, 178176
    s_add_u32 s61, s61, 172032
    buffer_load_dwordx4 v8, s[32:35], s61 offen lds
    v_mfma_f32_32x32x16_bf16 v[32:47], v[236:239], v[104:107], v[32:47]
    buffer_load_dwordx4 v8, s[32:35], s62 offen offset:1024 lds
    v_mfma_f32_32x32x16_bf16 v[48:63], v[232:235], v[108:111], v[48:63]
    s_add_u32 s63, s68, s83
    s_add_u32 s63, s63, 24576
    buffer_load_dwordx4 v[104:107], v9, s[28:31], s63 offen sc1
    v_mfma_f32_32x32x16_bf16 v[64:79], v[236:239], v[108:111], v[64:79]
    buffer_load_dwordx4 v[108:111], v10, s[28:31], s63 offen sc1
    v_mov_b32 v0, 130944
    v_mov_b32 v1, 1
    s_mov_b64 exec, 1
    ds_add_rtn_u32 v1, v0, v1 offset:48
    s_mov_b64 exec, 1
    s_waitcnt lgkmcnt(0)
    v_readfirstlane_b32 s57, v1
    v_mov_b32 v1, s95
    s_cmp_eq_u32 s57, 3
    s_cselect_b32 s58, 0, 0x7ff00000
    buffer_store_dword v1, v130, s[40:43], s58 offen sc1
    s_mov_b64 exec, -1
L2_p1:
    ds_read_b32 v7, v6 offset:72
    s_waitcnt lgkmcnt(0)
    v_readfirstlane_b32 s57, v7
    s_cmp_lg_u32 s57, 8
    s_cbranch_scc1 L2_p1
    s_add_u32 m0, s90, 0
    s_add_u32 s61, s91, 0
    buffer_load_dwordx4 v8, s[44:47], s61 offen lds
    s_add_u32 m0, s90, 1024
    s_add_u32 s61, s91, 7168
    buffer_load_dwordx4 v8, s[44:47], s61 offen lds
    s_waitcnt vmcnt(15)
    ds_read_b64_tr_b16 v[232:233], v12 offset:2048
    ds_read_b64_tr_b16 v[234:235], v12 offset:3072
    ds_read_b64_tr_b16 v[236:237], v13 offset:2048
    ds_read_b64_tr_b16 v[238:239], v13 offset:3072
    v_mfma_f32_32x32x16_bf16 v[16:31], v[224:227], v[80:83], v[16:31]
    s_add_u32 m0, s70, 0
    s_add_u32 s61, s60, s76
    s_add_u32 s62, s61, 292864
    s_add_u32 s61, s61, 286720
    buffer_load_dwordx4 v8, s[32:35], s61 offen lds
    v_mfma_f32_32x32x16_bf16 v[32:47], v[228:231], v[80:83], v[32:47]
    buffer_load_dwordx4 v8, s[32:35], s62 offen offset:1024 lds
    v_mfma_f32_32x32x16_bf16 v[48:63], v[224:227], v[84:87], v[48:63]
    s_add_u32 s63, s68, s80
    s_add_u32 s63, s63, 40960
    buffer_load_dwordx4 v[80:83], v9, s[28:31], s63 offen sc1
    v_mfma_f32_32x32x16_bf16 v[64:79], v[228:231], v[84:87], v[64:79]
    buffer_load_dwordx4 v[84:87], v10, s[28:31], s63 offen sc1
    s_add_u32 m0, s90, 2048
    s_add_u32 s61, s91, 14336
    buffer_load_dwordx4 v8, s[44:47], s61 offen lds
    s_add_u32 m0, s90, 3072
    s_add_u32 s61, s91, 21504
    buffer_load_dwordx4 v8, s[44:47], s61 offen lds
    s_waitcnt vmcnt(15)
    s_waitcnt lgkmcnt(0)
    ds_read_b64_tr_b16 v[224:225], v12 offset:4096
    ds_read_b64_tr_b16 v[226:227], v12 offset:5120
    ds_read_b64_tr_b16 v[228:229], v13 offset:4096
    ds_read_b64_tr_b16 v[230:231], v13 offset:5120
    v_mfma_f32_32x32x16_bf16 v[16:31], v[232:235], v[88:91], v[16:31]
    s_add_u32 m0, s70, 2048
    s_add_u32 s61, s60, s77
    s_add_u32 s62, s61, 292864
    s_add_u32 s61, s61, 286720
    buffer_load_dwordx4 v8, s[32:35], s61 offen lds
    v_mfma_f32_32x32x16_bf16 v[32:47], v[236:239], v[88:91], v[32:47]
    buffer_load_dwordx4 v8, s[32:35], s62 offen offset:1024 lds
    v_mfma_f32_32x32x16_bf16 v[48:63], v[232:235], v[92:95], v[48:63]
    s_add_u32 s63, s68, s81
    s_add_u32 s63, s63, 40960
    buffer_load_dwordx4 v[88:91], v9, s[28:31], s63 offen sc1
    v_mfma_f32_32x32x16_bf16 v[64:79], v[236:239], v[92:95], v[64:79]
    buffer_load_dwordx4 v[92:95], v10, s[28:31], s63 offen sc1
    s_add_u32 m0, s90, 4096
    s_add_u32 s61, s91, 28672
    buffer_load_dwordx4 v8, s[44:47], s61 offen lds
    s_add_u32 m0, s90, 5120
    s_add_u32 s61, s91, 35840
    buffer_load_dwordx4 v8, s[44:47], s61 offen lds
    s_waitcnt vmcnt(17)
    s_waitcnt lgkmcnt(0)
    ds_read_b64_tr_b16 v[232:233], v12 offset:6144
    ds_read_b64_tr_b16 v[234:235], v12 offset:7168
    ds_read_b64_tr_b16 v[236:237], v13 offset:6144
    ds_read_b64_tr_b16 v[238:239], v13 offset:7168
    v_mfma_f32_32x32x16_bf16 v[16:31], v[224:227], v[96:99], v[16:31]
    s_add_u32 m0, s70, 4096
    s_add_u32 s61, s60, s78
    s_add_u32 s62, s61, 292864
    s_add_u32 s61, s61, 286720
    buffer_load_dwordx4 v8, s[32:35], s61 offen lds
    v_mfma_f32_32x32x16_bf16 v[32:47], v[228:231], v[96:99], v[32:47]
    buffer_load_dwordx4 v8, s[32:35], s62 offen offset:1024 lds
    v_mfma_f32_32x32x16_bf16 v[48:63], v[224:227], v[100:103], v[48:63]
    s_add_u32 s63, s68, s82
    s_add_u32 s63, s63, 40960
    buffer_load_dwordx4 v[96:99], v9, s[28:31], s63 offen sc1
    v_mfma_f32_32x32x16_bf16 v[64:79], v[228:231], v[100:103], v[64:79]
    buffer_load_dwordx4 v[100:103], v10, s[28:31], s63 offen sc1
    s_add_u32 m0, s90, 6144
    s_add_u32 s61, s91, 43008
    buffer_load_dwordx4 v8, s[44:47], s61 offen lds
    s_add_u32 m0, s90, 7168
    s_add_u32 s61, s91, 50176
    buffer_load_dwordx4 v8, s[44:47], s61 offen lds
    s_waitcnt vmcnt(16)
    s_waitcnt lgkmcnt(0)
    ds_read_b64_tr_b16 v[224:225], v12 offset:0
    ds_read_b64_tr_b16 v[226:227], v12 offset:1024
    ds_read_b64_tr_b16 v[228:229], v13 offset:0
    ds_read_b64_tr_b16 v[230:231], v13 offset:1024
    v_mfma_f32_32x32x16_bf16 v[16:31], v[232:235], v[104:107], v[16:31]
    s_add_u32 m0, s70, 6144
    s_add_u32 s61, s60, s79
    s_add_u32 s62, s61, 292864
    s_add_u32 s61, s61, 286720
    buffer_load_dwordx4 v8, s[32:35], s61 offen lds
    v_mfma_f32_32x32x16_bf16 v[32:47], v[236:239], v[104:107], v[32:47]
    buffer_load_dwordx4 v8, s[32:35], s62 offen offset:1024 lds
    v_mfma_f32_32x32x16_bf16 v[48:63], v[232:235], v[108:111], v[48:63]
    s_add_u32 s63, s68, s83
    s_add_u32 s63, s63, 40960
    buffer_load_dwordx4 v[104:107], v9, s[28:31], s63 offen sc1
    v_mfma_f32_32x32x16_bf16 v[64:79], v[236:239], v[108:111], v[64:79]
    buffer_load_dwordx4 v[108:111], v10, s[28:31], s63 offen sc1
    v_mov_b32 v0, 130944
    v_mov_b32 v1, 1
    s_mov_b64 exec, 1
    ds_add_rtn_u32 v1, v0, v1 offset:12
    s_mov_b64 exec, 1
    s_waitcnt lgkmcnt(0)
    v_readfirstlane_b32 s57, v1
    v_mov_b32 v1, s95
    s_cmp_eq_u32 s57, 3
    s_cselect_b32 s58, 0, 0x7ff00000
    buffer_store_dword v1, v11, s[40:43], s58 offen sc1
    s_mov_b64 exec, -1
    s_add_u32 s57, s56, 15708160
    v_lshl_add_u32 v11, v2, 2, s57
    s_add_u32 m0, s90, 8192
    s_add_u32 s61, s91, 57344
    buffer_load_dwordx4 v8, s[44:47], s61 offen lds
    s_add_u32 m0, s90, 9216
    s_add_u32 s61, s91, 64512
    buffer_load_dwordx4 v8, s[44:47], s61 offen lds
    s_waitcnt vmcnt(17)
    ds_read_b64_tr_b16 v[232:233], v12 offset:2048
    ds_read_b64_tr_b16 v[234:235], v12 offset:3072
    ds_read_b64_tr_b16 v[236:237], v13 offset:2048
    ds_read_b64_tr_b16 v[238:239], v13 offset:3072
    v_mfma_f32_32x32x16_bf16 v[16:31], v[224:227], v[80:83], v[16:31]
    s_add_u32 m0, s70, 0
    s_add_u32 s61, s60, s76
    s_add_u32 s62, s61, 6144
    s_add_u32 s61, s61, 0
    buffer_load_dwordx4 v8, s[32:35], s61 offen lds
    v_mfma_f32_32x32x16_bf16 v[32:47], v[228:231], v[80:83], v[32:47]
    buffer_load_dwordx4 v8, s[32:35], s62 offen offset:1024 lds
    v_mfma_f32_32x32x16_bf16 v[48:63], v[224:227], v[84:87], v[48:63]
    v_mfma_f32_32x32x16_bf16 v[64:79], v[228:231], v[84:87], v[64:79]
    s_cmp_lg_u32 s48, 0
    s_cbranch_scc1 L2_Gw2w
    s_mov_b32 s65, 0x40000
    s_mov_b64 exec, 0xffff
L2_Gw2:
    buffer_load_dword v7, v255, s[40:43], 0 offen sc1
    s_sub_u32 s65, s65, 1
    s_cmp_eq_u32 s65, 0
    s_cbranch_scc1 L2_Gw2x
    s_waitcnt vmcnt(0)
    v_cmp_ne_u32 vcc, s95, v7
    s_cbranch_vccz L2_Gw2x
    s_mov_b64 exec, vcc
    s_sleep 4
    s_branch L2_Gw2
L2_Gw2x:
    s_mov_b64 exec, -1
    v_mov_b32 v7, 1
    ds_write_b32 v6, v7 offset:60
    s_branch L2_Gw2d
L2_Gw2w:
    ds_read_b32 v7, v6 offset:60
    s_waitcnt lgkmcnt(0)
    v_readfirstlane_b32 s65, v7
    s_cmp_eq_u32 s65, 1
    s_cbranch_scc1 L2_Gw2d
    s_sleep 1
    s_branch L2_Gw2w
L2_Gw2d:
    s_add_u32 s63, s68, s80
    s_add_u32 s63, s63, 0
    buffer_load_dwordx4 v[80:83], v9, s[28:31], s63 offen sc1
    buffer_load_dwordx4 v[84:87], v10, s[28:31], s63 offen sc1
    s_add_u32 m0, s90, 10240
    s_add_u32 s61, s91, 71680
    buffer_load_dwordx4 v8, s[44:47], s61 offen lds
    s_add_u32 m0, s90, 11264
    s_add_u32 s61, s91, 78848
    buffer_load_dwordx4 v8, s[44:47], s61 offen lds
    s_waitcnt vmcnt(17)
    s_waitcnt lgkmcnt(0)
    ds_read_b64_tr_b16 v[224:225], v12 offset:4096
    ds_read_b64_tr_b16 v[226:227], v12 offset:5120
    ds_read_b64_tr_b16 v[228:229], v13 offset:4096
    ds_read_b64_tr_b16 v[230:231], v13 offset:5120
    v_mfma_f32_32x32x16_bf16 v[16:31], v[232:235], v[88:91], v[16:31]
    s_add_u32 m0, s70, 2048
    s_add_u32 s61, s60, s77
    s_add_u32 s62, s61, 6144
    s_add_u32 s61, s61, 0
    buffer_load_dwordx4 v8, s[32:35], s61 offen lds
    v_mfma_f32_32x32x16_bf16 v[32:47], v[236:239], v[88:91], v[32:47]
    buffer_load_dwordx4 v8, s[32:35], s62 offen offset:1024 lds
    v_mfma_f32_32x32x16_bf16 v[48:63], v[232:235], v[92:95], v[48:63]
    s_add_u32 s63, s68, s81
    s_add_u32 s63, s63, 0
    buffer_load_dwordx4 v[88:91], v9, s[28:31], s63 offen sc1
    v_mfma_f32_32x32x16_bf16 v[64:79], v[236:239], v[92:95], v[64:79]
    buffer_load_dwordx4 v[92:95], v10, s[28:31], s63 offen sc1
    s_add_u32 m0, s90, 12288
    s_add_u32 s61, s91, 86016
    buffer_load_dwordx4 v8, s[44:47], s61 offen lds
    s_add_u32 m0, s90, 13312
    s_add_u32 s61, s91, 93184
    buffer_load_dwordx4 v8, s[44:47], s61 offen lds
    s_waitcnt vmcnt(17)
    s_waitcnt lgkmcnt(0)
    ds_read_b64_tr_b16 v[232:233], v12 offset:6144
    ds_read_b64_tr_b16 v[234:235], v12 offset:7168
    ds_read_b64_tr_b16 v[236:237], v13 offset:6144
    ds_read_b64_tr_b16 v[238:239], v13 offset:7168
    v_mfma_f32_32x32x16_bf16 v[16:31], v[224:227], v[96:99], v[16:31]
    s_add_u32 m0, s70, 4096
    s_add_u32 s61, s60, s78
    s_add_u32 s62, s61, 6144
    s_add_u32 s61, s61, 0
    buffer_load_dwordx4 v8, s[32:35], s61 offen lds
    v_mfma_f32_32x32x16_bf16 v[32:47], v[228:231], v[96:99], v[32:47]
    buffer_load_dwordx4 v8, s[32:35], s62 offen offset:1024 lds
    v_mfma_f32_32x32x16_bf16 v[48:63], v[224:227], v[100:103], v[48:63]
    s_add_u32 s63, s68, s82
    s_add_u32 s63, s63, 0
    buffer_load_dwordx4 v[96:99], v9, s[28:31], s63 offen sc1
    v_mfma_f32_32x32x16_bf16 v[64:79], v[228:231], v[100:103], v[64:79]
    buffer_load_dwordx4 v[100:103], v10, s[28:31], s63 offen sc1
    s_add_u32 m0, s90, 14336
    s_add_u32 s61, s91, 100352
    buffer_load_dwordx4 v8, s[44:47], s61 offen lds
    s_waitcnt vmcnt(15)
    s_waitcnt lgkmcnt(0)
    ds_read_b64_tr_b16 v[224:225], v12 offset:0
    ds_read_b64_tr_b16 v[226:227], v12 offset:1024
    ds_read_b64_tr_b16 v[228:229], v13 offset:0
    ds_read_b64_tr_b16 v[230:231], v13 offset:1024
    v_mfma_f32_32x32x16_bf16 v[16:31], v[232:235], v[104:107], v[16:31]
    s_add_u32 m0, s70, 6144
    s_add_u32 s61, s60, s79
    s_add_u32 s62, s61, 6144
    s_add_u32 s61, s61, 0
    buffer_load_dwordx4 v8, s[32:35], s61 offen lds
    v_mfma_f32_32x32x16_bf16 v[32:47], v[236:239], v[104:107], v[32:47]
    buffer_load_dwordx4 v8, s[32:35], s62 offen offset:1024 lds
    v_mfma_f32_32x32x16_bf16 v[48:63], v[232:235], v[108:111], v[48:63]
    s_add_u32 s63, s68, s83
    s_add_u32 s63, s63, 0
    buffer_load_dwordx4 v[104:107], v9, s[28:31], s63 offen sc1
    v_mfma_f32_32x32x16_bf16 v[64:79], v[236:239], v[108:111], v[64:79]
    buffer_load_dwordx4 v[108:111], v10, s[28:31], s63 offen sc1
    s_waitcnt vmcnt(13)
    s_waitcnt lgkmcnt(0)
    ds_read_b64_tr_b16 v[232:233], v12 offset:2048
    ds_read_b64_tr_b16 v[234:235], v12 offset:3072
    ds_read_b64_tr_b16 v[236:237], v13 offset:2048
    ds_read_b64_tr_b16 v[238:239], v13 offset:3072
    v_mfma_f32_32x32x16_bf16 v[16:31], v[224:227], v[80:83], v[16:31]
    s_add_u32 m0, s70, 0
    s_add_u32 s61, s60, s76
    s_add_u32 s62, s61, 120832
    s_add_u32 s61, s61, 114688
    buffer_load_dwordx4 v8, s[32:35], s61 offen lds
    v_mfma_f32_32x32x16_bf16 v[32:47], v[228:231], v[80:83], v[32:47]
    buffer_load_dwordx4 v8, s[32:35], s62 offen offset:1024 lds
    v_mfma_f32_32x32x16_bf16 v[48:63], v[224:227], v[84:87], v[48:63]
    s_add_u32 s63, s68, s80
    s_add_u32 s63, s63, 16384
    buffer_load_dwordx4 v[80:83], v9, s[28:31], s63 offen sc1
    v_mfma_f32_32x32x16_bf16 v[64:79], v[228:231], v[84:87], v[64:79]
    buffer_load_dwordx4 v[84:87], v10, s[28:31], s63 offen sc1
    s_waitcnt vmcnt(11)
    s_waitcnt lgkmcnt(0)
    ds_read_b64_tr_b16 v[224:225], v12 offset:4096
    ds_read_b64_tr_b16 v[226:227], v12 offset:5120
    ds_read_b64_tr_b16 v[228:229], v13 offset:4096
    ds_read_b64_tr_b16 v[230:231], v13 offset:5120
    v_mfma_f32_32x32x16_bf16 v[16:31], v[232:235], v[88:91], v[16:31]
    s_add_u32 m0, s70, 2048
    s_add_u32 s61, s60, s77
    s_add_u32 s62, s61, 120832
    s_add_u32 s61, s61, 114688
    buffer_load_dwordx4 v8, s[32:35], s61 offen lds
    v_mfma_f32_32x32x16_bf16 v[32:47], v[236:239], v[88:91], v[32:47]
    buffer_load_dwordx4 v8, s[32:35], s62 offen offset:1024 lds
    v_mfma_f32_32x32x16_bf16 v[48:63], v[232:235], v[92:95], v[48:63]
    s_add_u32 s63, s68, s81
    s_add_u32 s63, s63, 16384
    buffer_load_dwordx4 v[88:91], v9, s[28:31], s63 offen sc1
    v_mfma_f32_32x32x16_bf16 v[64:79], v[236:239], v[92:95], v[64:79]
    buffer_load_dwordx4 v[92:95], v10, s[28:31], s63 offen sc1
    s_waitcnt vmcnt(10)
    s_waitcnt lgkmcnt(0)
    ds_read_b64_tr_b16 v[232:233], v12 offset:6144
    ds_read_b64_tr_b16 v[234:235], v12 offset:7168
    ds_read_b64_tr_b16 v[236:237], v13 offset:6144
    ds_read_b64_tr_b16 v[238:239], v13 offset:7168
    v_mfma_f32_32x32x16_bf16 v[16:31], v[224:227], v[96:99], v[16:31]
    s_add_u32 m0, s70, 4096
    s_add_u32 s61, s60, s78
    s_add_u32 s62, s61, 120832
    s_add_u32 s61, s61, 114688
    buffer_load_dwordx4 v8, s[32:35], s61 offen lds
    v_mfma_f32_32x32x16_bf16 v[32:47], v[228:231], v[96:99], v[32:47]
    buffer_load_dwordx4 v8, s[32:35], s62 offen offset:1024 lds
    v_mfma_f32_32x32x16_bf16 v[48:63], v[224:227], v[100:103], v[48:63]
    s_add_u32 s63, s68, s82
    s_add_u32 s63, s63, 16384
    buffer_load_dwordx4 v[96:99], v9, s[28:31], s63 offen sc1
    v_mfma_f32_32x32x16_bf16 v[64:79], v[228:231], v[100:103], v[64:79]
    buffer_load_dwordx4 v[100:103], v10, s[28:31], s63 offen sc1
    s_waitcnt vmcnt(10)
    s_waitcnt lgkmcnt(0)
    ds_read_b64_tr_b16 v[224:225], v12 offset:0
    ds_read_b64_tr_b16 v[226:227], v12 offset:1024
    ds_read_b64_tr_b16 v[228:229], v13 offset:0
    ds_read_b64_tr_b16 v[230:231], v13 offset:1024
    v_mfma_f32_32x32x16_bf16 v[16:31], v[232:235], v[104:107], v[16:31]
    s_add_u32 m0, s70, 6144
    s_add_u32 s61, s60, s79
    s_add_u32 s62, s61, 120832
    s_add_u32 s61, s61, 114688
    buffer_load_dwordx4 v8, s[32:35], s61 offen lds
    v_mfma_f32_32x32x16_bf16 v[32:47], v[236:239], v[104:107], v[32:47]
    buffer_load_dwordx4 v8, s[32:35], s62 offen offset:1024 lds
    v_mfma_f32_32x32x16_bf16 v[48:63], v[232:235], v[108:111], v[48:63]
    s_add_u32 s63, s68, s83
    s_add_u32 s63, s63, 16384
    buffer_load_dwordx4 v[104:107], v9, s[28:31], s63 offen sc1
    v_mfma_f32_32x32x16_bf16 v[64:79], v[236:239], v[108:111], v[64:79]
    buffer_load_dwordx4 v[108:111], v10, s[28:31], s63 offen sc1
    v_mov_b32 v7, 1
    ds_write_b32 v254, v7 offset:96
    s_waitcnt vmcnt(10)
    s_waitcnt lgkmcnt(1)
    ds_read_b64_tr_b16 v[232:233], v12 offset:2048
    ds_read_b64_tr_b16 v[234:235], v12 offset:3072
    ds_read_b64_tr_b16 v[236:237], v13 offset:2048
    ds_read_b64_tr_b16 v[238:239], v13 offset:3072
    v_mfma_f32_32x32x16_bf16 v[16:31], v[224:227], v[80:83], v[16:31]
    s_add_u32 m0, s70, 0
    s_add_u32 s61, s60, s76
    s_add_u32 s62, s61, 235520
    s_add_u32 s61, s61, 229376
    buffer_load_dwordx4 v8, s[32:35], s61 offen lds
    v_mfma_f32_32x32x16_bf16 v[32:47], v[228:231], v[80:83], v[32:47]
    buffer_load_dwordx4 v8, s[32:35], s62 offen offset:1024 lds
    v_mfma_f32_32x32x16_bf16 v[48:63], v[224:227], v[84:87], v[48:63]
    s_add_u32 s63, s68, s80
    s_add_u32 s63, s63, 32768
    buffer_load_dwordx4 v[80:83], v9, s[28:31], s63 offen sc1
    v_mfma_f32_32x32x16_bf16 v[64:79], v[228:231], v[84:87], v[64:79]
    buffer_load_dwordx4 v[84:87], v10, s[28:31], s63 offen sc1
    s_waitcnt vmcnt(10)
    s_waitcnt lgkmcnt(0)
    ds_read_b64_tr_b16 v[224:225], v12 offset:4096
    ds_read_b64_tr_b16 v[226:227], v12 offset:5120
    ds_read_b64_tr_b16 v[228:229], v13 offset:4096
    ds_read_b64_tr_b16 v[230:231], v13 offset:5120
    v_mfma_f32_32x32x16_bf16 v[16:31], v[232:235], v[88:91], v[16:31]
    s_add_u32 m0, s70, 2048
    s_add_u32 s61, s60, s77
    s_add_u32 s62, s61, 235520
    s_add_u32 s61, s61, 229376
    buffer_load_dwordx4 v8, s[32:35], s61 offen lds
    v_mfma_f32_32x32x16_bf16 v[32:47], v[236:239], v[88:91], v[32:47]
    buffer_load_dwordx4 v8, s[32:35], s62 offen offset:1024 lds
    v_mfma_f32_32x32x16_bf16 v[48:63], v[232:235], v[92:95], v[48:63]
    s_add_u32 s63, s68, s81
    s_add_u32 s63, s63, 32768
    buffer_load_dwordx4 v[88:91], v9, s[28:31], s63 offen sc1
    v_mfma_f32_32x32x16_bf16 v[64:79], v[236:239], v[92:95], v[64:79]
    buffer_load_dwordx4 v[92:95], v10, s[28:31], s63 offen sc1
    s_waitcnt vmcnt(10)
    s_waitcnt lgkmcnt(0)
    ds_read_b64_tr_b16 v[232:233], v12 offset:6144
    ds_read_b64_tr_b16 v[234:235], v12 offset:7168
    ds_read_b64_tr_b16 v[236:237], v13 offset:6144
    ds_read_b64_tr_b16 v[238:239], v13 offset:7168
    v_mfma_f32_32x32x16_bf16 v[16:31], v[224:227], v[96:99], v[16:31]
    s_add_u32 m0, s70, 4096
    s_add_u32 s61, s60, s78
    s_add_u32 s62, s61, 235520
    s_add_u32 s61, s61, 229376
    buffer_load_dwordx4 v8, s[32:35], s61 offen lds
    v_mfma_f32_32x32x16_bf16 v[32:47], v[228:231], v[96:99], v[32:47]
    buffer_load_dwordx4 v8, s[32:35], s62 offen offset:1024 lds
    v_mfma_f32_32x32x16_bf16 v[48:63], v[224:227], v[100:103], v[48:63]
    s_add_u32 s63, s68, s82
    s_add_u32 s63, s63, 32768
    buffer_load_dwordx4 v[96:99], v9, s[28:31], s63 offen sc1
    v_mfma_f32_32x32x16_bf16 v[64:79], v[228:231], v[100:103], v[64:79]
    buffer_load_dwordx4 v[100:103], v10, s[28:31], s63 offen sc1
    v_xor_b32 v4, 8, v254
    s_mul_i32 s66, s74, 28672
    s_add_u32 s66, s66, 72576
    s_sub_u32 s66, s70, s66
L2_wo:
    ds_read_b32 v7, v4 offset:96
    s_waitcnt lgkmcnt(0)
    v_readfirstlane_b32 s57, v7
    s_cmp_lg_u32 s57, 1
    s_cbranch_scc1 L2_wo
    v_subrev_u32 v4, s66, v12
    v_subrev_u32 v5, s66, v13
    s_waitcnt vmcnt(10)
    ds_read_b64_tr_b16 v[224:225], v12 offset:0
    ds_read_b64_tr_b16 v[226:227], v12 offset:1024
    ds_read_b64_tr_b16 v[228:229], v13 offset:0
    ds_read_b64_tr_b16 v[230:231], v13 offset:1024
    v_mfma_f32_32x32x16_bf16 v[16:31], v[232:235], v[104:107], v[16:31]
    s_add_u32 m0, s70, 6144
    s_add_u32 s61, s60, s79
    s_add_u32 s62, s61, 235520
    s_add_u32 s61, s61, 229376
    buffer_load_dwordx4 v8, s[32:35], s61 offen lds
    v_mfma_f32_32x32x16_bf16 v[32:47], v[236:239], v[104:107], v[32:47]
    buffer_load_dwordx4 v8, s[32:35], s62 offen offset:1024 lds
    v_mfma_f32_32x32x16_bf16 v[48:63], v[232:235], v[108:111], v[48:63]
    s_add_u32 s63, s68, s83
    s_add_u32 s63, s63, 32768
    buffer_load_dwordx4 v[104:107], v9, s[28:31], s63 offen sc1
    v_mfma_f32_32x32x16_bf16 v[64:79], v[236:239], v[108:111], v[64:79]
    buffer_load_dwordx4 v[108:111], v10, s[28:31], s63 offen sc1
    ds_read_b64_tr_b16 v[112:113], v4 offset:0
    ds_read_b64_tr_b16 v[114:115], v4 offset:1024
    ds_read_b64_tr_b16 v[116:117], v5 offset:0
    ds_read_b64_tr_b16 v[118:119], v5 offset:1024
    ds_read_b64_tr_b16 v[120:121], v4 offset:2048
    ds_read_b64_tr_b16 v[122:123], v4 offset:3072
    ds_read_b64_tr_b16 v[124:125], v5 offset:2048
    ds_read_b64_tr_b16 v[126:127], v5 offset:3072
    s_waitcnt vmcnt(10)
    s_waitcnt lgkmcnt(8)
    ds_read_b64_tr_b16 v[232:233], v12 offset:2048
    ds_read_b64_tr_b16 v[234:235], v12 offset:3072
    ds_read_b64_tr_b16 v[236:237], v13 offset:2048
    ds_read_b64_tr_b16 v[238:239], v13 offset:3072
    v_mfma_f32_32x32x16_bf16 v[16:31], v[224:227], v[80:83], v[16:31]
    s_add_u32 m0, s70, 0
    s_add_u32 s61, s52, s76
    s_add_u32 s62, s61, 6144
    s_add_u32 s61, s61, 0
    buffer_load_dwordx4 v8, s[32:35], s61 offen lds
    v_mfma_f32_32x32x16_bf16 v[32:47], v[228:231], v[80:83], v[32:47]
    buffer_load_dwordx4 v8, s[32:35], s62 offen offset:1024 lds
    v_mfma_f32_32x32x16_bf16 v[48:63], v[224:227], v[84:87], v[48:63]
    s_add_u32 s63, s69, s80
    s_add_u32 s63, s63, 0
    buffer_load_dwordx4 v[80:83], v9, s[28:31], s63 offen sc1
    v_mfma_f32_32x32x16_bf16 v[64:79], v[228:231], v[84:87], v[64:79]
    buffer_load_dwordx4 v[84:87], v10, s[28:31], s63 offen sc1
    buffer_load_dwordx4 v[240:243], v253, s[24:27], s88 offen
    buffer_load_dwordx4 v[244:247], v253, s[24:27], s88 offen offset:16
    ds_read_b64_tr_b16 v[128:129], v4 offset:3584
    ds_read_b64_tr_b16 v[130:131], v4 offset:4608
    ds_read_b64_tr_b16 v[132:133], v5 offset:3584
    ds_read_b64_tr_b16 v[134:135], v5 offset:4608
    ds_read_b64_tr_b16 v[136:137], v4 offset:5632
    ds_read_b64_tr_b16 v[138:139], v4 offset:6656
    ds_read_b64_tr_b16 v[140:141], v5 offset:5632
    ds_read_b64_tr_b16 v[142:143], v5 offset:6656
    s_waitcnt vmcnt(12)
    s_waitcnt lgkmcnt(8)
    ds_read_b64_tr_b16 v[224:225], v12 offset:4096
    ds_read_b64_tr_b16 v[226:227], v12 offset:5120
    ds_read_b64_tr_b16 v[228:229], v13 offset:4096
    ds_read_b64_tr_b16 v[230:231], v13 offset:5120
    v_mfma_f32_32x32x16_bf16 v[16:31], v[232:235], v[88:91], v[16:31]
    s_add_u32 m0, s70, 2048
    s_add_u32 s61, s52, s77
    s_add_u32 s62, s61, 6144
    s_add_u32 s61, s61, 0
    buffer_load_dwordx4 v8, s[32:35], s61 offen lds
    v_mfma_f32_32x32x16_bf16 v[32:47], v[236:239], v[88:91], v[32:47]
    buffer_load_dwordx4 v8, s[32:35], s62 offen offset:1024 lds
    v_mfma_f32_32x32x16_bf16 v[48:63], v[232:235], v[92:95], v[48:63]
    s_add_u32 s63, s69, s81
    s_add_u32 s63, s63, 0
    buffer_load_dwordx4 v[88:91], v9, s[28:31], s63 offen sc1
    v_mfma_f32_32x32x16_bf16 v[64:79], v[236:239], v[92:95], v[64:79]
    buffer_load_dwordx4 v[92:95], v10, s[28:31], s63 offen sc1
    ds_read_b64_tr_b16 v[144:145], v4 offset:7168
    ds_read_b64_tr_b16 v[146:147], v4 offset:8192
    ds_read_b64_tr_b16 v[148:149], v5 offset:7168
    ds_read_b64_tr_b16 v[150:151], v5 offset:8192
    ds_read_b64_tr_b16 v[152:153], v4 offset:9216
    ds_read_b64_tr_b16 v[154:155], v4 offset:10240
    ds_read_b64_tr_b16 v[156:157], v5 offset:9216
    ds_read_b64_tr_b16 v[158:159], v5 offset:10240
    s_waitcnt vmcnt(12)
    s_waitcnt lgkmcnt(8)
    ds_read_b64_tr_b16 v[232:233], v12 offset:6144
    ds_read_b64_tr_b16 v[234:235], v12 offset:7168
    ds_read_b64_tr_b16 v[236:237], v13 offset:6144
    ds_read_b64_tr_b16 v[238:239], v13 offset:7168
    v_mfma_f32_32x32x16_bf16 v[16:31], v[224:227], v[96:99], v[16:31]
    s_add_u32 m0, s70, 4096
    s_add_u32 s61, s52, s78
    s_add_u32 s62, s61, 6144
    s_add_u32 s61, s61, 0
    buffer_load_dwordx4 v8, s[32:35], s61 offen lds
    v_mfma_f32_32x32x16_bf16 v[32:47], v[228:231], v[96:99], v[32:47]
    buffer_load_dwordx4 v8, s[32:35], s62 offen offset:1024 lds
    v_mfma_f32_32x32x16_bf16 v[48:63], v[224:227], v[100:103], v[48:63]
    s_add_u32 s63, s69, s82
    s_add_u32 s63, s63, 0
    buffer_load_dwordx4 v[96:99], v9, s[28:31], s63 offen sc1
    v_mfma_f32_32x32x16_bf16 v[64:79], v[228:231], v[100:103], v[64:79]
    buffer_load_dwordx4 v[100:103], v10, s[28:31], s63 offen sc1
    ds_read_b64_tr_b16 v[160:161], v4 offset:10752
    ds_read_b64_tr_b16 v[162:163], v4 offset:11776
    ds_read_b64_tr_b16 v[164:165], v5 offset:10752
    ds_read_b64_tr_b16 v[166:167], v5 offset:11776
    ds_read_b64_tr_b16 v[168:169], v4 offset:12800
    ds_read_b64_tr_b16 v[170:171], v4 offset:13824
    ds_read_b64_tr_b16 v[172:173], v5 offset:12800
    ds_read_b64_tr_b16 v[174:175], v5 offset:13824
    s_waitcnt vmcnt(12)
    s_waitcnt lgkmcnt(8)
    ds_read_b64_tr_b16 v[224:225], v12 offset:0
    ds_read_b64_tr_b16 v[226:227], v12 offset:1024
    ds_read_b64_tr_b16 v[228:229], v13 offset:0
    ds_read_b64_tr_b16 v[230:231], v13 offset:1024
    v_mfma_f32_32x32x16_bf16 v[16:31], v[232:235], v[104:107], v[16:31]
    s_add_u32 m0, s70, 6144
    s_add_u32 s61, s52, s79
    s_add_u32 s62, s61, 6144
    s_add_u32 s61, s61, 0
    buffer_load_dwordx4 v8, s[32:35], s61 offen lds
    v_mfma_f32_32x32x16_bf16 v[32:47], v[236:239], v[104:107], v[32:47]
    buffer_load_dwordx4 v8, s[32:35], s62 offen offset:1024 lds
    v_mfma_f32_32x32x16_bf16 v[48:63], v[232:235], v[108:111], v[48:63]
    s_add_u32 s63, s69, s83
    s_add_u32 s63, s63, 0
    buffer_load_dwordx4 v[104:107], v9, s[28:31], s63 offen sc1
    v_mfma_f32_32x32x16_bf16 v[64:79], v[236:239], v[108:111], v[64:79]
    buffer_load_dwordx4 v[108:111], v10, s[28:31], s63 offen sc1
    ds_read_b64_tr_b16 v[176:177], v4 offset:14336
    ds_read_b64_tr_b16 v[178:179], v4 offset:15360
    ds_read_b64_tr_b16 v[180:181], v5 offset:14336
    ds_read_b64_tr_b16 v[182:183], v5 offset:15360
    ds_read_b64_tr_b16 v[184:185], v4 offset:16384
    ds_read_b64_tr_b16 v[186:187], v4 offset:17408
    ds_read_b64_tr_b16 v[188:189], v5 offset:16384
    ds_read_b64_tr_b16 v[190:191], v5 offset:17408
    s_waitcnt vmcnt(10)
    s_waitcnt lgkmcnt(8)
    ds_read_b64_tr_b16 v[232:233], v12 offset:2048
    ds_read_b64_tr_b16 v[234:235], v12 offset:3072
    ds_read_b64_tr_b16 v[236:237], v13 offset:2048
    ds_read_b64_tr_b16 v[238:239], v13 offset:3072
    v_mfma_f32_32x32x16_bf16 v[16:31], v[224:227], v[80:83], v[16:31]
    v_mfma_f32_32x32x16_bf16 v[32:47], v[228:231], v[80:83], v[32:47]
    v_mfma_f32_32x32x16_bf16 v[48:63], v[224:227], v[84:87], v[48:63]
    v_mfma_f32_32x32x16_bf16 v[64:79], v[228:231], v[84:87], v[64:79]
    ds_read_b64_tr_b16 v[192:193], v4 offset:17920
    ds_read_b64_tr_b16 v[194:195], v4 offset:18944
    ds_read_b64_tr_b16 v[196:197], v5 offset:17920
    ds_read_b64_tr_b16 v[198:199], v5 offset:18944
    ds_read_b64_tr_b16 v[200:201], v4 offset:19968
    ds_read_b64_tr_b16 v[202:203], v4 offset:20992
    ds_read_b64_tr_b16 v[204:205], v5 offset:19968
    ds_read_b64_tr_b16 v[206:207], v5 offset:20992
    s_waitcnt vmcnt(6)
    s_waitcnt lgkmcnt(8)
    ds_read_b64_tr_b16 v[224:225], v12 offset:4096
    ds_read_b64_tr_b16 v[226:227], v12 offset:5120
    ds_read_b64_tr_b16 v[228:229], v13 offset:4096
    ds_read_b64_tr_b16 v[230:231], v13 offset:5120
    v_mfma_f32_32x32x16_bf16 v[16:31], v[232:235], v[88:91], v[16:31]
    v_mfma_f32_32x32x16_bf16 v[32:47], v[236:239], v[88:91], v[32:47]
    v_mfma_f32_32x32x16_bf16 v[48:63], v[232:235], v[92:95], v[48:63]
    v_mfma_f32_32x32x16_bf16 v[64:79], v[236:239], v[92:95], v[64:79]
    ds_read_b64_tr_b16 v[208:209], v4 offset:21504
    ds_read_b64_tr_b16 v[210:211], v4 offset:22528
    ds_read_b64_tr_b16 v[212:213], v5 offset:21504
    ds_read_b64_tr_b16 v[214:215], v5 offset:22528
    ds_read_b64_tr_b16 v[216:217], v4 offset:23552
    ds_read_b64_tr_b16 v[218:219], v4 offset:24576
    ds_read_b64_tr_b16 v[220:221], v5 offset:23552
    ds_read_b64_tr_b16 v[222:223], v5 offset:24576
    s_cmp_lg_u32 s48, 0
    s_cbranch_scc1 L2_Oww
    s_mov_b32 s65, 0x40000
    s_mov_b64 exec, 0xffff
L2_Ow:
    buffer_load_dword v7, v11, s[40:43], 0 offen sc1
    s_sub_u32 s65, s65, 1
    s_cmp_eq_u32 s65, 0
    s_cbranch_scc1 L2_Owx
    s_waitcnt vmcnt(0)
    v_cmp_ne_u32 vcc, s95, v7
    s_cbranch_vccz L2_Owx
    s_mov_b64 exec, vcc
    s_sleep 8
    s_branch L2_Ow
L2_Owx:
    s_mov_b64 exec, -1
    v_mov_b32 v7, 1
    ds_write_b32 v6, v7 offset:68
    s_branch L2_Owd
L2_Oww:
    ds_read_b32 v7, v6 offset:68
    s_waitcnt lgkmcnt(0)
    v_readfirstlane_b32 s65, v7
    s_cmp_eq_u32 s65, 1
    s_cbranch_scc1 L2_Owd
    s_sleep 1
    s_branch L2_Oww
L2_Owd:
    s_waitcnt vmcnt(2)
    s_waitcnt lgkmcnt(8)
    ds_read_b64_tr_b16 v[232:233], v12 offset:6144
    ds_read_b64_tr_b16 v[234:235], v12 offset:7168
    ds_read_b64_tr_b16 v[236:237], v13 offset:6144
    ds_read_b64_tr_b16 v[238:239], v13 offset:7168
    v_mfma_f32_32x32x16_bf16 v[16:31], v[224:227], v[96:99], v[16:31]
    v_mfma_f32_32x32x16_bf16 v[32:47], v[228:231], v[96:99], v[32:47]
    v_mfma_f32_32x32x16_bf16 v[48:63], v[224:227], v[100:103], v[48:63]
    v_mfma_f32_32x32x16_bf16 v[64:79], v[228:231], v[100:103], v[64:79]
    s_waitcnt vmcnt(0)
    s_waitcnt lgkmcnt(0)
    v_mfma_f32_32x32x16_bf16 v[16:31], v[232:235], v[104:107], v[16:31]
    v_mfma_f32_32x32x16_bf16 v[32:47], v[236:239], v[104:107], v[32:47]
    v_mfma_f32_32x32x16_bf16 v[48:63], v[232:235], v[108:111], v[48:63]
    v_mfma_f32_32x32x16_bf16 v[64:79], v[236:239], v[108:111], v[64:79]
    ds_read_b64_tr_b16 v[224:225], v4 offset:25088
    ds_read_b64_tr_b16 v[226:227], v4 offset:26112
    ds_read_b64_tr_b16 v[228:229], v5 offset:25088
    ds_read_b64_tr_b16 v[230:231], v5 offset:26112
    ds_read_b64_tr_b16 v[232:233], v4 offset:27136
    ds_read_b64_tr_b16 v[234:235], v4 offset:28160
    ds_read_b64_tr_b16 v[236:237], v5 offset:27136
    ds_read_b64_tr_b16 v[238:239], v5 offset:28160
    s_lshl_b32 s61, s74, 15
    s_lshl_b32 s64, s54, 16
    s_add_u32 s61, s61, s64
    s_lshl_b32 s64, s75, 10
    s_add_u32 s61, s61, s64
    s_add_u32 s61, s61, 15728640
    s_add_u32 s62, s61, 16384
    buffer_load_dwordx4 v[80:83], v3, s[40:43], s62 offen offset:0 sc1
    buffer_load_dwordx4 v[84:87], v3, s[40:43], s62 offen offset:2048 sc1
    s_add_u32 s62, s61, 20480
    buffer_load_dwordx4 v[88:91], v3, s[40:43], s62 offen offset:0 sc1
    buffer_load_dwordx4 v[92:95], v3, s[40:43], s62 offen offset:2048 sc1
    s_add_u32 s62, s61, 24576
    buffer_load_dwordx4 v[96:99], v3, s[40:43], s62 offen offset:0 sc1
    buffer_load_dwordx4 v[100:103], v3, s[40:43], s62 offen offset:2048 sc1
    s_add_u32 s62, s61, 28672
    buffer_load_dwordx4 v[104:107], v3, s[40:43], s62 offen offset:0 sc1
    buffer_load_dwordx4 v[108:111], v3, s[40:43], s62 offen offset:2048 sc1
    v_add_u32 v4, s70, v3
    v_mov_b32 v0, v254
    v_mov_b32 v7, 1
    ds_write_b128 v4, v[48:51] offset:0
    ds_write_b128 v4, v[52:55] offset:1024
    ds_write_b128 v4, v[56:59] offset:2048
    ds_write_b128 v4, v[60:63] offset:3072
    ds_write_b128 v4, v[64:67] offset:4096
    ds_write_b128 v4, v[68:71] offset:5120
    ds_write_b128 v4, v[72:75] offset:6144
    ds_write_b128 v4, v[76:79] offset:7168
    ds_write_b32 v0, v7 offset:16
    v_xor_b32 v4, 0x4000, v4
    v_xor_b32 v5, 8, v0
    v_lshrrev_b32 v7, 3, v2
    v_mul_u32_u24 v1, 896, v7
    v_and_b32 v9, 7, v2
    v_lshl_add_u32 v1, v9, 4, v1
    v_lshlrev_b32 v9, 1, v9
    v_xor_b32 v9, v9, v7
    v_lshlrev_b32 v9, 4, v9
    v_lshl_add_u32 v9, v7, 8, v9
    s_xor_b32 s64, s70, 0x4000
    s_lshl_b32 s63, s74, 12
    s_add_u32 s63, s63, s64
    v_add_u32 v9, s63, v9
    v_lshrrev_b32 v10, 5, v2
    v_lshlrev_b32 v10, 2, v10
    s_lshl_b32 s63, s74, 3
    v_or_b32 v10, s63, v10
    v_and_b32 v7, 7, v2
    v_xor_b32 v10, v10, v7
    v_lshlrev_b32 v10, 4, v10
    v_and_b32 v7, 31, v2
    v_lshl_add_u32 v10, v7, 8, v10
    v_add_u32 v10, s64, v10
    s_mul_i32 s63, s74, 14272
    s_add_u32 s63, s63, s88
    s_add_u32 s89, s63, 7168
    s_waitcnt lgkmcnt(0)
    s_add_u32 s62, s61, 0
    buffer_load_dwordx4 v[48:51], v3, s[40:43], s62 offen offset:0 sc1
    buffer_load_dwordx4 v[52:55], v3, s[40:43], s62 offen offset:2048 sc1
    s_add_u32 s62, s61, 4096
    buffer_load_dwordx4 v[56:59], v3, s[40:43], s62 offen offset:0 sc1
    buffer_load_dwordx4 v[60:63], v3, s[40:43], s62 offen offset:2048 sc1
    s_add_u32 s62, s61, 8192
    buffer_load_dwordx4 v[64:67], v3, s[40:43], s62 offen offset:0 sc1
    buffer_load_dwordx4 v[68:71], v3, s[40:43], s62 offen offset:2048 sc1
    s_add_u32 s62, s61, 12288
    buffer_load_dwordx4 v[72:75], v3, s[40:43], s62 offen offset:0 sc1
    buffer_load_dwordx4 v[76:79], v3, s[40:43], s62 offen offset:2048 sc1
    v_lshlrev_b32 v248, 16, v240
    v_and_b32 v249, 0xffff0000, v240
    v_add_f32 v16, v16, v248
    v_add_f32 v17, v17, v249
    v_lshlrev_b32 v248, 16, v241
    v_and_b32 v249, 0xffff0000, v241
    v_add_f32 v18, v18, v248
    v_add_f32 v19, v19, v249
    v_lshlrev_b32 v248, 16, v242
    v_and_b32 v249, 0xffff0000, v242
    v_add_f32 v20, v20, v248
    v_add_f32 v21, v21, v249
    v_lshlrev_b32 v248, 16, v243
    v_and_b32 v249, 0xffff0000, v243
    v_add_f32 v22, v22, v248
    v_add_f32 v23, v23, v249
    v_lshlrev_b32 v248, 16, v244
    v_and_b32 v249, 0xffff0000, v244
    v_add_f32 v32, v32, v248
    v_add_f32 v33, v33, v249
    v_lshlrev_b32 v248, 16, v245
    v_and_b32 v249, 0xffff0000, v245
    v_add_f32 v34, v34, v248
    v_add_f32 v35, v35, v249
    v_lshlrev_b32 v248, 16, v246
    v_and_b32 v249, 0xffff0000, v246
    v_add_f32 v36, v36, v248
    v_add_f32 v37, v37, v249
    v_lshlrev_b32 v248, 16, v247
    v_and_b32 v249, 0xffff0000, v247
    v_add_f32 v38, v38, v248
    v_add_f32 v39, v39, v249
L2_gx:
    ds_read_b32 v7, v5 offset:16
    s_waitcnt lgkmcnt(0)
    v_readfirstlane_b32 s66, v7
    s_cmp_eq_u32 s66, 1
    s_cbranch_scc1 L2_gx2
    s_sleep 2
    s_branch L2_gx
L2_gx2:
    ds_read_b128 v[240:243], v4 offset:0
    ds_read_b128 v[244:247], v4 offset:1024
    ds_read_b128 v[248:251], v4 offset:2048
    ds_read_b128 v[252:255], v4 offset:3072
    s_waitcnt lgkmcnt(3)
    v_add_f32 v16, v16, v240
    v_add_f32 v17, v17, v241
    v_add_f32 v18, v18, v242
    v_add_f32 v19, v19, v243
    ds_read_b128 v[240:243], v4 offset:4096
    s_waitcnt lgkmcnt(3)
    v_add_f32 v20, v20, v244
    v_add_f32 v21, v21, v245
    v_add_f32 v22, v22, v246
    v_add_f32 v23, v23, v247
    ds_read_b128 v[244:247], v4 offset:5120
    s_waitcnt lgkmcnt(3)
    v_add_f32 v24, v24, v248
    v_add_f32 v25, v25, v249
    v_add_f32 v26, v26, v250
    v_add_f32 v27, v27, v251
    ds_read_b128 v[248:251], v4 offset:6144
    s_waitcnt lgkmcnt(3)
    v_add_f32 v28, v28, v252
    v_add_f32 v29, v29, v253
    v_add_f32 v30, v30, v254
    v_add_f32 v31, v31, v255
    ds_read_b128 v[252:255], v4 offset:7168
    s_waitcnt lgkmcnt(3)
    v_add_f32 v32, v32, v240
    v_add_f32 v33, v33, v241
    v_add_f32 v34, v34, v242
    v_add_f32 v35, v35, v243
    s_waitcnt lgkmcnt(2)
    v_add_f32 v36, v36, v244
    v_add_f32 v37, v37, v245
    v_add_f32 v38, v38, v246
    v_add_f32 v39, v39, v247
    s_waitcnt lgkmcnt(1)
    v_add_f32 v40, v40, v248
    v_add_f32 v41, v41, v249
    v_add_f32 v42, v42, v250
    v_add_f32 v43, v43, v251
    s_waitcnt lgkmcnt(0)
    v_add_f32 v44, v44, v252
    v_add_f32 v45, v45, v253
    v_add_f32 v46, v46, v254
    v_add_f32 v47, v47, v255
    v_and_b32 v12, 7, v2
    v_lshlrev_b32 v12, 12, v12
    v_add_u32 v12, 3068, v12
    s_mov_b32 s65, 0x8000
    s_mov_b32 s64, -2
    s_movk_i32 s68, 0xff
    v_xor_b32 v4, 16, v9
    v_xor_b32 v5, 0x2000, v9
    v_xor_b32 v11, 0x2010, v9
    v_xor_b32 v6, 4, v0
    v_xor_b32 v241, 16, v10
    v_xor_b32 v242, 128, v10
    v_xor_b32 v243, 144, v10
    v_xor_b32 v244, 32, v10
    v_xor_b32 v245, 48, v10
    v_xor_b32 v246, 160, v10
    v_xor_b32 v247, 176, v10
    s_waitcnt vmcnt(14)
    v_max3_u32 v7, v80, v81, v82
    v_max3_u32 v248, v83, v84, v85
    v_max3_u32 v7, v7, v86, v87
    v_max_u32 v7, v7, v248
    v_cmp_lt_u32 vcc, s64, v7
    s_cbranch_vccnz L2_ua4
    v_mfma_f32_32x32x16_bf16 v[16:31], v[176:179], v[80:83], v[16:31]
    v_mfma_f32_32x32x16_bf16 v[32:47], v[180:183], v[80:83], v[32:47]
    v_mfma_f32_32x32x16_bf16 v[16:31], v[184:187], v[84:87], v[16:31]
    v_mfma_f32_32x32x16_bf16 v[32:47], v[188:191], v[84:87], v[32:47]
    s_bitset0_b32 s68, 4
L2_ua4:
    s_waitcnt vmcnt(12)
    v_max3_u32 v7, v88, v89, v90
    v_max3_u32 v248, v91, v92, v93
    v_max3_u32 v7, v7, v94, v95
    v_max_u32 v7, v7, v248
    v_cmp_lt_u32 vcc, s64, v7
    s_cbranch_vccnz L2_ua5
    v_mfma_f32_32x32x16_bf16 v[16:31], v[192:195], v[88:91], v[16:31]
    v_mfma_f32_32x32x16_bf16 v[32:47], v[196:199], v[88:91], v[32:47]
    v_mfma_f32_32x32x16_bf16 v[16:31], v[200:203], v[92:95], v[16:31]
    v_mfma_f32_32x32x16_bf16 v[32:47], v[204:207], v[92:95], v[32:47]
    s_bitset0_b32 s68, 5
L2_ua5:
    s_waitcnt vmcnt(10)
    v_max3_u32 v7, v96, v97, v98
    v_max3_u32 v248, v99, v100, v101
    v_max3_u32 v7, v7, v102, v103
    v_max_u32 v7, v7, v248
    v_cmp_lt_u32 vcc, s64, v7
    s_cbranch_vccnz L2_ua6
    v_mfma_f32_32x32x16_bf16 v[16:31], v[208:211], v[96:99], v[16:31]
    v_mfma_f32_32x32x16_bf16 v[32:47], v[212:215], v[96:99], v[32:47]
    v_mfma_f32_32x32x16_bf16 v[16:31], v[216:219], v[100:103], v[16:31]
    v_mfma_f32_32x32x16_bf16 v[32:47], v[220:223], v[100:103], v[32:47]
    s_bitset0_b32 s68, 6
L2_ua6:
    s_waitcnt vmcnt(8)
    v_max3_u32 v7, v104, v105, v106
    v_max3_u32 v248, v107, v108, v109
    v_max3_u32 v7, v7, v110, v111
    v_max_u32 v7, v7, v248
    v_cmp_lt_u32 vcc, s64, v7
    s_cbranch_vccnz L2_ua7
    v_mfma_f32_32x32x16_bf16 v[16:31], v[224:227], v[104:107], v[16:31]
    v_mfma_f32_32x32x16_bf16 v[32:47], v[228:231], v[104:107], v[32:47]
    v_mfma_f32_32x32x16_bf16 v[16:31], v[232:235], v[108:111], v[16:31]
    v_mfma_f32_32x32x16_bf16 v[32:47], v[236:239], v[108:111], v[32:47]
    s_bitset0_b32 s68, 7
L2_ua7:
    s_waitcnt vmcnt(6)
    v_max3_u32 v7, v48, v49, v50
    v_max3_u32 v248, v51, v52, v53
    v_max3_u32 v7, v7, v54, v55
    v_max_u32 v7, v7, v248
    v_cmp_lt_u32 vcc, s64, v7
    s_cbranch_vccnz L2_ua0
    v_mfma_f32_32x32x16_bf16 v[16:31], v[112:115], v[48:51], v[16:31]
    v_mfma_f32_32x32x16_bf16 v[32:47], v[116:119], v[48:51], v[32:47]
    v_mfma_f32_32x32x16_bf16 v[16:31], v[120:123], v[52:55], v[16:31]
    v_mfma_f32_32x32x16_bf16 v[32:47], v[124:127], v[52:55], v[32:47]
    s_bitset0_b32 s68, 0
L2_ua0:
    s_waitcnt vmcnt(4)
    v_max3_u32 v7, v56, v57, v58
    v_max3_u32 v248, v59, v60, v61
    v_max3_u32 v7, v7, v62, v63
    v_max_u32 v7, v7, v248
    v_cmp_lt_u32 vcc, s64, v7
    s_cbranch_vccnz L2_ua1
    v_mfma_f32_32x32x16_bf16 v[16:31], v[128:131], v[56:59], v[16:31]
    v_mfma_f32_32x32x16_bf16 v[32:47], v[132:135], v[56:59], v[32:47]
    v_mfma_f32_32x32x16_bf16 v[16:31], v[136:139], v[60:63], v[16:31]
    v_mfma_f32_32x32x16_bf16 v[32:47], v[140:143], v[60:63], v[32:47]
    s_bitset0_b32 s68, 1
L2_ua1:
    s_waitcnt vmcnt(2)
    v_max3_u32 v7, v64, v65, v66
    v_max3_u32 v248, v67, v68, v69
    v_max3_u32 v7, v7, v70, v71
    v_max_u32 v7, v7, v248
    v_cmp_lt_u32 vcc, s64, v7
    s_cbranch_vccnz L2_ua2
    v_mfma_f32_32x32x16_bf16 v[16:31], v[144:147], v[64:67], v[16:31]
    v_mfma_f32_32x32x16_bf16 v[32:47], v[148:151], v[64:67], v[32:47]
    v_mfma_f32_32x32x16_bf16 v[16:31], v[152:155], v[68:71], v[16:31]
    v_mfma_f32_32x32x16_bf16 v[32:47], v[156:159], v[68:71], v[32:47]
    s_bitset0_b32 s68, 2
L2_ua2:
    s_waitcnt vmcnt(0)
    v_max3_u32 v7, v72, v73, v74
    v_max3_u32 v248, v75, v76, v77
    v_max3_u32 v7, v7, v78, v79
    v_max_u32 v7, v7, v248
    v_cmp_lt_u32 vcc, s64, v7
    s_cbranch_vccnz L2_ua3
    v_mfma_f32_32x32x16_bf16 v[16:31], v[160:163], v[72:75], v[16:31]
    v_mfma_f32_32x32x16_bf16 v[32:47], v[164:167], v[72:75], v[32:47]
    v_mfma_f32_32x32x16_bf16 v[16:31], v[168:171], v[76:79], v[16:31]
    v_mfma_f32_32x32x16_bf16 v[32:47], v[172:175], v[76:79], v[32:47]
    s_bitset0_b32 s68, 3
L2_ua3:
L2_round:
    s_cmp_eq_u32 s68, 0
    s_cbranch_scc1 L2_all
    s_sub_u32 s65, s65, 1
    s_cmp_eq_u32 s65, 0
    s_cselect_b32 s64, -1, s64
    s_mov_b32 s69, s68
    s_bcnt1_i32_b32 s66, s68
    s_cmp_le_u32 s66, 4
    s_cbranch_scc1 L2_ld
    s_sleep 2
    buffer_load_dword v7, v12, s[40:43], s61 offen sc1
    s_waitcnt vmcnt(0)
    v_cmp_lt_u32 vcc, s64, v7
    s_nop 0
    s_andn2_b32 s69, s68, vcc_lo
    s_cbranch_scc0 L2_round
L2_ld:
    s_bitcmp0_b32 s69, 0
    s_cbranch_scc1 L2_lb0
    s_add_u32 s62, s61, 0
    buffer_load_dwordx4 v[48:51], v3, s[40:43], s62 offen offset:0 sc1
    buffer_load_dwordx4 v[52:55], v3, s[40:43], s62 offen offset:2048 sc1
L2_lb0:
    s_bitcmp0_b32 s69, 1
    s_cbranch_scc1 L2_lb1
    s_add_u32 s62, s61, 4096
    buffer_load_dwordx4 v[56:59], v3, s[40:43], s62 offen offset:0 sc1
    buffer_load_dwordx4 v[60:63], v3, s[40:43], s62 offen offset:2048 sc1
L2_lb1:
    s_bitcmp0_b32 s69, 2
    s_cbranch_scc1 L2_lb2
    s_add_u32 s62, s61, 8192
    buffer_load_dwordx4 v[64:67], v3, s[40:43], s62 offen offset:0 sc1
    buffer_load_dwordx4 v[68:71], v3, s[40:43], s62 offen offset:2048 sc1
L2_lb2:
    s_bitcmp0_b32 s69, 3
    s_cbranch_scc1 L2_lb3
    s_add_u32 s62, s61, 12288
    buffer_load_dwordx4 v[72:75], v3, s[40:43], s62 offen offset:0 sc1
    buffer_load_dwordx4 v[76:79], v3, s[40:43], s62 offen offset:2048 sc1
L2_lb3:
    s_bitcmp0_b32 s69, 4
    s_cbranch_scc1 L2_lb4
    s_add_u32 s62, s61, 16384
    buffer_load_dwordx4 v[80:83], v3, s[40:43], s62 offen offset:0 sc1
    buffer_load_dwordx4 v[84:87], v3, s[40:43], s62 offen offset:2048 sc1
L2_lb4:
    s_bitcmp0_b32 s69, 5
    s_cbranch_scc1 L2_lb5
    s_add_u32 s62, s61, 20480
    buffer_load_dwordx4 v[88:91], v3, s[40:43], s62 offen offset:0 sc1
    buffer_load_dwordx4 v[92:95], v3, s[40:43], s62 offen offset:2048 sc1
L2_lb5:
    s_bitcmp0_b32 s69, 6
    s_cbranch_scc1 L2_lb6
    s_add_u32 s62, s61, 24576
    buffer_load_dwordx4 v[96:99], v3, s[40:43], s62 offen offset:0 sc1
    buffer_load_dwordx4 v[100:103], v3, s[40:43], s62 offen offset:2048 sc1
L2_lb6:
    s_bitcmp0_b32 s69, 7
    s_cbranch_scc1 L2_lb7
    s_add_u32 s62, s61, 28672
    buffer_load_dwordx4 v[104:107], v3, s[40:43], s62 offen offset:0 sc1
    buffer_load_dwordx4 v[108:111], v3, s[40:43], s62 offen offset:2048 sc1
L2_lb7:
    s_waitcnt vmcnt(0)
    s_bitcmp0_b32 s69, 0
    s_cbranch_scc1 L2_ub0
    v_max3_u32 v7, v48, v49, v50
    v_max3_u32 v248, v51, v52, v53
    v_max3_u32 v7, v7, v54, v55
    v_max_u32 v7, v7, v248
    v_cmp_lt_u32 vcc, s64, v7
    s_cbranch_vccnz L2_ub0
    v_mfma_f32_32x32x16_bf16 v[16:31], v[112:115], v[48:51], v[16:31]
    v_mfma_f32_32x32x16_bf16 v[32:47], v[116:119], v[48:51], v[32:47]
    v_mfma_f32_32x32x16_bf16 v[16:31], v[120:123], v[52:55], v[16:31]
    v_mfma_f32_32x32x16_bf16 v[32:47], v[124:127], v[52:55], v[32:47]
    s_bitset0_b32 s68, 0
L2_ub0:
    s_bitcmp0_b32 s69, 1
    s_cbranch_scc1 L2_ub1
    v_max3_u32 v7, v56, v57, v58
    v_max3_u32 v248, v59, v60, v61
    v_max3_u32 v7, v7, v62, v63
    v_max_u32 v7, v7, v248
    v_cmp_lt_u32 vcc, s64, v7
    s_cbranch_vccnz L2_ub1
    v_mfma_f32_32x32x16_bf16 v[16:31], v[128:131], v[56:59], v[16:31]
    v_mfma_f32_32x32x16_bf16 v[32:47], v[132:135], v[56:59], v[32:47]
    v_mfma_f32_32x32x16_bf16 v[16:31], v[136:139], v[60:63], v[16:31]
    v_mfma_f32_32x32x16_bf16 v[32:47], v[140:143], v[60:63], v[32:47]
    s_bitset0_b32 s68, 1
L2_ub1:
    s_bitcmp0_b32 s69, 2
    s_cbranch_scc1 L2_ub2
    v_max3_u32 v7, v64, v65, v66
    v_max3_u32 v248, v67, v68, v69
    v_max3_u32 v7, v7, v70, v71
    v_max_u32 v7, v7, v248
    v_cmp_lt_u32 vcc, s64, v7
    s_cbranch_vccnz L2_ub2
    v_mfma_f32_32x32x16_bf16 v[16:31], v[144:147], v[64:67], v[16:31]
    v_mfma_f32_32x32x16_bf16 v[32:47], v[148:151], v[64:67], v[32:47]
    v_mfma_f32_32x32x16_bf16 v[16:31], v[152:155], v[68:71], v[16:31]
    v_mfma_f32_32x32x16_bf16 v[32:47], v[156:159], v[68:71], v[32:47]
    s_bitset0_b32 s68, 2
L2_ub2:
    s_bitcmp0_b32 s69, 3
    s_cbranch_scc1 L2_ub3
    v_max3_u32 v7, v72, v73, v74
    v_max3_u32 v248, v75, v76, v77
    v_max3_u32 v7, v7, v78, v79
    v_max_u32 v7, v7, v248
    v_cmp_lt_u32 vcc, s64, v7
    s_cbranch_vccnz L2_ub3
    v_mfma_f32_32x32x16_bf16 v[16:31], v[160:163], v[72:75], v[16:31]
    v_mfma_f32_32x32x16_bf16 v[32:47], v[164:167], v[72:75], v[32:47]
    v_mfma_f32_32x32x16_bf16 v[16:31], v[168:171], v[76:79], v[16:31]
    v_mfma_f32_32x32x16_bf16 v[32:47], v[172:175], v[76:79], v[32:47]
    s_bitset0_b32 s68, 3
L2_ub3:
    s_bitcmp0_b32 s69, 4
    s_cbranch_scc1 L2_ub4
    v_max3_u32 v7, v80, v81, v82
    v_max3_u32 v248, v83, v84, v85
    v_max3_u32 v7, v7, v86, v87
    v_max_u32 v7, v7, v248
    v_cmp_lt_u32 vcc, s64, v7
    s_cbranch_vccnz L2_ub4
    v_mfma_f32_32x32x16_bf16 v[16:31], v[176:179], v[80:83], v[16:31]
    v_mfma_f32_32x32x16_bf16 v[32:47], v[180:183], v[80:83], v[32:47]
    v_mfma_f32_32x32x16_bf16 v[16:31], v[184:187], v[84:87], v[16:31]
    v_mfma_f32_32x32x16_bf16 v[32:47], v[188:191], v[84:87], v[32:47]
    s_bitset0_b32 s68, 4
L2_ub4:
    s_bitcmp0_b32 s69, 5
    s_cbranch_scc1 L2_ub5
    v_max3_u32 v7, v88, v89, v90
    v_max3_u32 v248, v91, v92, v93
    v_max3_u32 v7, v7, v94, v95
    v_max_u32 v7, v7, v248
    v_cmp_lt_u32 vcc, s64, v7
    s_cbranch_vccnz L2_ub5
    v_mfma_f32_32x32x16_bf16 v[16:31], v[192:195], v[88:91], v[16:31]
    v_mfma_f32_32x32x16_bf16 v[32:47], v[196:199], v[88:91], v[32:47]
    v_mfma_f32_32x32x16_bf16 v[16:31], v[200:203], v[92:95], v[16:31]
    v_mfma_f32_32x32x16_bf16 v[32:47], v[204:207], v[92:95], v[32:47]
    s_bitset0_b32 s68, 5
L2_ub5:
    s_bitcmp0_b32 s69, 6
    s_cbranch_scc1 L2_ub6
    v_max3_u32 v7, v96, v97, v98
    v_max3_u32 v248, v99, v100, v101
    v_max3_u32 v7, v7, v102, v103
    v_max_u32 v7, v7, v248
    v_cmp_lt_u32 vcc, s64, v7
    s_cbranch_vccnz L2_ub6
    v_mfma_f32_32x32x16_bf16 v[16:31], v[208:211], v[96:99], v[16:31]
    v_mfma_f32_32x32x16_bf16 v[32:47], v[212:215], v[96:99], v[32:47]
    v_mfma_f32_32x32x16_bf16 v[16:31], v[216:219], v[100:103], v[16:31]
    v_mfma_f32_32x32x16_bf16 v[32:47], v[220:223], v[100:103], v[32:47]
    s_bitset0_b32 s68, 6
L2_ub6:
    s_bitcmp0_b32 s69, 7
    s_cbranch_scc1 L2_ub7
    v_max3_u32 v7, v104, v105, v106
    v_max3_u32 v248, v107, v108, v109
    v_max3_u32 v7, v7, v110, v111
    v_max_u32 v7, v7, v248
    v_cmp_lt_u32 vcc, s64, v7
    s_cbranch_vccnz L2_ub7
    v_mfma_f32_32x32x16_bf16 v[16:31], v[224:227], v[104:107], v[16:31]
    v_mfma_f32_32x32x16_bf16 v[32:47], v[228:231], v[104:107], v[32:47]
    v_mfma_f32_32x32x16_bf16 v[16:31], v[232:235], v[108:111], v[16:31]
    v_mfma_f32_32x32x16_bf16 v[32:47], v[236:239], v[108:111], v[32:47]
    s_bitset0_b32 s68, 7
L2_ub7:
    s_branch L2_round
L2_all:
    v_mov_b32 v7, 1
    s_nop 7
    s_nop 2
    ds_write_b128 v10, v[16:19]
    ds_write_b128 v241, v[20:23]
    ds_write_b128 v242, v[24:27]
    ds_write_b128 v243, v[28:31]
    ds_write_b128 v244, v[32:35]
    ds_write_b128 v245, v[36:39]
    ds_write_b128 v246, v[40:43]
    ds_write_b128 v247, v[44:47]
    ds_write_b32 v0, v7 offset:32
    ds_read_b128 v[48:51], v9 offset:0
    ds_read_b128 v[52:55], v4 offset:0
    ds_read_b128 v[56:59], v9 offset:2048
    ds_read_b128 v[60:63], v4 offset:2048
L2_fx:
    ds_read_b32 v7, v6 offset:32
    ds_read_b128 v[64:67], v5 offset:0
    ds_read_b128 v[68:71], v11 offset:0
    ds_read_b128 v[72:75], v5 offset:2048
    ds_read_b128 v[76:79], v11 offset:2048
    s_waitcnt lgkmcnt(4)
    v_readfirstlane_b32 s66, v7
    s_cmp_lg_u32 s66, 1
    s_cbranch_scc1 L2_fx
    s_waitcnt lgkmcnt(2)
    v_pk_add_f32 v[48:49], v[48:49], v[64:65]
    v_pk_add_f32 v[50:51], v[50:51], v[66:67]
    v_pk_add_f32 v[52:53], v[52:53], v[68:69]
    v_pk_add_f32 v[54:55], v[54:55], v[70:71]
    v_cvt_pk_bf16_f32 v80, v48, v49
    v_cvt_pk_bf16_f32 v81, v50, v51
    v_cvt_pk_bf16_f32 v82, v52, v53
    v_cvt_pk_bf16_f32 v83, v54, v55
    buffer_store_dwordx4 v[80:83], v1, s[36:39], s63 offen sc1
    s_waitcnt lgkmcnt(0)
    v_pk_add_f32 v[56:57], v[56:57], v[72:73]
    v_pk_add_f32 v[58:59], v[58:59], v[74:75]
    v_pk_add_f32 v[60:61], v[60:61], v[76:77]
    v_pk_add_f32 v[62:63], v[62:63], v[78:79]
    v_cvt_pk_bf16_f32 v84, v56, v57
    v_cvt_pk_bf16_f32 v85, v58, v59
    v_cvt_pk_bf16_f32 v86, v60, v61
    v_cvt_pk_bf16_f32 v87, v62, v63
    buffer_store_dwordx4 v[84:87], v1, s[36:39], s89 offen sc1
    s_endpgm
L_end:
    s_endpgm
L1_AP1y:
    s_waitcnt vmcnt(4)
    s_barrier
    v_add_u32 v3, 114688, v3
    v_add_u32 v4, 114688, v4
    v_add_u32 v5, 114688, v5
    v_add_u32 v6, 114688, v6
    ds_read_b64_tr_b16 v[128:129], v3 offset:0
    ds_read_b64_tr_b16 v[130:131], v3 offset:2048
    ds_read_b64_tr_b16 v[132:133], v4 offset:0
    ds_read_b64_tr_b16 v[134:135], v4 offset:2048
    ds_read_b64_tr_b16 v[136:137], v5 offset:0
    ds_read_b64_tr_b16 v[138:139], v5 offset:2048
    ds_read_b64_tr_b16 v[140:141], v6 offset:0
    ds_read_b64_tr_b16 v[142:143], v6 offset:2048
    v_add_u32 v7, 147456, v7
    ds_read_b64_tr_b16 v[144:145], v7 offset:0
    ds_read_b64_tr_b16 v[146:147], v7 offset:256
    s_waitcnt lgkmcnt(6)
    v_mfma_f32_32x32x16_bf16 v[160:175], v[16:19], v[128:131], 0
    ds_read_b64_tr_b16 v[148:149], v7 offset:1024
    ds_read_b64_tr_b16 v[150:151], v7 offset:1280
    v_lshlrev_b32 v152, 16, v48
    v_and_b32 v153, s90, v48
    v_lshlrev_b32 v154, 16, v49
    v_mfma_f32_32x32x16_bf16 v[176:191], v[16:19], v[132:135], 0
    ds_read_b64_tr_b16 v[128:129], v3 offset:4096
    ds_read_b64_tr_b16 v[130:131], v3 offset:6144
    v_and_b32 v155, s90, v49
    v_lshlrev_b32 v156, 16, v50
    s_waitcnt lgkmcnt(6)
    v_mfma_f32_32x32x16_bf16 v[192:207], v[16:19], v[136:139], 0
    ds_read_b64_tr_b16 v[132:133], v4 offset:4096
    ds_read_b64_tr_b16 v[134:135], v4 offset:6144
    v_and_b32 v157, s90, v50
    v_lshlrev_b32 v158, 16, v51
    v_and_b32 v159, s90, v51
    v_mfma_f32_32x32x16_bf16 v[208:223], v[16:19], v[140:143], 0
    ds_read_b64_tr_b16 v[136:137], v5 offset:4096
    ds_read_b64_tr_b16 v[138:139], v5 offset:6144
    v_add_f32 v152, v152, v9
    v_add_f32 v153, v153, v9
    s_waitcnt lgkmcnt(6)
    v_mfma_f32_32x32x16_bf16 v[224:239], v[144:147], v[16:19], 0
    ds_read_b64_tr_b16 v[140:141], v6 offset:4096
    ds_read_b64_tr_b16 v[142:143], v6 offset:6144
    v_add_f32 v154, v154, v9
    v_add_f32 v155, v155, v9
    v_add_f32 v156, v156, v9
    v_mfma_f32_32x32x16_bf16 v[240:255], v[148:151], v[16:19], 0
    ds_read_b64_tr_b16 v[144:145], v7 offset:4096
    ds_read_b64_tr_b16 v[146:147], v7 offset:4352
    v_add_f32 v157, v157, v9
    v_add_f32 v158, v158, v9
    s_waitcnt lgkmcnt(6)
    v_mfma_f32_32x32x16_bf16 v[160:175], v[20:23], v[128:131], v[160:175]
    ds_read_b64_tr_b16 v[148:149], v7 offset:5120
    ds_read_b64_tr_b16 v[150:151], v7 offset:5376
    v_add_f32 v159, v159, v9
    v_cvt_pk_bf16_f32 v48, v152, v153
    v_cvt_pk_bf16_f32 v49, v154, v155
    v_mfma_f32_32x32x16_bf16 v[176:191], v[20:23], v[132:135], v[176:191]
    ds_read_b64_tr_b16 v[128:129], v3 offset:8192
    ds_read_b64_tr_b16 v[130:131], v3 offset:10240
    v_cvt_pk_bf16_f32 v50, v156, v157
    v_cvt_pk_bf16_f32 v51, v158, v159
    s_waitcnt lgkmcnt(6)
    v_mfma_f32_32x32x16_bf16 v[192:207], v[20:23], v[136:139], v[192:207]
    ds_read_b64_tr_b16 v[132:133], v4 offset:8192
    ds_read_b64_tr_b16 v[134:135], v4 offset:10240
    v_lshlrev_b32 v152, 16, v52
    v_and_b32 v153, s90, v52
    v_lshlrev_b32 v154, 16, v53
    v_mfma_f32_32x32x16_bf16 v[208:223], v[20:23], v[140:143], v[208:223]
    ds_read_b64_tr_b16 v[136:137], v5 offset:8192
    ds_read_b64_tr_b16 v[138:139], v5 offset:10240
    v_and_b32 v155, s90, v53
    v_lshlrev_b32 v156, 16, v54
    s_waitcnt lgkmcnt(6)
    v_mfma_f32_32x32x16_bf16 v[224:239], v[144:147], v[20:23], v[224:239]
    ds_read_b64_tr_b16 v[140:141], v6 offset:8192
    ds_read_b64_tr_b16 v[142:143], v6 offset:10240
    v_and_b32 v157, s90, v54
    v_lshlrev_b32 v158, 16, v55
    v_and_b32 v159, s90, v55
    v_mfma_f32_32x32x16_bf16 v[240:255], v[148:151], v[20:23], v[240:255]
    ds_read_b64_tr_b16 v[144:145], v7 offset:8192
    ds_read_b64_tr_b16 v[146:147], v7 offset:8448
    v_add_f32 v152, v152, v9
    v_add_f32 v153, v153, v9
    s_waitcnt lgkmcnt(6)
    v_mfma_f32_32x32x16_bf16 v[160:175], v[24:27], v[128:131], v[160:175]
    ds_read_b64_tr_b16 v[148:149], v7 offset:9216
    ds_read_b64_tr_b16 v[150:151], v7 offset:9472
    v_add_f32 v154, v154, v9
    v_add_f32 v155, v155, v9
    v_add_f32 v156, v156, v9
    v_mfma_f32_32x32x16_bf16 v[176:191], v[24:27], v[132:135], v[176:191]
    ds_read_b64_tr_b16 v[128:129], v3 offset:12288
    ds_read_b64_tr_b16 v[130:131], v3 offset:14336
    v_add_f32 v157, v157, v9
    v_add_f32 v158, v158, v9
    s_waitcnt lgkmcnt(6)
    v_mfma_f32_32x32x16_bf16 v[192:207], v[24:27], v[136:139], v[192:207]
    ds_read_b64_tr_b16 v[132:133], v4 offset:12288
    ds_read_b64_tr_b16 v[134:135], v4 offset:14336
    v_add_f32 v159, v159, v9
    v_cvt_pk_bf16_f32 v52, v152, v153
    v_cvt_pk_bf16_f32 v53, v154, v155
    v_mfma_f32_32x32x16_bf16 v[208:223], v[24:27], v[140:143], v[208:223]
    ds_read_b64_tr_b16 v[136:137], v5 offset:12288
    ds_read_b64_tr_b16 v[138:139], v5 offset:14336
    v_cvt_pk_bf16_f32 v54, v156, v157
    v_cvt_pk_bf16_f32 v55, v158, v159
    s_waitcnt lgkmcnt(6)
    v_mfma_f32_32x32x16_bf16 v[224:239], v[144:147], v[24:27], v[224:239]
    ds_read_b64_tr_b16 v[140:141], v6 offset:12288
    ds_read_b64_tr_b16 v[142:143], v6 offset:14336
    v_lshlrev_b32 v152, 16, v56
    v_and_b32 v153, s90, v56
    v_lshlrev_b32 v154, 16, v57
    v_mfma_f32_32x32x16_bf16 v[240:255], v[148:151], v[24:27], v[240:255]
    ds_read_b64_tr_b16 v[144:145], v7 offset:12288
    ds_read_b64_tr_b16 v[146:147], v7 offset:12544
    v_and_b32 v155, s90, v57
    v_lshlrev_b32 v156, 16, v58
    s_waitcnt lgkmcnt(6)
    v_mfma_f32_32x32x16_bf16 v[160:175], v[28:31], v[128:131], v[160:175]
    ds_read_b64_tr_b16 v[148:149], v7 offset:13312
    ds_read_b64_tr_b16 v[150:151], v7 offset:13568
    v_and_b32 v157, s90, v58
    v_lshlrev_b32 v158, 16, v59
    v_and_b32 v159, s90, v59
    v_mfma_f32_32x32x16_bf16 v[176:191], v[28:31], v[132:135], v[176:191]
    s_waitcnt vmcnt(0)
    s_barrier
    ds_read_b64_tr_b16 v[128:129], v3 offset:16384
    ds_read_b64_tr_b16 v[130:131], v3 offset:18432
    v_add_f32 v152, v152, v9
    v_add_f32 v153, v153, v9
    s_waitcnt lgkmcnt(6)
    v_mfma_f32_32x32x16_bf16 v[192:207], v[28:31], v[136:139], v[192:207]
    ds_read_b64_tr_b16 v[132:133], v4 offset:16384
    ds_read_b64_tr_b16 v[134:135], v4 offset:18432
    v_add_f32 v154, v154, v9
    v_add_f32 v155, v155, v9
    v_add_f32 v156, v156, v9
    v_mfma_f32_32x32x16_bf16 v[208:223], v[28:31], v[140:143], v[208:223]
    ds_read_b64_tr_b16 v[136:137], v5 offset:16384
    ds_read_b64_tr_b16 v[138:139], v5 offset:18432
    v_add_f32 v157, v157, v9
    v_add_f32 v158, v158, v9
    s_waitcnt lgkmcnt(6)
    v_mfma_f32_32x32x16_bf16 v[224:239], v[144:147], v[28:31], v[224:239]
    ds_read_b64_tr_b16 v[140:141], v6 offset:16384
    ds_read_b64_tr_b16 v[142:143], v6 offset:18432
    v_add_f32 v159, v159, v9
    v_cvt_pk_bf16_f32 v56, v152, v153
    v_cvt_pk_bf16_f32 v57, v154, v155
    v_mfma_f32_32x32x16_bf16 v[240:255], v[148:151], v[28:31], v[240:255]
    ds_read_b64_tr_b16 v[144:145], v7 offset:2048
    ds_read_b64_tr_b16 v[146:147], v7 offset:2304
    v_cvt_pk_bf16_f32 v58, v156, v157
    v_cvt_pk_bf16_f32 v59, v158, v159
    s_waitcnt lgkmcnt(6)
    v_mfma_f32_32x32x16_bf16 v[160:175], v[32:35], v[128:131], v[160:175]
    ds_read_b64_tr_b16 v[148:149], v7 offset:3072
    ds_read_b64_tr_b16 v[150:151], v7 offset:3328
    v_lshlrev_b32 v152, 16, v60
    v_and_b32 v153, s90, v60
    v_lshlrev_b32 v154, 16, v61
    v_mfma_f32_32x32x16_bf16 v[176:191], v[32:35], v[132:135], v[176:191]
    ds_read_b64_tr_b16 v[128:129], v3 offset:20480
    ds_read_b64_tr_b16 v[130:131], v3 offset:22528
    v_and_b32 v155, s90, v61
    v_lshlrev_b32 v156, 16, v62
    s_waitcnt lgkmcnt(6)
    v_mfma_f32_32x32x16_bf16 v[192:207], v[32:35], v[136:139], v[192:207]
    ds_read_b64_tr_b16 v[132:133], v4 offset:20480
    ds_read_b64_tr_b16 v[134:135], v4 offset:22528
    v_and_b32 v157, s90, v62
    v_lshlrev_b32 v158, 16, v63
    v_and_b32 v159, s90, v63
    v_mfma_f32_32x32x16_bf16 v[208:223], v[32:35], v[140:143], v[208:223]
    ds_read_b64_tr_b16 v[136:137], v5 offset:20480
    ds_read_b64_tr_b16 v[138:139], v5 offset:22528
    v_add_f32 v152, v152, v9
    v_add_f32 v153, v153, v9
    s_waitcnt lgkmcnt(6)
    v_mfma_f32_32x32x16_bf16 v[224:239], v[144:147], v[32:35], v[224:239]
    ds_read_b64_tr_b16 v[140:141], v6 offset:20480
    ds_read_b64_tr_b16 v[142:143], v6 offset:22528
    v_add_f32 v154, v154, v9
    v_add_f32 v155, v155, v9
    v_add_f32 v156, v156, v9
    v_mfma_f32_32x32x16_bf16 v[240:255], v[148:151], v[32:35], v[240:255]
    ds_read_b64_tr_b16 v[144:145], v7 offset:6144
    ds_read_b64_tr_b16 v[146:147], v7 offset:6400
    v_add_f32 v157, v157, v9
    v_add_f32 v158, v158, v9
    s_waitcnt lgkmcnt(6)
    v_mfma_f32_32x32x16_bf16 v[160:175], v[36:39], v[128:131], v[160:175]
    ds_read_b64_tr_b16 v[148:149], v7 offset:7168
    ds_read_b64_tr_b16 v[150:151], v7 offset:7424
    v_add_f32 v159, v159, v9
    v_cvt_pk_bf16_f32 v60, v152, v153
    v_cvt_pk_bf16_f32 v61, v154, v155
    v_mfma_f32_32x32x16_bf16 v[176:191], v[36:39], v[132:135], v[176:191]
    ds_read_b64_tr_b16 v[128:129], v3 offset:24576
    ds_read_b64_tr_b16 v[130:131], v3 offset:26624
    v_cvt_pk_bf16_f32 v62, v156, v157
    v_cvt_pk_bf16_f32 v63, v158, v159
    s_waitcnt lgkmcnt(6)
    v_mfma_f32_32x32x16_bf16 v[192:207], v[36:39], v[136:139], v[192:207]
    ds_read_b64_tr_b16 v[132:133], v4 offset:24576
    ds_read_b64_tr_b16 v[134:135], v4 offset:26624
    v_lshlrev_b32 v152, 16, v64
    v_and_b32 v153, s90, v64
    v_mfma_f32_32x32x16_bf16 v[208:223], v[36:39], v[140:143], v[208:223]
    ds_read_b64_tr_b16 v[136:137], v5 offset:24576
    ds_read_b64_tr_b16 v[138:139], v5 offset:26624
    v_lshlrev_b32 v154, 16, v65
    v_and_b32 v155, s90, v65
    v_lshlrev_b32 v156, 16, v66
    s_waitcnt lgkmcnt(6)
    v_mfma_f32_32x32x16_bf16 v[224:239], v[144:147], v[36:39], v[224:239]
    ds_read_b64_tr_b16 v[140:141], v6 offset:24576
    ds_read_b64_tr_b16 v[142:143], v6 offset:26624
    v_and_b32 v157, s90, v66
    v_lshlrev_b32 v158, 16, v67
    v_mfma_f32_32x32x16_bf16 v[240:255], v[148:151], v[36:39], v[240:255]
    ds_read_b64_tr_b16 v[144:145], v7 offset:10240
    ds_read_b64_tr_b16 v[146:147], v7 offset:10496
    v_and_b32 v159, s90, v67
    v_add_f32 v152, v152, v9
    v_add_f32 v153, v153, v9
    s_waitcnt lgkmcnt(6)
    v_mfma_f32_32x32x16_bf16 v[160:175], v[40:43], v[128:131], v[160:175]
    ds_read_b64_tr_b16 v[148:149], v7 offset:11264
    ds_read_b64_tr_b16 v[150:151], v7 offset:11520
    v_add_f32 v154, v154, v9
    v_add_f32 v155, v155, v9
    v_mfma_f32_32x32x16_bf16 v[176:191], v[40:43], v[132:135], v[176:191]
    ds_read_b64_tr_b16 v[128:129], v3 offset:28672
    ds_read_b64_tr_b16 v[130:131], v3 offset:30720
    v_add_f32 v156, v156, v9
    v_add_f32 v157, v157, v9
    v_add_f32 v158, v158, v9
    s_waitcnt lgkmcnt(6)
    v_mfma_f32_32x32x16_bf16 v[192:207], v[40:43], v[136:139], v[192:207]
    ds_read_b64_tr_b16 v[132:133], v4 offset:28672
    ds_read_b64_tr_b16 v[134:135], v4 offset:30720
    v_add_f32 v159, v159, v9
    v_cvt_pk_bf16_f32 v64, v152, v153
    v_mfma_f32_32x32x16_bf16 v[208:223], v[40:43], v[140:143], v[208:223]
    ds_read_b64_tr_b16 v[136:137], v5 offset:28672
    ds_read_b64_tr_b16 v[138:139], v5 offset:30720
    v_cvt_pk_bf16_f32 v65, v154, v155
    v_cvt_pk_bf16_f32 v66, v156, v157
    v_cvt_pk_bf16_f32 v67, v158, v159
    s_waitcnt lgkmcnt(6)
    v_mfma_f32_32x32x16_bf16 v[224:239], v[144:147], v[40:43], v[224:239]
    ds_read_b64_tr_b16 v[140:141], v6 offset:28672
    ds_read_b64_tr_b16 v[142:143], v6 offset:30720
    v_lshlrev_b32 v152, 16, v68
    v_and_b32 v153, s90, v68
    v_mfma_f32_32x32x16_bf16 v[240:255], v[148:151], v[40:43], v[240:255]
    ds_read_b64_tr_b16 v[144:145], v7 offset:14336
    ds_read_b64_tr_b16 v[146:147], v7 offset:14592
    v_lshlrev_b32 v154, 16, v69
    v_and_b32 v155, s90, v69
    v_lshlrev_b32 v156, 16, v70
    s_waitcnt lgkmcnt(6)
    v_mfma_f32_32x32x16_bf16 v[160:175], v[44:47], v[128:131], v[160:175]
    ds_read_b64_tr_b16 v[148:149], v7 offset:15360
    ds_read_b64_tr_b16 v[150:151], v7 offset:15616
    v_and_b32 v157, s90, v70
    v_lshlrev_b32 v158, 16, v71
    v_mfma_f32_32x32x16_bf16 v[176:191], v[44:47], v[132:135], v[176:191]
    s_barrier
    v_subrev_u32 v3, 114688, v3
    v_subrev_u32 v4, 114688, v4
    v_subrev_u32 v5, 114688, v5
    v_subrev_u32 v6, 114688, v6
    ds_read_b64_tr_b16 v[128:129], v3 offset:0
    ds_read_b64_tr_b16 v[130:131], v3 offset:2048
    v_and_b32 v159, s90, v71
    v_add_f32 v152, v152, v9
    v_add_f32 v153, v153, v9
    s_waitcnt lgkmcnt(6)
    v_mfma_f32_32x32x16_bf16 v[192:207], v[44:47], v[136:139], v[192:207]
    ds_read_b64_tr_b16 v[132:133], v4 offset:0
    ds_read_b64_tr_b16 v[134:135], v4 offset:2048
    v_add_f32 v154, v154, v9
    v_add_f32 v155, v155, v9
    v_mfma_f32_32x32x16_bf16 v[208:223], v[44:47], v[140:143], v[208:223]
    ds_read_b64_tr_b16 v[136:137], v5 offset:0
    ds_read_b64_tr_b16 v[138:139], v5 offset:2048
    v_add_f32 v156, v156, v9
    v_add_f32 v157, v157, v9
    v_add_f32 v158, v158, v9
    s_waitcnt lgkmcnt(6)
    v_mfma_f32_32x32x16_bf16 v[224:239], v[144:147], v[44:47], v[224:239]
    ds_read_b64_tr_b16 v[140:141], v6 offset:0
    ds_read_b64_tr_b16 v[142:143], v6 offset:2048
    v_add_f32 v159, v159, v9
    v_cvt_pk_bf16_f32 v68, v152, v153
    v_mfma_f32_32x32x16_bf16 v[240:255], v[148:151], v[44:47], v[240:255]
    v_subrev_u32 v7, 131072, v7
    ds_read_b64_tr_b16 v[144:145], v7 offset:0
    ds_read_b64_tr_b16 v[146:147], v7 offset:256
    v_cvt_pk_bf16_f32 v69, v154, v155
    v_cvt_pk_bf16_f32 v70, v156, v157
    v_cvt_pk_bf16_f32 v71, v158, v159
    s_waitcnt lgkmcnt(6)
    v_mfma_f32_32x32x16_bf16 v[160:175], v[48:51], v[128:131], v[160:175]
    ds_read_b64_tr_b16 v[148:149], v7 offset:1024
    ds_read_b64_tr_b16 v[150:151], v7 offset:1280
    v_lshlrev_b32 v152, 16, v72
    v_and_b32 v153, s90, v72
    v_mfma_f32_32x32x16_bf16 v[176:191], v[48:51], v[132:135], v[176:191]
    ds_read_b64_tr_b16 v[128:129], v3 offset:4096
    ds_read_b64_tr_b16 v[130:131], v3 offset:6144
    v_lshlrev_b32 v154, 16, v73
    v_and_b32 v155, s90, v73
    v_lshlrev_b32 v156, 16, v74
    s_waitcnt lgkmcnt(6)
    v_mfma_f32_32x32x16_bf16 v[192:207], v[48:51], v[136:139], v[192:207]
    ds_read_b64_tr_b16 v[132:133], v4 offset:4096
    ds_read_b64_tr_b16 v[134:135], v4 offset:6144
    v_and_b32 v157, s90, v74
    v_lshlrev_b32 v158, 16, v75
    v_mfma_f32_32x32x16_bf16 v[208:223], v[48:51], v[140:143], v[208:223]
    ds_read_b64_tr_b16 v[136:137], v5 offset:4096
    ds_read_b64_tr_b16 v[138:139], v5 offset:6144
    v_and_b32 v159, s90, v75
    v_add_f32 v152, v152, v9
    v_add_f32 v153, v153, v9
    s_waitcnt lgkmcnt(6)
    v_mfma_f32_32x32x16_bf16 v[224:239], v[144:147], v[48:51], v[224:239]
    ds_read_b64_tr_b16 v[140:141], v6 offset:4096
    ds_read_b64_tr_b16 v[142:143], v6 offset:6144
    v_add_f32 v154, v154, v9
    v_add_f32 v155, v155, v9
    v_mfma_f32_32x32x16_bf16 v[240:255], v[148:151], v[48:51], v[240:255]
    ds_read_b64_tr_b16 v[144:145], v7 offset:4096
    ds_read_b64_tr_b16 v[146:147], v7 offset:4352
    v_add_f32 v156, v156, v9
    v_add_f32 v157, v157, v9
    v_add_f32 v158, v158, v9
    s_waitcnt lgkmcnt(6)
    v_mfma_f32_32x32x16_bf16 v[160:175], v[52:55], v[128:131], v[160:175]
    ds_read_b64_tr_b16 v[148:149], v7 offset:5120
    ds_read_b64_tr_b16 v[150:151], v7 offset:5376
    v_add_f32 v159, v159, v9
    v_cvt_pk_bf16_f32 v72, v152, v153
    v_mfma_f32_32x32x16_bf16 v[176:191], v[52:55], v[132:135], v[176:191]
    ds_read_b64_tr_b16 v[128:129], v3 offset:8192
    ds_read_b64_tr_b16 v[130:131], v3 offset:10240
    v_cvt_pk_bf16_f32 v73, v154, v155
    v_cvt_pk_bf16_f32 v74, v156, v157
    v_cvt_pk_bf16_f32 v75, v158, v159
    s_waitcnt lgkmcnt(6)
    v_mfma_f32_32x32x16_bf16 v[192:207], v[52:55], v[136:139], v[192:207]
    ds_read_b64_tr_b16 v[132:133], v4 offset:8192
    ds_read_b64_tr_b16 v[134:135], v4 offset:10240
    v_lshlrev_b32 v152, 16, v76
    v_and_b32 v153, s90, v76
    v_mfma_f32_32x32x16_bf16 v[208:223], v[52:55], v[140:143], v[208:223]
    ds_read_b64_tr_b16 v[136:137], v5 offset:8192
    ds_read_b64_tr_b16 v[138:139], v5 offset:10240
    v_lshlrev_b32 v154, 16, v77
    v_and_b32 v155, s90, v77
    v_lshlrev_b32 v156, 16, v78
    s_waitcnt lgkmcnt(6)
    v_mfma_f32_32x32x16_bf16 v[224:239], v[144:147], v[52:55], v[224:239]
    ds_read_b64_tr_b16 v[140:141], v6 offset:8192
    ds_read_b64_tr_b16 v[142:143], v6 offset:10240
    v_and_b32 v157, s90, v78
    v_lshlrev_b32 v158, 16, v79
    v_mfma_f32_32x32x16_bf16 v[240:255], v[148:151], v[52:55], v[240:255]
    ds_read_b64_tr_b16 v[144:145], v7 offset:8192
    ds_read_b64_tr_b16 v[146:147], v7 offset:8448
    s_mov_b64 exec, 0x3fff
    buffer_load_dword v12, v11, s[28:31], s74 offen
    s_mov_b64 exec, 0xf
    buffer_load_dword v12, v11, s[32:35], s75 offen
    s_mov_b64 exec, -1
    s_add_u32 s74, s74, 1792
    s_add_u32 s75, s75, 512
    v_and_b32 v159, s90, v79
    v_add_f32 v152, v152, v9
    v_add_f32 v153, v153, v9
    s_waitcnt lgkmcnt(6)
    v_mfma_f32_32x32x16_bf16 v[160:175], v[56:59], v[128:131], v[160:175]
    ds_read_b64_tr_b16 v[148:149], v7 offset:9216
    ds_read_b64_tr_b16 v[150:151], v7 offset:9472
    v_add_f32 v154, v154, v9
    v_add_f32 v155, v155, v9
    v_mfma_f32_32x32x16_bf16 v[176:191], v[56:59], v[132:135], v[176:191]
    ds_read_b64_tr_b16 v[128:129], v3 offset:12288
    ds_read_b64_tr_b16 v[130:131], v3 offset:14336
    v_add_f32 v156, v156, v9
    v_add_f32 v157, v157, v9
    v_add_f32 v158, v158, v9
    s_waitcnt lgkmcnt(6)
    v_mfma_f32_32x32x16_bf16 v[192:207], v[56:59], v[136:139], v[192:207]
    ds_read_b64_tr_b16 v[132:133], v4 offset:12288
    ds_read_b64_tr_b16 v[134:135], v4 offset:14336
    v_add_f32 v159, v159, v9
    v_cvt_pk_bf16_f32 v76, v152, v153
    v_mfma_f32_32x32x16_bf16 v[208:223], v[56:59], v[140:143], v[208:223]
    ds_read_b64_tr_b16 v[136:137], v5 offset:12288
    ds_read_b64_tr_b16 v[138:139], v5 offset:14336
    v_cvt_pk_bf16_f32 v77, v154, v155
    v_cvt_pk_bf16_f32 v78, v156, v157
    v_cvt_pk_bf16_f32 v79, v158, v159
    s_waitcnt lgkmcnt(6)
    v_mfma_f32_32x32x16_bf16 v[224:239], v[144:147], v[56:59], v[224:239]
    ds_read_b64_tr_b16 v[140:141], v6 offset:12288
    ds_read_b64_tr_b16 v[142:143], v6 offset:14336
    v_lshlrev_b32 v152, 16, v80
    v_and_b32 v153, s90, v80
    v_mfma_f32_32x32x16_bf16 v[240:255], v[148:151], v[56:59], v[240:255]
    ds_read_b64_tr_b16 v[144:145], v7 offset:12288
    ds_read_b64_tr_b16 v[146:147], v7 offset:12544
    v_lshlrev_b32 v154, 16, v81
    v_and_b32 v155, s90, v81
    s_waitcnt lgkmcnt(6)
    v_mfma_f32_32x32x16_bf16 v[160:175], v[60:63], v[128:131], v[160:175]
    ds_read_b64_tr_b16 v[148:149], v7 offset:13312
    ds_read_b64_tr_b16 v[150:151], v7 offset:13568
    v_lshlrev_b32 v156, 16, v82
    v_and_b32 v157, s90, v82
    v_lshlrev_b32 v158, 16, v83
    v_mfma_f32_32x32x16_bf16 v[176:191], v[60:63], v[132:135], v[176:191]
    s_barrier
    ds_read_b64_tr_b16 v[128:129], v3 offset:32768
    ds_read_b64_tr_b16 v[130:131], v3 offset:34816
    v_and_b32 v159, s90, v83
    v_add_f32 v152, v152, v9
    s_waitcnt lgkmcnt(6)
    v_mfma_f32_32x32x16_bf16 v[192:207], v[60:63], v[136:139], v[192:207]
    ds_read_b64_tr_b16 v[132:133], v4 offset:32768
    ds_read_b64_tr_b16 v[134:135], v4 offset:34816
    v_add_f32 v153, v153, v9
    v_add_f32 v154, v154, v9
    v_add_f32 v155, v155, v9
    v_mfma_f32_32x32x16_bf16 v[208:223], v[60:63], v[140:143], v[208:223]
    ds_read_b64_tr_b16 v[136:137], v5 offset:32768
    ds_read_b64_tr_b16 v[138:139], v5 offset:34816
    v_add_f32 v156, v156, v9
    v_add_f32 v157, v157, v9
    s_waitcnt lgkmcnt(6)
    v_mfma_f32_32x32x16_bf16 v[224:239], v[144:147], v[60:63], v[224:239]
    ds_read_b64_tr_b16 v[140:141], v6 offset:32768
    ds_read_b64_tr_b16 v[142:143], v6 offset:34816
    v_add_f32 v158, v158, v9
    v_add_f32 v159, v159, v9
    v_cvt_pk_bf16_f32 v80, v152, v153
    v_mfma_f32_32x32x16_bf16 v[240:255], v[148:151], v[60:63], v[240:255]
    ds_read_b64_tr_b16 v[144:145], v7 offset:2048
    ds_read_b64_tr_b16 v[146:147], v7 offset:2304
    v_cvt_pk_bf16_f32 v81, v154, v155
    v_cvt_pk_bf16_f32 v82, v156, v157
    s_waitcnt lgkmcnt(6)
    v_mfma_f32_32x32x16_bf16 v[160:175], v[64:67], v[128:131], v[160:175]
    ds_read_b64_tr_b16 v[148:149], v7 offset:3072
    ds_read_b64_tr_b16 v[150:151], v7 offset:3328
    v_cvt_pk_bf16_f32 v83, v158, v159
    v_lshlrev_b32 v152, 16, v84
    v_and_b32 v153, s90, v84
    v_mfma_f32_32x32x16_bf16 v[176:191], v[64:67], v[132:135], v[176:191]
    ds_read_b64_tr_b16 v[128:129], v3 offset:36864
    ds_read_b64_tr_b16 v[130:131], v3 offset:38912
    v_lshlrev_b32 v154, 16, v85
    v_and_b32 v155, s90, v85
    s_waitcnt lgkmcnt(6)
    v_mfma_f32_32x32x16_bf16 v[192:207], v[64:67], v[136:139], v[192:207]
    ds_read_b64_tr_b16 v[132:133], v4 offset:36864
    ds_read_b64_tr_b16 v[134:135], v4 offset:38912
    v_lshlrev_b32 v156, 16, v86
    v_and_b32 v157, s90, v86
    v_lshlrev_b32 v158, 16, v87
    v_mfma_f32_32x32x16_bf16 v[208:223], v[64:67], v[140:143], v[208:223]
    ds_read_b64_tr_b16 v[136:137], v5 offset:36864
    ds_read_b64_tr_b16 v[138:139], v5 offset:38912
    v_and_b32 v159, s90, v87
    v_add_f32 v152, v152, v9
    s_waitcnt lgkmcnt(6)
    v_mfma_f32_32x32x16_bf16 v[224:239], v[144:147], v[64:67], v[224:239]
    ds_read_b64_tr_b16 v[140:141], v6 offset:36864
    ds_read_b64_tr_b16 v[142:143], v6 offset:38912
    v_add_f32 v153, v153, v9
    v_add_f32 v154, v154, v9
    v_add_f32 v155, v155, v9
    v_mfma_f32_32x32x16_bf16 v[240:255], v[148:151], v[64:67], v[240:255]
    ds_read_b64_tr_b16 v[144:145], v7 offset:6144
    ds_read_b64_tr_b16 v[146:147], v7 offset:6400
    v_add_f32 v156, v156, v9
    v_add_f32 v157, v157, v9
    s_waitcnt lgkmcnt(6)
    v_mfma_f32_32x32x16_bf16 v[160:175], v[68:71], v[128:131], v[160:175]
    ds_read_b64_tr_b16 v[148:149], v7 offset:7168
    ds_read_b64_tr_b16 v[150:151], v7 offset:7424
    v_add_f32 v158, v158, v9
    v_add_f32 v159, v159, v9
    v_cvt_pk_bf16_f32 v84, v152, v153
    v_mfma_f32_32x32x16_bf16 v[176:191], v[68:71], v[132:135], v[176:191]
    ds_read_b64_tr_b16 v[128:129], v3 offset:40960
    ds_read_b64_tr_b16 v[130:131], v3 offset:43008
    v_cvt_pk_bf16_f32 v85, v154, v155
    v_cvt_pk_bf16_f32 v86, v156, v157
    s_waitcnt lgkmcnt(6)
    v_mfma_f32_32x32x16_bf16 v[192:207], v[68:71], v[136:139], v[192:207]
    ds_read_b64_tr_b16 v[132:133], v4 offset:40960
    ds_read_b64_tr_b16 v[134:135], v4 offset:43008
    v_cvt_pk_bf16_f32 v87, v158, v159
    v_lshlrev_b32 v152, 16, v88
    v_and_b32 v153, s90, v88
    v_mfma_f32_32x32x16_bf16 v[208:223], v[68:71], v[140:143], v[208:223]
    ds_read_b64_tr_b16 v[136:137], v5 offset:40960
    ds_read_b64_tr_b16 v[138:139], v5 offset:43008
    v_lshlrev_b32 v154, 16, v89
    v_and_b32 v155, s90, v89
    s_waitcnt lgkmcnt(6)
    v_mfma_f32_32x32x16_bf16 v[224:239], v[144:147], v[68:71], v[224:239]
    ds_read_b64_tr_b16 v[140:141], v6 offset:40960
    ds_read_b64_tr_b16 v[142:143], v6 offset:43008
    v_lshlrev_b32 v156, 16, v90
    v_and_b32 v157, s90, v90
    v_lshlrev_b32 v158, 16, v91
    v_mfma_f32_32x32x16_bf16 v[240:255], v[148:151], v[68:71], v[240:255]
    ds_read_b64_tr_b16 v[144:145], v7 offset:10240
    ds_read_b64_tr_b16 v[146:147], v7 offset:10496
    v_and_b32 v159, s90, v91
    v_add_f32 v152, v152, v9
    s_waitcnt lgkmcnt(6)
    v_mfma_f32_32x32x16_bf16 v[160:175], v[72:75], v[128:131], v[160:175]
    ds_read_b64_tr_b16 v[148:149], v7 offset:11264
    ds_read_b64_tr_b16 v[150:151], v7 offset:11520
    v_add_f32 v153, v153, v9
    v_add_f32 v154, v154, v9
    v_add_f32 v155, v155, v9
    v_mfma_f32_32x32x16_bf16 v[176:191], v[72:75], v[132:135], v[176:191]
    ds_read_b64_tr_b16 v[128:129], v3 offset:45056
    ds_read_b64_tr_b16 v[130:131], v3 offset:47104
    v_add_f32 v156, v156, v9
    v_add_f32 v157, v157, v9
    s_waitcnt lgkmcnt(6)
    v_mfma_f32_32x32x16_bf16 v[192:207], v[72:75], v[136:139], v[192:207]
    ds_read_b64_tr_b16 v[132:133], v4 offset:45056
    ds_read_b64_tr_b16 v[134:135], v4 offset:47104
    v_add_f32 v158, v158, v9
    v_add_f32 v159, v159, v9
    v_cvt_pk_bf16_f32 v88, v152, v153
    v_mfma_f32_32x32x16_bf16 v[208:223], v[72:75], v[140:143], v[208:223]
    ds_read_b64_tr_b16 v[136:137], v5 offset:45056
    ds_read_b64_tr_b16 v[138:139], v5 offset:47104
    v_cvt_pk_bf16_f32 v89, v154, v155
    v_cvt_pk_bf16_f32 v90, v156, v157
    s_waitcnt lgkmcnt(6)
    v_mfma_f32_32x32x16_bf16 v[224:239], v[144:147], v[72:75], v[224:239]
    ds_read_b64_tr_b16 v[140:141], v6 offset:45056
    ds_read_b64_tr_b16 v[142:143], v6 offset:47104
    v_cvt_pk_bf16_f32 v91, v158, v159
    v_lshlrev_b32 v152, 16, v92
    v_and_b32 v153, s90, v92
    v_mfma_f32_32x32x16_bf16 v[240:255], v[148:151], v[72:75], v[240:255]
    ds_read_b64_tr_b16 v[144:145], v7 offset:14336
    ds_read_b64_tr_b16 v[146:147], v7 offset:14592
    v_lshlrev_b32 v154, 16, v93
    v_and_b32 v155, s90, v93
    s_waitcnt lgkmcnt(6)
    v_mfma_f32_32x32x16_bf16 v[160:175], v[76:79], v[128:131], v[160:175]
    ds_read_b64_tr_b16 v[148:149], v7 offset:15360
    ds_read_b64_tr_b16 v[150:151], v7 offset:15616
    v_lshlrev_b32 v156, 16, v94
    v_and_b32 v157, s90, v94
    v_lshlrev_b32 v158, 16, v95
    v_mfma_f32_32x32x16_bf16 v[176:191], v[76:79], v[132:135], v[176:191]
    s_barrier
    ds_read_b64_tr_b16 v[128:129], v3 offset:49152
    ds_read_b64_tr_b16 v[130:131], v3 offset:51200
    v_and_b32 v159, s90, v95
    v_add_f32 v152, v152, v9
    s_waitcnt lgkmcnt(6)
    v_mfma_f32_32x32x16_bf16 v[192:207], v[76:79], v[136:139], v[192:207]
    ds_read_b64_tr_b16 v[132:133], v4 offset:49152
    ds_read_b64_tr_b16 v[134:135], v4 offset:51200
    v_add_f32 v153, v153, v9
    v_add_f32 v154, v154, v9
    v_add_f32 v155, v155, v9
    v_mfma_f32_32x32x16_bf16 v[208:223], v[76:79], v[140:143], v[208:223]
    ds_read_b64_tr_b16 v[136:137], v5 offset:49152
    ds_read_b64_tr_b16 v[138:139], v5 offset:51200
    v_add_f32 v156, v156, v9
    v_add_f32 v157, v157, v9
    s_waitcnt lgkmcnt(6)
    v_mfma_f32_32x32x16_bf16 v[224:239], v[144:147], v[76:79], v[224:239]
    ds_read_b64_tr_b16 v[140:141], v6 offset:49152
    ds_read_b64_tr_b16 v[142:143], v6 offset:51200
    v_add_f32 v158, v158, v9
    v_add_f32 v159, v159, v9
    v_cvt_pk_bf16_f32 v92, v152, v153
    v_mfma_f32_32x32x16_bf16 v[240:255], v[148:151], v[76:79], v[240:255]
    ds_read_b64_tr_b16 v[144:145], v7 offset:49152
    ds_read_b64_tr_b16 v[146:147], v7 offset:49408
    v_cvt_pk_bf16_f32 v93, v154, v155
    v_cvt_pk_bf16_f32 v94, v156, v157
    s_waitcnt lgkmcnt(6)
    v_mfma_f32_32x32x16_bf16 v[160:175], v[80:83], v[128:131], v[160:175]
    ds_read_b64_tr_b16 v[148:149], v7 offset:50176
    ds_read_b64_tr_b16 v[150:151], v7 offset:50432
    v_cvt_pk_bf16_f32 v95, v158, v159
    v_lshlrev_b32 v152, 16, v96
    v_mfma_f32_32x32x16_bf16 v[176:191], v[80:83], v[132:135], v[176:191]
    ds_read_b64_tr_b16 v[128:129], v3 offset:53248
    ds_read_b64_tr_b16 v[130:131], v3 offset:55296
    v_and_b32 v153, s90, v96
    v_lshlrev_b32 v154, 16, v97
    v_and_b32 v155, s90, v97
    s_waitcnt lgkmcnt(6)
    v_mfma_f32_32x32x16_bf16 v[192:207], v[80:83], v[136:139], v[192:207]
    ds_read_b64_tr_b16 v[132:133], v4 offset:53248
    ds_read_b64_tr_b16 v[134:135], v4 offset:55296
    v_lshlrev_b32 v156, 16, v98
    v_and_b32 v157, s90, v98
    v_mfma_f32_32x32x16_bf16 v[208:223], v[80:83], v[140:143], v[208:223]
    ds_read_b64_tr_b16 v[136:137], v5 offset:53248
    ds_read_b64_tr_b16 v[138:139], v5 offset:55296
    v_lshlrev_b32 v158, 16, v99
    v_and_b32 v159, s90, v99
    v_add_f32 v152, v152, v9
    s_waitcnt lgkmcnt(6)
    v_mfma_f32_32x32x16_bf16 v[224:239], v[144:147], v[80:83], v[224:239]
    ds_read_b64_tr_b16 v[140:141], v6 offset:53248
    ds_read_b64_tr_b16 v[142:143], v6 offset:55296
    v_add_f32 v153, v153, v9
    v_add_f32 v154, v154, v9
    v_mfma_f32_32x32x16_bf16 v[240:255], v[148:151], v[80:83], v[240:255]
    ds_read_b64_tr_b16 v[144:145], v7 offset:53248
    ds_read_b64_tr_b16 v[146:147], v7 offset:53504
    v_add_f32 v155, v155, v9
    v_add_f32 v156, v156, v9
    v_add_f32 v157, v157, v9
    s_waitcnt lgkmcnt(6)
    v_mfma_f32_32x32x16_bf16 v[160:175], v[84:87], v[128:131], v[160:175]
    ds_read_b64_tr_b16 v[148:149], v7 offset:54272
    ds_read_b64_tr_b16 v[150:151], v7 offset:54528
    v_add_f32 v158, v158, v9
    v_add_f32 v159, v159, v9
    v_mfma_f32_32x32x16_bf16 v[176:191], v[84:87], v[132:135], v[176:191]
    ds_read_b64_tr_b16 v[128:129], v3 offset:57344
    ds_read_b64_tr_b16 v[130:131], v3 offset:59392
    v_cvt_pk_bf16_f32 v96, v152, v153
    v_cvt_pk_bf16_f32 v97, v154, v155
    v_cvt_pk_bf16_f32 v98, v156, v157
    s_waitcnt lgkmcnt(6)
    v_mfma_f32_32x32x16_bf16 v[192:207], v[84:87], v[136:139], v[192:207]
    ds_read_b64_tr_b16 v[132:133], v4 offset:57344
    ds_read_b64_tr_b16 v[134:135], v4 offset:59392
    v_cvt_pk_bf16_f32 v99, v158, v159
    v_lshlrev_b32 v152, 16, v100
    v_mfma_f32_32x32x16_bf16 v[208:223], v[84:87], v[140:143], v[208:223]
    ds_read_b64_tr_b16 v[136:137], v5 offset:57344
    ds_read_b64_tr_b16 v[138:139], v5 offset:59392
    v_and_b32 v153, s90, v100
    v_lshlrev_b32 v154, 16, v101
    v_and_b32 v155, s90, v101
    s_waitcnt lgkmcnt(6)
    v_mfma_f32_32x32x16_bf16 v[224:239], v[144:147], v[84:87], v[224:239]
    ds_read_b64_tr_b16 v[140:141], v6 offset:57344
    ds_read_b64_tr_b16 v[142:143], v6 offset:59392
    v_lshlrev_b32 v156, 16, v102
    v_and_b32 v157, s90, v102
    v_mfma_f32_32x32x16_bf16 v[240:255], v[148:151], v[84:87], v[240:255]
    ds_read_b64_tr_b16 v[144:145], v7 offset:57344
    ds_read_b64_tr_b16 v[146:147], v7 offset:57600
    v_lshlrev_b32 v158, 16, v103
    v_and_b32 v159, s90, v103
    v_add_f32 v152, v152, v9
    s_waitcnt lgkmcnt(6)
    v_mfma_f32_32x32x16_bf16 v[160:175], v[88:91], v[128:131], v[160:175]
    ds_read_b64_tr_b16 v[148:149], v7 offset:58368
    ds_read_b64_tr_b16 v[150:151], v7 offset:58624
    v_add_f32 v153, v153, v9
    v_add_f32 v154, v154, v9
    v_mfma_f32_32x32x16_bf16 v[176:191], v[88:91], v[132:135], v[176:191]
    ds_read_b64_tr_b16 v[128:129], v3 offset:61440
    ds_read_b64_tr_b16 v[130:131], v3 offset:63488
    v_add_f32 v155, v155, v9
    v_add_f32 v156, v156, v9
    v_add_f32 v157, v157, v9
    s_waitcnt lgkmcnt(6)
    v_mfma_f32_32x32x16_bf16 v[192:207], v[88:91], v[136:139], v[192:207]
    ds_read_b64_tr_b16 v[132:133], v4 offset:61440
    ds_read_b64_tr_b16 v[134:135], v4 offset:63488
    v_add_f32 v158, v158, v9
    v_add_f32 v159, v159, v9
    v_mfma_f32_32x32x16_bf16 v[208:223], v[88:91], v[140:143], v[208:223]
    ds_read_b64_tr_b16 v[136:137], v5 offset:61440
    ds_read_b64_tr_b16 v[138:139], v5 offset:63488
    v_cvt_pk_bf16_f32 v100, v152, v153
    v_cvt_pk_bf16_f32 v101, v154, v155
    v_cvt_pk_bf16_f32 v102, v156, v157
    s_waitcnt lgkmcnt(6)
    v_mfma_f32_32x32x16_bf16 v[224:239], v[144:147], v[88:91], v[224:239]
    ds_read_b64_tr_b16 v[140:141], v6 offset:61440
    ds_read_b64_tr_b16 v[142:143], v6 offset:63488
    v_cvt_pk_bf16_f32 v103, v158, v159
    v_lshlrev_b32 v152, 16, v104
    v_mfma_f32_32x32x16_bf16 v[240:255], v[148:151], v[88:91], v[240:255]
    ds_read_b64_tr_b16 v[144:145], v7 offset:61440
    ds_read_b64_tr_b16 v[146:147], v7 offset:61696
    v_and_b32 v153, s90, v104
    v_lshlrev_b32 v154, 16, v105
    v_and_b32 v155, s90, v105
    s_waitcnt lgkmcnt(6)
    v_mfma_f32_32x32x16_bf16 v[160:175], v[92:95], v[128:131], v[160:175]
    ds_read_b64_tr_b16 v[148:149], v7 offset:62464
    ds_read_b64_tr_b16 v[150:151], v7 offset:62720
    v_lshlrev_b32 v156, 16, v106
    v_and_b32 v157, s90, v106
    v_mfma_f32_32x32x16_bf16 v[176:191], v[92:95], v[132:135], v[176:191]
    s_barrier
    v_add_u32 v3, 81920, v3
    v_add_u32 v4, 81920, v4
    v_add_u32 v5, 81920, v5
    v_add_u32 v6, 81920, v6
    ds_read_b64_tr_b16 v[128:129], v3 offset:0
    ds_read_b64_tr_b16 v[130:131], v3 offset:2048
    v_lshlrev_b32 v158, 16, v107
    v_and_b32 v159, s90, v107
    v_add_f32 v152, v152, v9
    s_waitcnt lgkmcnt(6)
    v_mfma_f32_32x32x16_bf16 v[192:207], v[92:95], v[136:139], v[192:207]
    ds_read_b64_tr_b16 v[132:133], v4 offset:0
    ds_read_b64_tr_b16 v[134:135], v4 offset:2048
    v_add_f32 v153, v153, v9
    v_add_f32 v154, v154, v9
    v_mfma_f32_32x32x16_bf16 v[208:223], v[92:95], v[140:143], v[208:223]
    ds_read_b64_tr_b16 v[136:137], v5 offset:0
    ds_read_b64_tr_b16 v[138:139], v5 offset:2048
    v_add_f32 v155, v155, v9
    v_add_f32 v156, v156, v9
    v_add_f32 v157, v157, v9
    s_waitcnt lgkmcnt(6)
    v_mfma_f32_32x32x16_bf16 v[224:239], v[144:147], v[92:95], v[224:239]
    ds_read_b64_tr_b16 v[140:141], v6 offset:0
    ds_read_b64_tr_b16 v[142:143], v6 offset:2048
    v_add_f32 v158, v158, v9
    v_add_f32 v159, v159, v9
    v_mfma_f32_32x32x16_bf16 v[240:255], v[148:151], v[92:95], v[240:255]
    v_add_u32 v7, 51200, v7
    ds_read_b64_tr_b16 v[144:145], v7 offset:0
    ds_read_b64_tr_b16 v[146:147], v7 offset:256
    v_cvt_pk_bf16_f32 v104, v152, v153
    v_cvt_pk_bf16_f32 v105, v154, v155
    v_cvt_pk_bf16_f32 v106, v156, v157
    s_waitcnt lgkmcnt(6)
    v_mfma_f32_32x32x16_bf16 v[160:175], v[96:99], v[128:131], v[160:175]
    ds_read_b64_tr_b16 v[148:149], v7 offset:1024
    ds_read_b64_tr_b16 v[150:151], v7 offset:1280
    v_cvt_pk_bf16_f32 v107, v158, v159
    v_lshlrev_b32 v152, 16, v108
    v_mfma_f32_32x32x16_bf16 v[176:191], v[96:99], v[132:135], v[176:191]
    ds_read_b64_tr_b16 v[128:129], v3 offset:4096
    ds_read_b64_tr_b16 v[130:131], v3 offset:6144
    v_and_b32 v153, s90, v108
    v_lshlrev_b32 v154, 16, v109
    v_and_b32 v155, s90, v109
    s_waitcnt lgkmcnt(6)
    v_mfma_f32_32x32x16_bf16 v[192:207], v[96:99], v[136:139], v[192:207]
    ds_read_b64_tr_b16 v[132:133], v4 offset:4096
    ds_read_b64_tr_b16 v[134:135], v4 offset:6144
    v_lshlrev_b32 v156, 16, v110
    v_and_b32 v157, s90, v110
    v_mfma_f32_32x32x16_bf16 v[208:223], v[96:99], v[140:143], v[208:223]
    ds_read_b64_tr_b16 v[136:137], v5 offset:4096
    ds_read_b64_tr_b16 v[138:139], v5 offset:6144
    v_lshlrev_b32 v158, 16, v111
    v_and_b32 v159, s90, v111
    v_add_f32 v152, v152, v9
    s_waitcnt lgkmcnt(6)
    v_mfma_f32_32x32x16_bf16 v[224:239], v[144:147], v[96:99], v[224:239]
    ds_read_b64_tr_b16 v[140:141], v6 offset:4096
    ds_read_b64_tr_b16 v[142:143], v6 offset:6144
    v_add_f32 v153, v153, v9
    v_add_f32 v154, v154, v9
    v_mfma_f32_32x32x16_bf16 v[240:255], v[148:151], v[96:99], v[240:255]
    ds_read_b64_tr_b16 v[144:145], v7 offset:4096
    ds_read_b64_tr_b16 v[146:147], v7 offset:4352
    v_add_f32 v155, v155, v9
    v_add_f32 v156, v156, v9
    v_add_f32 v157, v157, v9
    s_waitcnt lgkmcnt(6)
    v_mfma_f32_32x32x16_bf16 v[160:175], v[100:103], v[128:131], v[160:175]
    ds_read_b64_tr_b16 v[148:149], v7 offset:5120
    ds_read_b64_tr_b16 v[150:151], v7 offset:5376
    v_add_f32 v158, v158, v9
    v_add_f32 v159, v159, v9
    v_mfma_f32_32x32x16_bf16 v[176:191], v[100:103], v[132:135], v[176:191]
    ds_read_b64_tr_b16 v[128:129], v3 offset:8192
    ds_read_b64_tr_b16 v[130:131], v3 offset:10240
    v_cvt_pk_bf16_f32 v108, v152, v153
    v_cvt_pk_bf16_f32 v109, v154, v155
    v_cvt_pk_bf16_f32 v110, v156, v157
    s_waitcnt lgkmcnt(6)
    v_mfma_f32_32x32x16_bf16 v[192:207], v[100:103], v[136:139], v[192:207]
    ds_read_b64_tr_b16 v[132:133], v4 offset:8192
    ds_read_b64_tr_b16 v[134:135], v4 offset:10240
    v_cvt_pk_bf16_f32 v111, v158, v159
    v_lshlrev_b32 v152, 16, v112
    v_mfma_f32_32x32x16_bf16 v[208:223], v[100:103], v[140:143], v[208:223]
    ds_read_b64_tr_b16 v[136:137], v5 offset:8192
    ds_read_b64_tr_b16 v[138:139], v5 offset:10240
    v_and_b32 v153, s90, v112
    v_lshlrev_b32 v154, 16, v113
    s_waitcnt lgkmcnt(6)
    v_mfma_f32_32x32x16_bf16 v[224:239], v[144:147], v[100:103], v[224:239]
    ds_read_b64_tr_b16 v[140:141], v6 offset:8192
    ds_read_b64_tr_b16 v[142:143], v6 offset:10240
    v_and_b32 v155, s90, v113
    v_lshlrev_b32 v156, 16, v114
    v_and_b32 v157, s90, v114
    v_mfma_f32_32x32x16_bf16 v[240:255], v[148:151], v[100:103], v[240:255]
    ds_read_b64_tr_b16 v[144:145], v7 offset:8192
    ds_read_b64_tr_b16 v[146:147], v7 offset:8448
    v_lshlrev_b32 v158, 16, v115
    v_and_b32 v159, s90, v115
    s_waitcnt lgkmcnt(6)
    v_mfma_f32_32x32x16_bf16 v[160:175], v[104:107], v[128:131], v[160:175]
    ds_read_b64_tr_b16 v[148:149], v7 offset:9216
    ds_read_b64_tr_b16 v[150:151], v7 offset:9472
    v_add_f32 v152, v152, v9
    v_add_f32 v153, v153, v9
    v_add_f32 v154, v154, v9
    v_mfma_f32_32x32x16_bf16 v[176:191], v[104:107], v[132:135], v[176:191]
    ds_read_b64_tr_b16 v[128:129], v3 offset:12288
    ds_read_b64_tr_b16 v[130:131], v3 offset:14336
    v_add_f32 v155, v155, v9
    v_add_f32 v156, v156, v9
    s_waitcnt lgkmcnt(6)
    v_mfma_f32_32x32x16_bf16 v[192:207], v[104:107], v[136:139], v[192:207]
    ds_read_b64_tr_b16 v[132:133], v4 offset:12288
    ds_read_b64_tr_b16 v[134:135], v4 offset:14336
    v_add_f32 v157, v157, v9
    v_add_f32 v158, v158, v9
    v_add_f32 v159, v159, v9
    v_mfma_f32_32x32x16_bf16 v[208:223], v[104:107], v[140:143], v[208:223]
    ds_read_b64_tr_b16 v[136:137], v5 offset:12288
    ds_read_b64_tr_b16 v[138:139], v5 offset:14336
    v_cvt_pk_bf16_f32 v112, v152, v153
    v_cvt_pk_bf16_f32 v113, v154, v155
    s_waitcnt lgkmcnt(6)
    v_mfma_f32_32x32x16_bf16 v[224:239], v[144:147], v[104:107], v[224:239]
    ds_read_b64_tr_b16 v[140:141], v6 offset:12288
    ds_read_b64_tr_b16 v[142:143], v6 offset:14336
    v_cvt_pk_bf16_f32 v114, v156, v157
    v_cvt_pk_bf16_f32 v115, v158, v159
    v_lshlrev_b32 v152, 16, v116
    v_mfma_f32_32x32x16_bf16 v[240:255], v[148:151], v[104:107], v[240:255]
    ds_read_b64_tr_b16 v[144:145], v7 offset:12288
    ds_read_b64_tr_b16 v[146:147], v7 offset:12544
    v_and_b32 v153, s90, v116
    v_lshlrev_b32 v154, 16, v117
    s_waitcnt lgkmcnt(6)
    v_mfma_f32_32x32x16_bf16 v[160:175], v[108:111], v[128:131], v[160:175]
    ds_read_b64_tr_b16 v[148:149], v7 offset:13312
    ds_read_b64_tr_b16 v[150:151], v7 offset:13568
    v_and_b32 v155, s90, v117
    v_lshlrev_b32 v156, 16, v118
    v_and_b32 v157, s90, v118
    v_mfma_f32_32x32x16_bf16 v[176:191], v[108:111], v[132:135], v[176:191]
    s_barrier
    ds_read_b64_tr_b16 v[128:129], v3 offset:16384
    ds_read_b64_tr_b16 v[130:131], v3 offset:18432
    v_lshlrev_b32 v158, 16, v119
    v_and_b32 v159, s90, v119
    s_waitcnt lgkmcnt(6)
    v_mfma_f32_32x32x16_bf16 v[192:207], v[108:111], v[136:139], v[192:207]
    ds_read_b64_tr_b16 v[132:133], v4 offset:16384
    ds_read_b64_tr_b16 v[134:135], v4 offset:18432
    v_add_f32 v152, v152, v9
    v_add_f32 v153, v153, v9
    v_add_f32 v154, v154, v9
    v_mfma_f32_32x32x16_bf16 v[208:223], v[108:111], v[140:143], v[208:223]
    ds_read_b64_tr_b16 v[136:137], v5 offset:16384
    ds_read_b64_tr_b16 v[138:139], v5 offset:18432
    v_add_f32 v155, v155, v9
    v_add_f32 v156, v156, v9
    s_waitcnt lgkmcnt(6)
    v_mfma_f32_32x32x16_bf16 v[224:239], v[144:147], v[108:111], v[224:239]
    ds_read_b64_tr_b16 v[140:141], v6 offset:16384
    ds_read_b64_tr_b16 v[142:143], v6 offset:18432
    v_add_f32 v157, v157, v9
    v_add_f32 v158, v158, v9
    v_add_f32 v159, v159, v9
    v_mfma_f32_32x32x16_bf16 v[240:255], v[148:151], v[108:111], v[240:255]
    ds_read_b64_tr_b16 v[144:145], v7 offset:47104
    ds_read_b64_tr_b16 v[146:147], v7 offset:47360
    v_cvt_pk_bf16_f32 v116, v152, v153
    v_cvt_pk_bf16_f32 v117, v154, v155
    s_waitcnt lgkmcnt(6)
    v_mfma_f32_32x32x16_bf16 v[160:175], v[112:115], v[128:131], v[160:175]
    ds_read_b64_tr_b16 v[148:149], v7 offset:48128
    ds_read_b64_tr_b16 v[150:151], v7 offset:48384
    v_cvt_pk_bf16_f32 v118, v156, v157
    v_cvt_pk_bf16_f32 v119, v158, v159
    v_lshlrev_b32 v152, 16, v120
    v_mfma_f32_32x32x16_bf16 v[176:191], v[112:115], v[132:135], v[176:191]
    ds_read_b64_tr_b16 v[128:129], v3 offset:20480
    ds_read_b64_tr_b16 v[130:131], v3 offset:22528
    v_and_b32 v153, s90, v120
    v_lshlrev_b32 v154, 16, v121
    s_waitcnt lgkmcnt(6)
    v_mfma_f32_32x32x16_bf16 v[192:207], v[112:115], v[136:139], v[192:207]
    ds_read_b64_tr_b16 v[132:133], v4 offset:20480
    ds_read_b64_tr_b16 v[134:135], v4 offset:22528
    v_and_b32 v155, s90, v121
    v_lshlrev_b32 v156, 16, v122
    v_and_b32 v157, s90, v122
    v_mfma_f32_32x32x16_bf16 v[208:223], v[112:115], v[140:143], v[208:223]
    ds_read_b64_tr_b16 v[136:137], v5 offset:20480
    ds_read_b64_tr_b16 v[138:139], v5 offset:22528
    v_lshlrev_b32 v158, 16, v123
    v_and_b32 v159, s90, v123
    s_waitcnt lgkmcnt(6)
    v_mfma_f32_32x32x16_bf16 v[224:239], v[144:147], v[112:115], v[224:239]
    ds_read_b64_tr_b16 v[140:141], v6 offset:20480
    ds_read_b64_tr_b16 v[142:143], v6 offset:22528
    v_add_f32 v152, v152, v9
    v_add_f32 v153, v153, v9
    v_add_f32 v154, v154, v9
    v_mfma_f32_32x32x16_bf16 v[240:255], v[148:151], v[112:115], v[240:255]
    ds_read_b64_tr_b16 v[144:145], v7 offset:51200
    ds_read_b64_tr_b16 v[146:147], v7 offset:51456
    v_add_f32 v155, v155, v9
    v_add_f32 v156, v156, v9
    s_waitcnt lgkmcnt(6)
    v_mfma_f32_32x32x16_bf16 v[160:175], v[116:119], v[128:131], v[160:175]
    ds_read_b64_tr_b16 v[148:149], v7 offset:52224
    ds_read_b64_tr_b16 v[150:151], v7 offset:52480
    v_add_f32 v157, v157, v9
    v_add_f32 v158, v158, v9
    v_add_f32 v159, v159, v9
    v_mfma_f32_32x32x16_bf16 v[176:191], v[116:119], v[132:135], v[176:191]
    ds_read_b64_tr_b16 v[128:129], v3 offset:24576
    ds_read_b64_tr_b16 v[130:131], v3 offset:26624
    v_cvt_pk_bf16_f32 v120, v152, v153
    v_cvt_pk_bf16_f32 v121, v154, v155
    s_waitcnt lgkmcnt(6)
    v_mfma_f32_32x32x16_bf16 v[192:207], v[116:119], v[136:139], v[192:207]
    ds_read_b64_tr_b16 v[132:133], v4 offset:24576
    ds_read_b64_tr_b16 v[134:135], v4 offset:26624
    v_cvt_pk_bf16_f32 v122, v156, v157
    v_cvt_pk_bf16_f32 v123, v158, v159
    v_lshlrev_b32 v152, 16, v124
    v_mfma_f32_32x32x16_bf16 v[208:223], v[116:119], v[140:143], v[208:223]
    ds_read_b64_tr_b16 v[136:137], v5 offset:24576
    ds_read_b64_tr_b16 v[138:139], v5 offset:26624
    v_and_b32 v153, s90, v124
    v_lshlrev_b32 v154, 16, v125
    s_waitcnt lgkmcnt(6)
    v_mfma_f32_32x32x16_bf16 v[224:239], v[144:147], v[116:119], v[224:239]
    ds_read_b64_tr_b16 v[140:141], v6 offset:24576
    ds_read_b64_tr_b16 v[142:143], v6 offset:26624
    v_and_b32 v155, s90, v125
    v_lshlrev_b32 v156, 16, v126
    v_and_b32 v157, s90, v126
    v_mfma_f32_32x32x16_bf16 v[240:255], v[148:151], v[116:119], v[240:255]
    ds_read_b64_tr_b16 v[144:145], v7 offset:55296
    ds_read_b64_tr_b16 v[146:147], v7 offset:55552
    v_lshlrev_b32 v158, 16, v127
    v_and_b32 v159, s90, v127
    s_waitcnt lgkmcnt(6)
    v_mfma_f32_32x32x16_bf16 v[160:175], v[120:123], v[128:131], v[160:175]
    ds_read_b64_tr_b16 v[148:149], v7 offset:56320
    ds_read_b64_tr_b16 v[150:151], v7 offset:56576
    v_add_f32 v152, v152, v9
    v_add_f32 v153, v153, v9
    v_add_f32 v154, v154, v9
    v_mfma_f32_32x32x16_bf16 v[176:191], v[120:123], v[132:135], v[176:191]
    ds_read_b64_tr_b16 v[128:129], v3 offset:28672
    ds_read_b64_tr_b16 v[130:131], v3 offset:30720
    v_add_f32 v155, v155, v9
    v_add_f32 v156, v156, v9
    s_waitcnt lgkmcnt(6)
    v_mfma_f32_32x32x16_bf16 v[192:207], v[120:123], v[136:139], v[192:207]
    ds_read_b64_tr_b16 v[132:133], v4 offset:28672
    ds_read_b64_tr_b16 v[134:135], v4 offset:30720
    v_add_f32 v157, v157, v9
    v_add_f32 v158, v158, v9
    v_add_f32 v159, v159, v9
    v_mfma_f32_32x32x16_bf16 v[208:223], v[120:123], v[140:143], v[208:223]
    ds_read_b64_tr_b16 v[136:137], v5 offset:28672
    ds_read_b64_tr_b16 v[138:139], v5 offset:30720
    v_cvt_pk_bf16_f32 v124, v152, v153
    v_cvt_pk_bf16_f32 v125, v154, v155
    s_waitcnt lgkmcnt(6)
    v_mfma_f32_32x32x16_bf16 v[224:239], v[144:147], v[120:123], v[224:239]
    ds_read_b64_tr_b16 v[140:141], v6 offset:28672
    ds_read_b64_tr_b16 v[142:143], v6 offset:30720
    v_cvt_pk_bf16_f32 v126, v156, v157
    v_cvt_pk_bf16_f32 v127, v158, v159
    v_mfma_f32_32x32x16_bf16 v[240:255], v[148:151], v[120:123], v[240:255]
    ds_read_b64_tr_b16 v[144:145], v7 offset:59392
    ds_read_b64_tr_b16 v[146:147], v7 offset:59648
    s_waitcnt lgkmcnt(6)
    v_mfma_f32_32x32x16_bf16 v[160:175], v[124:127], v[128:131], v[160:175]
    ds_read_b64_tr_b16 v[148:149], v7 offset:60416
    ds_read_b64_tr_b16 v[150:151], v7 offset:60672
    v_mfma_f32_32x32x16_bf16 v[176:191], v[124:127], v[132:135], v[176:191]
    s_barrier
    s_waitcnt lgkmcnt(4)
    v_mfma_f32_32x32x16_bf16 v[192:207], v[124:127], v[136:139], v[192:207]
    v_mfma_f32_32x32x16_bf16 v[208:223], v[124:127], v[140:143], v[208:223]
    s_waitcnt lgkmcnt(0)
    v_mfma_f32_32x32x16_bf16 v[224:239], v[144:147], v[124:127], v[224:239]
    v_mfma_f32_32x32x16_bf16 v[240:255], v[148:151], v[124:127], v[240:255]
    s_branch L1_AP1e
L_code_end:
.section .rodata,"a"
.p2align 6
.amdhsa_kernel parallel_sum__mha_block__geglu_ffn__prompt_kernel
  .amdhsa_next_free_vgpr 256
  .amdhsa_next_free_sgpr 102
  .amdhsa_accum_offset 256
  .amdhsa_group_segment_fixed_size 0
  .amdhsa_kernarg_size 80
  .amdhsa_user_sgpr_count 2
  .amdhsa_user_sgpr_kernarg_segment_ptr 1
  .amdhsa_system_sgpr_workgroup_id_x 1
.end_amdhsa_kernel
```
